```python
import torch

def _softmax(x, axis=-1):
    return torch.softmax(x, dim=axis)
def _gelu(x):
    return torch.nn.functional.gelu(x, approximate="tanh")
def _silu(x):
    return torch.nn.functional.silu(x)
def _sigmoid(x):
    return torch.sigmoid(x)
def _layernorm(x, axis=-1, eps=1e-5):
    m = x.mean(dim=axis, keepdim=True)
    v = x.var(dim=axis, keepdim=True, unbiased=False)
    return (x - m) / torch.sqrt(v + eps)
def _scatter_add(tgt, idx, src, axis=0):
    return tgt.clone().index_add_(axis, idx, src)
def _segment_sum(src, seg, n):
    out = torch.zeros((n,) + src.shape[1:], dtype=src.dtype)
    return out.index_add_(0, seg, src)
def _pad(x, pw):
    flat = tuple(v for pair in reversed(pw) for v in pair)
    return torch.nn.functional.pad(x, flat)

kernel_name = 'interleave_layers__linear_kernel_hedgehog__glu_gated_glu__prompt'

def setup_inputs():

    _w = (lambda a: (lambda t: t.to(torch.bfloat16) if t.is_floating_point() else t)(torch.as_tensor(a)))
    def _A_setup():
        B, S, D, H = 1, 2048, 512, 32
        Dh = D // H
        return {
            "x": _w((lambda *s: torch.randn(*s, dtype=torch.bfloat16) * 0.05)(B, S, D)),
            "wqkv": _w((lambda *s: torch.randn(*s, dtype=torch.bfloat16) * 0.4)(D, 3 * D)),
            "w_phi": _w((lambda *s: torch.randn(*s, dtype=torch.bfloat16) * 0.4)(H, Dh, Dh) * (Dh ** -0.5)),
            "wo": _w((lambda *s: torch.randn(*s, dtype=torch.bfloat16) * 0.05)(D, D)),
        }
    _A_in = _A_setup()

    def _B_setup():
        B, S, D, F = 1, 2048, 512, 1792
        return {
            "x": _w((lambda *s: torch.randn(*s, dtype=torch.bfloat16) * 0.05)(B, S, D)),
            "w_gate": _w((lambda *s: torch.randn(*s, dtype=torch.bfloat16) * 0.05)(D, F)),
            "w_up": _w((lambda *s: torch.randn(*s, dtype=torch.bfloat16) * 0.05)(D, F)),
            "w_down": _w((lambda *s: torch.randn(*s, dtype=torch.bfloat16) * 0.05)(F, D)),
        }
    _B_in = _B_setup()

    return {
        "A_x": _A_in["x"],
        "A_wqkv": _A_in["wqkv"],
        "A_w_phi": _A_in["w_phi"],
        "A_wo": _A_in["wo"],
        "B_x": _B_in["x"],
        "B_w_gate": _B_in["w_gate"],
        "B_w_up": _B_in["w_up"],
        "B_w_down": _B_in["w_down"],
    }

def reference(A_x, A_wqkv, A_w_phi, A_wo, B_x, B_w_gate, B_w_up, B_w_down):
    def _A_ref(x, wqkv, w_phi, wo):
        B, S, D = x.shape
        H = 32; Dh = D // H
        qkv = (lambda x, *d: x.permute(*d))((x @ wqkv).reshape(B, S, 3, H, Dh), 2, 0, 3, 1, 4)
        q, k, v = qkv[0], qkv[1], qkv[2]
        pq = torch.einsum("bhsd,hdf->bhsf", q, w_phi)
        pk = torch.einsum("bhsd,hdf->bhsf", k, w_phi)
        phi_q = torch.concatenate([_softmax(pq, axis=-1), _softmax(-pq, axis=-1)], axis=-1)
        phi_k = torch.concatenate([_softmax(pk, axis=-1), _softmax(-pk, axis=-1)], axis=-1)
        kv = torch.einsum("bhsf,bhsd->bhfd", phi_k, v)
        z  = torch.einsum("bhsf->bhf", phi_k)
        num = torch.einsum("bhqf,bhfd->bhqd", phi_q, kv)
        den = torch.einsum("bhqf,bhf->bhq", phi_q, z)[..., None] + 1e-6
        o = num / den
        return (lambda x, *d: x.permute(*d))(o, 0, 2, 1, 3).reshape(B, S, D) @ wo

    def _B_ref(x, w_gate, w_up, w_down):
        g = torch.einsum("bsd,df->bsf", x, w_gate)
        u = torch.einsum("bsd,df->bsf", x, w_up)
        h = _sigmoid(g) * u
        return torch.einsum("bsf,fd->bsd", h, w_down)

    x = A_x
    x = x + _A_ref(_layernorm(x, axis=-1), A_wqkv, A_w_phi, A_wo)
    x = x + _B_ref(_layernorm(x, axis=-1), B_w_gate, B_w_up, B_w_down)
    x = x + _A_ref(_layernorm(x, axis=-1), A_wqkv, A_w_phi, A_wo)
    x = x + _B_ref(_layernorm(x, axis=-1), B_w_gate, B_w_up, B_w_down)
    return x
```

```asm
; @launch grid=(256,1,1) block=(256,1,1) lds=163840
.amdgcn_target "amdgcn-amd-amdhsa--gfx950"
.set CODE_LEN, 46692
.set CODE_MASK, 7
.set CODE_SLICE, 384
.text
.globl interleave_layers__linear_kernel_hedgehog__glu_gated_glu__prompt_kernel
.p2align 8
.type interleave_layers__linear_kernel_hedgehog__glu_gated_glu__prompt_kernel,@function
interleave_layers__linear_kernel_hedgehog__glu_gated_glu__prompt_kernel:
    s_cmp_ge_u32 s2, 0x100
    s_cbranch_scc1 L_end
    s_load_dwordx2 s[8:9], s[0:1], 0
    s_load_dwordx2 s[12:13], s[0:1], 8
    s_load_dwordx2 s[4:5], s[0:1], 80
    s_load_dwordx2 s[32:33], s[0:1], 16
    s_load_dwordx2 s[16:17], s[0:1], 24
    s_load_dwordx4 s[84:87], s[0:1], 40
    s_load_dwordx2 s[20:21], s[0:1], 56
    s_load_dwordx2 s[28:29], s[0:1], 64
    v_lshrrev_b32_e32 v4, 6, v0
    v_and_b32_e32 v0, 63, v0
    v_readfirstlane_b32 s37, v4
    s_mov_b32 s10, 0x200000
    s_mov_b32 s11, 0x20000
    s_mov_b32 s14, 0x180000
    s_mov_b32 s15, 0x20000
    s_mov_b32 s6, 0x10000000
    s_mov_b32 s7, 0x20000
    s_mov_b32 s34, 0x4000
    s_mov_b32 s35, 0x20000
    s_mov_b32 s18, 0x80000
    s_mov_b32 s19, 0x20000
    s_mov_b32 s22, 0x1c0000
    s_mov_b32 s23, 0x20000
    s_mov_b32 s30, 0x200000
    s_mov_b32 s31, 0x20000
    s_mov_b32 s26, 0x1c0000
    s_mov_b32 s27, 0x20000
    s_and_b32 s50, s2, 7
    s_lshr_b32 s51, s2, 3
    s_and_b32 s39, s51, 15
    s_lshl_b32 s81, s50, 5
    s_add_u32 s81, s81, s51
    s_lshr_b32 s38, s81, 4
    s_lshl_b32 s81, s81, 2
    s_add_u32 s81, s81, s37
    s_lshl_b32 s50, s38, 2
    s_add_u32 s41, s50, s37
    v_lshlrev_b32_e32 v1, 4, v0
    v_mov_b32_e32 v7, 0
    v_lshrrev_b32_e32 v16, 3, v0
    v_and_b32_e32 v17, 7, v0
    v_lshrrev_b32_e32 v18, 1, v16
    v_xor_b32_e32 v17, v17, v18
    v_lshlrev_b32_e32 v16, 10, v16
    v_lshl_add_u32 v120, v17, 4, v16
    v_lshlrev_b32_e32 v4, 7, v0
    v_xor_b32_e32 v121, 64, v120
    s_mul_i32 s83, s37, 12288
    s_add_u32 s83, s83, 98304
    v_lshrrev_b32_e32 v18, 2, v0
    v_and_b32_e32 v19, 3, v0
    v_mul_u32_u24_e32 v5, 0xc00, v18
    v_lshl_add_u32 v5, v19, 4, v5
    s_lshl_b32 s56, s41, 15
    s_add_u32 s57, s56, 0x1c00
    s_add_u32 s58, s56, 0x3800
    s_add_u32 s59, s56, 0x5400
    s_mul_i32 s52, s37, 0xc000
    s_lshl_b32 s50, s39, 6
    s_add_u32 s52, s52, s50
    s_lshl_b32 s53, s37, 11
    s_getpc_b64 s[90:91]
L_pc:
    s_and_b32 s50, s81, 127
    s_mul_i32 s50, s50, CODE_SLICE
    v_add_u32_e32 v22, s50, v4
    v_min_u32_e32 v22, CODE_LEN, v22
    s_mov_b64 exec, CODE_MASK
    global_load_dword a254, v22, s[90:91]
    s_mov_b64 exec, -1
    s_waitcnt lgkmcnt(0)
    s_load_dword s36, s[4:5], 0
    s_mul_i32 s50, s81, 2048
    s_mov_b64 exec, 0xffff
    buffer_load_dword a255, v4, s[8:11], s50 offen nt
    s_mov_b64 exec, -1
    s_mul_i32 s50, s81, 1536
    s_mov_b64 exec, 0xfff
    buffer_load_dword a255, v4, s[12:15], s50 offen
    s_mov_b64 exec, -1
    s_lshl_b32 s50, s37, 8
    s_add_u32 m0, s50, 159744
    s_lshl_b32 s54, s39, 10
    s_add_u32 s54, s54, s50
    s_mov_b64 exec, 0xffff
    buffer_load_dwordx4 v1, s[32:35], s54 offen lds
    s_mov_b64 exec, -1
    s_and_b32 s40, s39, 7
    s_and_b32 s46, s37, 1
    s_lshr_b32 s47, s37, 1
    s_lshr_b32 s51, s39, 3
    s_lshl_b32 s51, s51, 1
    s_lshl_b32 s50, s38, 2
    s_add_u32 s50, s50, s51
    s_add_u32 s42, s50, s47
    s_lshl_b32 s48, s37, 10
    s_lshl_b32 s49, s37, 12
    s_mov_b32 s45, 0x3f803f80
    s_mov_b32 s44, 0xffc00000
    s_cmp_eq_u32 s46, 0
    s_cselect_b32 s24, s84, s86
    s_cselect_b32 s25, s85, s87
    v_add_u32_e32 v74, 0, v0
    v_mul_u32_u24_e32 v75, 0x124a, v74
    v_lshrrev_b32_e32 v75, 16, v75
    v_mul_u32_u24_e32 v75, 3360, v75
    v_lshl_add_u32 v76, v74, 4, v75
    v_add_u32_e32 v74, 64, v0
    v_mul_u32_u24_e32 v75, 0x124a, v74
    v_lshrrev_b32_e32 v75, 16, v75
    v_mul_u32_u24_e32 v75, 3360, v75
    v_lshl_add_u32 v77, v74, 4, v75
    v_subrev_u32_e32 v77, 1024, v77
    v_add_u32_e32 v74, 128, v0
    v_mul_u32_u24_e32 v75, 0x124a, v74
    v_lshrrev_b32_e32 v75, 16, v75
    v_mul_u32_u24_e32 v75, 3360, v75
    v_lshl_add_u32 v78, v74, 4, v75
    v_subrev_u32_e32 v78, 2048, v78
    v_add_u32_e32 v74, 192, v0
    v_mul_u32_u24_e32 v75, 0x124a, v74
    v_lshrrev_b32_e32 v75, 16, v75
    v_mul_u32_u24_e32 v75, 3360, v75
    v_lshl_add_u32 v79, v74, 4, v75
    v_subrev_u32_e32 v79, 3072, v79
    v_lshlrev_b32_e32 v23, 10, v0
    s_and_b32 s50, s81, 127
    s_mul_i32 s50, s50, 12288
    s_mov_b64 exec, 0xfff
    buffer_load_dword a255, v23, s[12:15], s50 offen offset:384
    s_mov_b64 exec, -1
    s_add_u32 m0, s83, 0
    s_nop 0
    buffer_load_dwordx4 v120, s[8:11], s56 offen lds
    buffer_load_dwordx4 v121, s[8:11], s57 offen offset:1024 lds
    buffer_load_dwordx4 v120, s[8:11], s58 offen offset:2048 lds
    v_add_u32_e32 v120, 0x80, v120
    buffer_load_dwordx4 v121, s[8:11], s59 offen offset:3072 lds
    v_add_u32_e32 v121, 0x80, v121
    v_add_u32_e32 v2, 0x10000, v1
    v_add_u32_e32 v3, 0x20000, v1
    v_cmp_gt_u32_e32 vcc, 32, v0
    v_mov_b32_e32 v22, 0xbb000000
    s_nop 0
    v_cndmask_b32_e32 v11, 0, v22, vcc
    v_and_b32_e32 v18, 31, v0
    v_lshrrev_b32_e32 v22, 5, v0
    v_bfe_u32 v23, v0, 1, 3
    v_xor_b32_e32 v22, v22, v23
    v_lshlrev_b32_e32 v22, 4, v22
    v_lshl_add_u32 v22, v18, 7, v22
    v_add_u32_e32 v122, s83, v22
    v_xor_b32_e32 v123, 32, v122
    v_xor_b32_e32 v124, 64, v122
    v_xor_b32_e32 v125, 0x60, v122
    s_lshr_b32 s88, s39, 3
    s_lshr_b32 s89, s41, 1
    s_lshr_b32 s87, s42, 1
    s_mul_i32 s64, s42, 32768
    s_mul_i32 s50, s40, 4096
    s_add_u32 s64, s64, s50
    s_mul_i32 s50, s46, 2048
    s_add_u32 s64, s64, s50
    s_add_u32 s64, s64, 0x1800000
    s_mul_i32 s65, s41, 32768
    s_add_u32 s65, s65, 0x1800000
    s_mul_i32 s66, s42, 4096
    s_mul_i32 s50, s40, 512
    s_add_u32 s66, s66, s50
    s_mul_i32 s50, s46, 8
    s_add_u32 s66, s66, s50
    s_add_u32 s66, s66, 0x1a00000
    s_mul_i32 s67, s41, 4096
    s_add_u32 s67, s67, 0x1a00000
    s_mul_i32 s68, s89, 229376
    s_mul_i32 s50, s46, 32768
    s_add_u32 s68, s68, s50
    s_mul_i32 s50, s39, 2048
    s_add_u32 s68, s68, s50
    s_add_u32 s68, s68, 0x1000000
    s_mul_i32 s69, s87, 229376
    s_mul_i32 s50, s47, 32768
    s_add_u32 s69, s69, s50
    s_mul_i32 s50, s46, 16384
    s_add_u32 s69, s69, s50
    s_add_u32 s69, s69, 0x1000000
    s_mul_i32 s70, s89, 229376
    s_mul_i32 s50, s40, 4096
    s_add_u32 s70, s70, s50
    s_mul_i32 s50, s88, 2048
    s_add_u32 s70, s70, s50
    s_mul_i32 s50, s46, 1024
    s_add_u32 s70, s70, s50
    s_add_u32 s70, s70, 0x1000000
    s_mul_i32 s61, s87, 229376
    s_mul_i32 s50, s37, 4096
    s_add_u32 s61, s61, s50
    s_add_u32 s61, s61, 0x1000000
    s_mul_i32 s71, s42, 2048
    s_mul_i32 s50, s40, 8
    s_add_u32 s71, s71, s50
    s_mul_i32 s50, s46, 4
    s_add_u32 s71, s71, s50
    s_add_u32 s71, s71, 0x60000
    s_mul_i32 s72, s41, 2048
    s_add_u32 s72, s72, 0x60000
    s_mul_i32 s73, s41, 2048
    s_mul_i32 s50, s39, 4
    s_add_u32 s73, s73, s50
    s_add_u32 s73, s73, 0x60000
    s_mul_i32 s74, s42, 2048
    s_mul_i32 s50, s46, 32
    s_add_u32 s74, s74, s50
    s_add_u32 s74, s74, 0x60000
    s_mul_i32 s75, s89, 4096
    s_mul_i32 s50, s46, 64
    s_add_u32 s75, s75, s50
    s_mul_i32 s50, s39, 4
    s_add_u32 s75, s75, s50
    s_add_u32 s75, s75, 0x60000
    s_mul_i32 s76, s87, 4096
    s_add_u32 s76, s76, 0x60000
    s_mul_i32 s77, s39, 64
    s_mul_i32 s50, s37, 16
    s_add_u32 s77, s77, s50
    s_mul_i32 s80, s37, 8192
    s_mul_i32 s50, s40, 128
    s_add_u32 s80, s80, s50
    s_mul_i32 s55, s40, 229376
    s_mul_i32 s50, s47, 114688
    s_add_u32 s55, s55, s50
    s_mul_i32 s50, s46, 57344
    s_add_u32 s55, s55, s50
    s_add_u32 s55, s55, 0xc00000
    s_mul_i32 s60, s39, 229376
    s_mul_i32 s50, s37, 4096
    s_add_u32 s60, s60, s50
    s_add_u32 s60, s60, 0x400000
    s_mul_i32 s82, s39, 98304
    s_mul_i32 s50, s37, 4096
    s_add_u32 s82, s82, s50
    s_add_u32 s82, s82, 0x800000
    v_bfe_u32 v24, v0, 2, 2
    v_lshrrev_b32_e32 v25, 5, v0
    v_lshl_add_u32 v24, v25, 3, v24
    v_mul_u32_u24_e32 v6, 64, v24
    v_bfe_u32 v24, v0, 4, 1
    v_lshl_add_u32 v6, v24, 5, v6
    v_and_b32_e32 v24, 3, v0
    v_lshl_add_u32 v6, v24, 3, v6
    v_bfe_u32 v24, v0, 2, 2
    v_lshrrev_b32_e32 v25, 5, v0
    v_lshl_add_u32 v24, v25, 2, v24
    v_mul_u32_u24_e32 v64, 64, v24
    v_bfe_u32 v24, v0, 4, 1
    v_lshl_add_u32 v64, v24, 5, v64
    v_and_b32_e32 v24, 3, v0
    v_lshl_add_u32 v64, v24, 3, v64
    v_add_u32_e32 v126, s53, v6
    v_mov_b32_e32 v48, 0
    v_mov_b32_e32 v49, 0
    v_mov_b32_e32 v50, 0
    v_mov_b32_e32 v51, 0
    v_mov_b32_e32 v52, 0
    v_mov_b32_e32 v53, 0
    v_mov_b32_e32 v54, 0
    v_mov_b32_e32 v55, 0
    v_mov_b32_e32 v56, 0
    v_mov_b32_e32 v57, 0
    v_and_b32_e32 v65, 31, v0
    v_lshrrev_b32_e32 v66, 5, v0
    v_lshlrev_b32_e32 v65, 5, v65
    v_add_u32_e32 v65, 157696, v65
    v_lshl_add_u32 v66, v66, 2, v65
    s_lshl_b32 s50, s37, 3
    v_add_u32_e32 v66, s50, v66
    s_lshl_b32 s50, s38, 12
    s_add_u32 s50, s50, s48
    v_add_u32_e32 v72, s50, v64
    v_bfe_u32 v67, v0, 2, 2
    v_lshrrev_b32_e32 v68, 5, v0
    v_lshl_add_u32 v67, v68, 2, v67
    v_lshlrev_b32_e32 v67, 5, v67
    v_bfe_u32 v68, v0, 4, 1
    v_lshl_add_u32 v67, v68, 9, v67
    v_cmp_eq_u32_e32 vcc, 0, v68
    v_and_b32_e32 v68, 3, v0
    v_lshl_add_u32 v67, v68, 3, v67
    v_add_u32_e32 v67, 159744, v67
    s_waitcnt lgkmcnt(0)
    s_add_u32 s36, s36, 1
    s_and_b32 s78, s36, 0xfff
    s_lshl_b32 s50, s37, 1
    s_add_u32 s50, s50, 0
    s_mul_i32 s51, s38, 6
    s_add_u32 s51, s51, s50
    s_lshl_b32 s88, s50, 4
    s_add_u32 s88, s88, s38
    s_lshl_b32 s88, s88, 1
    s_cmp_lt_u32 s50, 3
    s_cselect_b32 s51, s51, s88
    s_cselect_b32 s88, 3, 1
    s_lshl_b32 s88, s88, 10
    s_lshl_b32 s51, s51, 10
    s_add_u32 s51, s51, s60
    s_sub_u32 s84, s51, s49
    s_add_u32 s85, s84, s88
    s_lshl_b32 s50, s37, 1
    s_add_u32 s50, s50, 1
    s_mul_i32 s51, s38, 6
    s_add_u32 s51, s51, s50
    s_lshl_b32 s88, s50, 4
    s_add_u32 s88, s88, s38
    s_lshl_b32 s88, s88, 1
    s_cmp_lt_u32 s50, 3
    s_cselect_b32 s51, s51, s88
    s_cselect_b32 s88, 3, 1
    s_lshl_b32 s88, s88, 10
    s_lshl_b32 s51, s51, 10
    s_add_u32 s51, s51, s60
    s_sub_u32 s86, s51, s49
    s_add_u32 s87, s86, s88
    v_bfe_u32 v74, v0, 2, 3
    v_lshlrev_b32_e32 v73, 10, v74
    v_lshrrev_b32_e32 v74, 5, v0
    v_lshl_add_u32 v73, v74, 6, v73
    v_and_b32_e32 v74, 3, v0
    v_lshl_add_u32 v73, v74, 4, v73
    s_add_u32 m0, s53, 0
    s_add_u32 s54, s52, 1024
    buffer_load_dwordx4 v5, s[12:15], s54 offen lds
    buffer_load_dwordx4 v5, s[12:15], s54 offen offset:1024 lds
    s_add_u32 m0, s83, 4096
    s_nop 0
    buffer_load_dwordx4 v120, s[8:11], s56 offen lds
    buffer_load_dwordx4 v121, s[8:11], s57 offen offset:1024 lds
    buffer_load_dwordx4 v120, s[8:11], s58 offen offset:2048 lds
    v_add_u32_e32 v120, 0x80, v120
    buffer_load_dwordx4 v121, s[8:11], s59 offen offset:3072 lds
    v_add_u32_e32 v121, 0x80, v121
    s_add_u32 m0, s53, 8192
    s_add_u32 s54, s52, 197632
    buffer_load_dwordx4 v5, s[12:15], s54 offen lds
    buffer_load_dwordx4 v5, s[12:15], s54 offen offset:1024 lds
    s_waitcnt vmcnt(8)
    ds_read_b128 v[128:131], v122 offset:0
    ds_read_b128 v[132:135], v123 offset:0
    ds_read_b128 v[136:139], v124 offset:0
    ds_read_b128 v[140:143], v125 offset:0
    s_waitcnt vmcnt(6)
    s_barrier
    ds_read_b64_tr_b16 v[80:81], v6 offset:0
    ds_read_b64_tr_b16 v[82:83], v6 offset:256
    ds_read_b64_tr_b16 v[84:85], v6 offset:1024
    ds_read_b64_tr_b16 v[86:87], v6 offset:1280
    ds_read_b64_tr_b16 v[88:89], v6 offset:2048
    ds_read_b64_tr_b16 v[90:91], v6 offset:2304
    ds_read_b64_tr_b16 v[92:93], v6 offset:3072
    ds_read_b64_tr_b16 v[94:95], v6 offset:3328
    ds_read_b64_tr_b16 v[96:97], v6 offset:4096
    ds_read_b64_tr_b16 v[98:99], v6 offset:4352
    ds_read_b64_tr_b16 v[100:101], v6 offset:5120
    ds_read_b64_tr_b16 v[102:103], v6 offset:5376
    ds_read_b64_tr_b16 v[104:105], v6 offset:6144
    ds_read_b64_tr_b16 v[106:107], v6 offset:6400
    ds_read_b64_tr_b16 v[112:113], v126 offset:0
    ds_read_b64_tr_b16 v[114:115], v126 offset:256
    ds_read_b64_tr_b16 v[116:117], v126 offset:1024
    ds_read_b64_tr_b16 v[118:119], v126 offset:1280
    ds_read_b64_tr_b16 v[68:69], v67
    ds_read_b64_tr_b16 v[70:71], v67 offset:256
    s_waitcnt lgkmcnt(15)
    v_dot2c_f32_bf16_e32 v48, s45, v128
    v_dot2c_f32_bf16_e32 v52, v128, v128
    v_dot2c_f32_bf16_e32 v49, s45, v129
    v_dot2c_f32_bf16_e32 v53, v129, v129
    s_add_u32 m0, s83, 8192
    s_nop 0
    buffer_load_dwordx4 v120, s[8:11], s56 offen lds
    v_dot2c_f32_bf16_e32 v50, s45, v130
    v_dot2c_f32_bf16_e32 v54, v130, v130
    v_dot2c_f32_bf16_e32 v51, s45, v131
    v_dot2c_f32_bf16_e32 v55, v131, v131
    v_dot2c_f32_bf16_e32 v48, s45, v132
    v_dot2c_f32_bf16_e32 v52, v132, v132
    v_dot2c_f32_bf16_e32 v49, s45, v133
    buffer_load_dwordx4 v121, s[8:11], s57 offen offset:1024 lds
    v_dot2c_f32_bf16_e32 v53, v133, v133
    v_dot2c_f32_bf16_e32 v50, s45, v134
    v_dot2c_f32_bf16_e32 v54, v134, v134
    v_dot2c_f32_bf16_e32 v51, s45, v135
    v_dot2c_f32_bf16_e32 v55, v135, v135
    v_dot2c_f32_bf16_e32 v48, s45, v136
    buffer_load_dwordx4 v120, s[8:11], s58 offen offset:2048 lds
    v_add_u32_e32 v120, 0x80, v120
    v_dot2c_f32_bf16_e32 v52, v136, v136
    v_dot2c_f32_bf16_e32 v49, s45, v137
    v_dot2c_f32_bf16_e32 v53, v137, v137
    v_dot2c_f32_bf16_e32 v50, s45, v138
    v_dot2c_f32_bf16_e32 v54, v138, v138
    v_dot2c_f32_bf16_e32 v51, s45, v139
    v_dot2c_f32_bf16_e32 v55, v139, v139
    buffer_load_dwordx4 v121, s[8:11], s59 offen offset:3072 lds
    v_add_u32_e32 v121, 0x80, v121
    v_dot2c_f32_bf16_e32 v48, s45, v140
    v_dot2c_f32_bf16_e32 v52, v140, v140
    v_dot2c_f32_bf16_e32 v49, s45, v141
    v_dot2c_f32_bf16_e32 v53, v141, v141
    v_dot2c_f32_bf16_e32 v50, s45, v142
    v_dot2c_f32_bf16_e32 v54, v142, v142
    s_add_u32 m0, s53, 16384
    s_add_u32 s54, s52, 394240
    buffer_load_dwordx4 v5, s[12:15], s54 offen lds
    v_dot2c_f32_bf16_e32 v51, s45, v143
    v_dot2c_f32_bf16_e32 v55, v143, v143
    s_waitcnt lgkmcnt(5)
    v_dot2c_f32_bf16_e32 v56, s45, v112
    s_waitcnt lgkmcnt(3)
    v_dot2c_f32_bf16_e32 v57, s45, v116
    v_dot2c_f32_bf16_e32 v56, s45, v113
    v_dot2c_f32_bf16_e32 v57, s45, v117
    buffer_load_dwordx4 v5, s[12:15], s54 offen offset:1024 lds
    v_dot2c_f32_bf16_e32 v56, s45, v114
    s_waitcnt lgkmcnt(2)
    v_dot2c_f32_bf16_e32 v57, s45, v118
    v_dot2c_f32_bf16_e32 v56, s45, v115
    v_dot2c_f32_bf16_e32 v57, s45, v119
    s_waitcnt vmcnt(6)
    s_barrier
    v_mfma_f32_32x32x16_bf16 v[16:31], v[80:83], v[128:131], 0
    ds_read_b64_tr_b16 v[108:109], v6 offset:7168
    ds_read_b64_tr_b16 v[110:111], v6 offset:7424
    s_waitcnt lgkmcnt(3)
    v_cndmask_b32_e32 v74, 0, v68, vcc
    v_sub_u32_e32 v75, v68, v74
    v_mfma_f32_32x32x16_bf16 v[32:47], v[84:87], v[128:131], 0
    ds_read_b64_tr_b16 v[80:81], v6 offset:8192
    ds_read_b64_tr_b16 v[82:83], v6 offset:8448
    ds_read_b128 v[144:147], v122 offset:4096
    v_accvgpr_write_b32 a240, v74
    s_add_u32 m0, s83, 0
    s_nop 0
    buffer_load_dwordx4 v120, s[8:11], s56 offen lds
    v_mfma_f32_32x32x16_bf16 v[16:31], v[88:91], v[132:135], v[16:31]
    ds_read_b64_tr_b16 v[84:85], v6 offset:9216
    ds_read_b64_tr_b16 v[86:87], v6 offset:9472
    v_accvgpr_write_b32 a244, v75
    ds_read_b128 v[148:151], v123 offset:4096
    v_cndmask_b32_e32 v74, 0, v69, vcc
    buffer_load_dwordx4 v121, s[8:11], s57 offen offset:1024 lds
    v_mfma_f32_32x32x16_bf16 v[32:47], v[92:95], v[132:135], v[32:47]
    ds_read_b64_tr_b16 v[88:89], v6 offset:10240
    ds_read_b64_tr_b16 v[90:91], v6 offset:10496
    ds_read_b128 v[152:155], v124 offset:4096
    ds_read_b128 v[156:159], v125 offset:4096
    v_sub_u32_e32 v75, v69, v74
    v_accvgpr_write_b32 a241, v74
    v_accvgpr_write_b32 a245, v75
    v_mfma_f32_32x32x16_bf16 v[16:31], v[96:99], v[136:139], v[16:31]
    ds_read_b64_tr_b16 v[92:93], v6 offset:11264
    ds_read_b64_tr_b16 v[94:95], v6 offset:11520
    buffer_load_dwordx4 v120, s[8:11], s58 offen offset:2048 lds
    v_add_u32_e32 v120, 0x80, v120
    s_waitcnt lgkmcnt(14)
    v_cndmask_b32_e32 v74, 0, v70, vcc
    ds_read_b64_tr_b16 v[112:113], v126 offset:8192
    v_mfma_f32_32x32x16_bf16 v[32:47], v[100:103], v[136:139], v[32:47]
    ds_read_b64_tr_b16 v[96:97], v6 offset:12288
    ds_read_b64_tr_b16 v[98:99], v6 offset:12544
    v_sub_u32_e32 v75, v70, v74
    buffer_load_dwordx4 v121, s[8:11], s59 offen offset:3072 lds
    v_add_u32_e32 v121, 0x80, v121
    v_accvgpr_write_b32 a242, v74
    v_mfma_f32_32x32x16_bf16 v[16:31], v[104:107], v[140:143], v[16:31]
    ds_read_b64_tr_b16 v[100:101], v6 offset:13312
    ds_read_b64_tr_b16 v[102:103], v6 offset:13568
    ds_read_b64_tr_b16 v[114:115], v126 offset:8448
    v_accvgpr_write_b32 a246, v75
    v_cndmask_b32_e32 v74, 0, v71, vcc
    ds_read_b64_tr_b16 v[116:117], v126 offset:9216
    v_sub_u32_e32 v75, v71, v74
    s_waitcnt lgkmcnt(15)
    v_mfma_f32_32x32x16_bf16 v[32:47], v[108:111], v[140:143], v[32:47]
    ds_read_b64_tr_b16 v[104:105], v6 offset:14336
    ds_read_b64_tr_b16 v[106:107], v6 offset:14592
    s_add_u32 m0, s53, 24576
    s_add_u32 s54, s52, 590848
    buffer_load_dwordx4 v5, s[12:15], s54 offen lds
    buffer_load_dwordx4 v5, s[12:15], s54 offen offset:1024 lds
    ds_read_b64_tr_b16 v[118:119], v126 offset:9472
    v_accvgpr_write_b32 a243, v74
    v_accvgpr_write_b32 a247, v75
    s_waitcnt lgkmcnt(12)
    v_dot2c_f32_bf16_e32 v48, s45, v144
    v_dot2c_f32_bf16_e32 v52, v144, v144
    v_dot2c_f32_bf16_e32 v49, s45, v145
    v_dot2c_f32_bf16_e32 v53, v145, v145
    s_add_u32 m0, s83, 4096
    s_nop 0
    buffer_load_dwordx4 v120, s[8:11], s56 offen lds
    v_dot2c_f32_bf16_e32 v50, s45, v146
    v_dot2c_f32_bf16_e32 v54, v146, v146
    v_dot2c_f32_bf16_e32 v51, s45, v147
    v_dot2c_f32_bf16_e32 v55, v147, v147
    v_dot2c_f32_bf16_e32 v48, s45, v148
    v_dot2c_f32_bf16_e32 v52, v148, v148
    v_dot2c_f32_bf16_e32 v49, s45, v149
    v_dot2c_f32_bf16_e32 v53, v149, v149
    v_dot2c_f32_bf16_e32 v50, s45, v150
    v_dot2c_f32_bf16_e32 v54, v150, v150
    v_dot2c_f32_bf16_e32 v51, s45, v151
    v_dot2c_f32_bf16_e32 v55, v151, v151
    v_dot2c_f32_bf16_e32 v48, s45, v152
    v_dot2c_f32_bf16_e32 v52, v152, v152
    v_dot2c_f32_bf16_e32 v49, s45, v153
    v_dot2c_f32_bf16_e32 v53, v153, v153
    buffer_load_dwordx4 v121, s[8:11], s57 offen offset:1024 lds
    v_dot2c_f32_bf16_e32 v50, s45, v154
    v_dot2c_f32_bf16_e32 v54, v154, v154
    v_dot2c_f32_bf16_e32 v51, s45, v155
    v_dot2c_f32_bf16_e32 v55, v155, v155
    v_dot2c_f32_bf16_e32 v48, s45, v156
    v_dot2c_f32_bf16_e32 v52, v156, v156
    v_dot2c_f32_bf16_e32 v49, s45, v157
    v_dot2c_f32_bf16_e32 v53, v157, v157
    v_dot2c_f32_bf16_e32 v50, s45, v158
    v_dot2c_f32_bf16_e32 v54, v158, v158
    v_dot2c_f32_bf16_e32 v51, s45, v159
    v_dot2c_f32_bf16_e32 v55, v159, v159
    s_waitcnt lgkmcnt(9)
    v_dot2c_f32_bf16_e32 v56, s45, v112
    s_waitcnt lgkmcnt(3)
    v_dot2c_f32_bf16_e32 v57, s45, v116
    v_dot2c_f32_bf16_e32 v56, s45, v113
    v_dot2c_f32_bf16_e32 v57, s45, v117
    buffer_load_dwordx4 v120, s[8:11], s58 offen offset:2048 lds
    v_add_u32_e32 v120, 0x80, v120
    v_dot2c_f32_bf16_e32 v56, s45, v114
    s_waitcnt lgkmcnt(0)
    v_dot2c_f32_bf16_e32 v57, s45, v118
    v_dot2c_f32_bf16_e32 v56, s45, v115
    v_dot2c_f32_bf16_e32 v57, s45, v119
    s_waitcnt vmcnt(9)
    s_barrier
    v_mfma_f32_32x32x16_bf16 v[16:31], v[80:83], v[144:147], v[16:31]
    ds_read_b64_tr_b16 v[108:109], v6 offset:15360
    ds_read_b64_tr_b16 v[110:111], v6 offset:15616
    v_mfma_f32_32x32x16_bf16 v[32:47], v[84:87], v[144:147], v[32:47]
    ds_read_b64_tr_b16 v[80:81], v6 offset:16384
    ds_read_b64_tr_b16 v[82:83], v6 offset:16640
    ds_read_b128 v[160:163], v122 offset:8192
    ds_read_b128 v[164:167], v123 offset:8192
    v_mfma_f32_32x32x16_bf16 v[16:31], v[88:91], v[148:151], v[16:31]
    ds_read_b64_tr_b16 v[84:85], v6 offset:17408
    ds_read_b64_tr_b16 v[86:87], v6 offset:17664
    buffer_load_dwordx4 v121, s[8:11], s59 offen offset:3072 lds
    v_add_u32_e32 v121, 0x80, v121
    ds_read_b128 v[168:171], v124 offset:8192
    v_mfma_f32_32x32x16_bf16 v[32:47], v[92:95], v[148:151], v[32:47]
    ds_read_b64_tr_b16 v[88:89], v6 offset:18432
    ds_read_b64_tr_b16 v[90:91], v6 offset:18688
    ds_read_b128 v[172:175], v125 offset:8192
    v_mfma_f32_32x32x16_bf16 v[16:31], v[96:99], v[152:155], v[16:31]
    ds_read_b64_tr_b16 v[92:93], v6 offset:19456
    ds_read_b64_tr_b16 v[94:95], v6 offset:19712
    ds_read_b64_tr_b16 v[112:113], v126 offset:16384
    s_add_u32 m0, s53, 32768
    s_add_u32 s54, s52, 787456
    buffer_load_dwordx4 v5, s[12:15], s54 offen lds
    v_mfma_f32_32x32x16_bf16 v[32:47], v[100:103], v[152:155], v[32:47]
    ds_read_b64_tr_b16 v[96:97], v6 offset:20480
    ds_read_b64_tr_b16 v[98:99], v6 offset:20736
    ds_read_b64_tr_b16 v[114:115], v126 offset:16640
    v_mfma_f32_32x32x16_bf16 v[16:31], v[104:107], v[156:159], v[16:31]
    ds_read_b64_tr_b16 v[100:101], v6 offset:21504
    ds_read_b64_tr_b16 v[102:103], v6 offset:21760
    ds_read_b64_tr_b16 v[116:117], v126 offset:17408
    s_waitcnt lgkmcnt(15)
    v_mfma_f32_32x32x16_bf16 v[32:47], v[108:111], v[156:159], v[32:47]
    ds_read_b64_tr_b16 v[104:105], v6 offset:22528
    ds_read_b64_tr_b16 v[106:107], v6 offset:22784
    buffer_load_dwordx4 v5, s[12:15], s54 offen offset:1024 lds
    ds_read_b64_tr_b16 v[118:119], v126 offset:17664
    s_waitcnt lgkmcnt(12)
    v_dot2c_f32_bf16_e32 v48, s45, v160
    v_dot2c_f32_bf16_e32 v52, v160, v160
    v_dot2c_f32_bf16_e32 v49, s45, v161
    v_dot2c_f32_bf16_e32 v53, v161, v161
    s_add_u32 m0, s83, 8192
    s_nop 0
    buffer_load_dwordx4 v120, s[8:11], s56 offen lds
    v_dot2c_f32_bf16_e32 v50, s45, v162
    v_dot2c_f32_bf16_e32 v54, v162, v162
    v_dot2c_f32_bf16_e32 v51, s45, v163
    v_dot2c_f32_bf16_e32 v55, v163, v163
    v_dot2c_f32_bf16_e32 v48, s45, v164
    v_dot2c_f32_bf16_e32 v52, v164, v164
    v_dot2c_f32_bf16_e32 v49, s45, v165
    v_dot2c_f32_bf16_e32 v53, v165, v165
    v_dot2c_f32_bf16_e32 v50, s45, v166
    v_dot2c_f32_bf16_e32 v54, v166, v166
    v_dot2c_f32_bf16_e32 v51, s45, v167
    v_dot2c_f32_bf16_e32 v55, v167, v167
    v_dot2c_f32_bf16_e32 v48, s45, v168
    v_dot2c_f32_bf16_e32 v52, v168, v168
    v_dot2c_f32_bf16_e32 v49, s45, v169
    v_dot2c_f32_bf16_e32 v53, v169, v169
    buffer_load_dwordx4 v121, s[8:11], s57 offen offset:1024 lds
    v_dot2c_f32_bf16_e32 v50, s45, v170
    v_dot2c_f32_bf16_e32 v54, v170, v170
    v_dot2c_f32_bf16_e32 v51, s45, v171
    v_dot2c_f32_bf16_e32 v55, v171, v171
    v_dot2c_f32_bf16_e32 v48, s45, v172
    v_dot2c_f32_bf16_e32 v52, v172, v172
    v_dot2c_f32_bf16_e32 v49, s45, v173
    v_dot2c_f32_bf16_e32 v53, v173, v173
    v_dot2c_f32_bf16_e32 v50, s45, v174
    v_dot2c_f32_bf16_e32 v54, v174, v174
    v_dot2c_f32_bf16_e32 v51, s45, v175
    v_dot2c_f32_bf16_e32 v55, v175, v175
    s_waitcnt lgkmcnt(9)
    v_dot2c_f32_bf16_e32 v56, s45, v112
    s_waitcnt lgkmcnt(3)
    v_dot2c_f32_bf16_e32 v57, s45, v116
    v_dot2c_f32_bf16_e32 v56, s45, v113
    v_dot2c_f32_bf16_e32 v57, s45, v117
    buffer_load_dwordx4 v120, s[8:11], s58 offen offset:2048 lds
    v_add_u32_e32 v120, 0x80, v120
    v_dot2c_f32_bf16_e32 v56, s45, v114
    s_waitcnt lgkmcnt(0)
    v_dot2c_f32_bf16_e32 v57, s45, v118
    v_dot2c_f32_bf16_e32 v56, s45, v115
    v_dot2c_f32_bf16_e32 v57, s45, v119
    s_waitcnt vmcnt(9)
    s_barrier
    v_mfma_f32_32x32x16_bf16 v[16:31], v[80:83], v[160:163], v[16:31]
    ds_read_b64_tr_b16 v[108:109], v6 offset:23552
    ds_read_b64_tr_b16 v[110:111], v6 offset:23808
    v_mfma_f32_32x32x16_bf16 v[32:47], v[84:87], v[160:163], v[32:47]
    ds_read_b64_tr_b16 v[80:81], v6 offset:24576
    ds_read_b64_tr_b16 v[82:83], v6 offset:24832
    ds_read_b128 v[176:179], v122 offset:0
    ds_read_b128 v[180:183], v123 offset:0
    v_mfma_f32_32x32x16_bf16 v[16:31], v[88:91], v[164:167], v[16:31]
    ds_read_b64_tr_b16 v[84:85], v6 offset:25600
    ds_read_b64_tr_b16 v[86:87], v6 offset:25856
    buffer_load_dwordx4 v121, s[8:11], s59 offen offset:3072 lds
    v_add_u32_e32 v121, 0x80, v121
    ds_read_b128 v[184:187], v124 offset:0
    v_mfma_f32_32x32x16_bf16 v[32:47], v[92:95], v[164:167], v[32:47]
    ds_read_b64_tr_b16 v[88:89], v6 offset:26624
    ds_read_b64_tr_b16 v[90:91], v6 offset:26880
    ds_read_b128 v[188:191], v125 offset:0
    v_mfma_f32_32x32x16_bf16 v[16:31], v[96:99], v[168:171], v[16:31]
    ds_read_b64_tr_b16 v[92:93], v6 offset:27648
    ds_read_b64_tr_b16 v[94:95], v6 offset:27904
    ds_read_b64_tr_b16 v[112:113], v126 offset:24576
    s_add_u32 m0, s53, 40960
    s_add_u32 s54, s52, 984064
    buffer_load_dwordx4 v5, s[12:15], s54 offen lds
    v_mfma_f32_32x32x16_bf16 v[32:47], v[100:103], v[168:171], v[32:47]
    ds_read_b64_tr_b16 v[96:97], v6 offset:28672
    ds_read_b64_tr_b16 v[98:99], v6 offset:28928
    ds_read_b64_tr_b16 v[114:115], v126 offset:24832
    v_mfma_f32_32x32x16_bf16 v[16:31], v[104:107], v[172:175], v[16:31]
    ds_read_b64_tr_b16 v[100:101], v6 offset:29696
    ds_read_b64_tr_b16 v[102:103], v6 offset:29952
    ds_read_b64_tr_b16 v[116:117], v126 offset:25600
    s_waitcnt lgkmcnt(15)
    v_mfma_f32_32x32x16_bf16 v[32:47], v[108:111], v[172:175], v[32:47]
    ds_read_b64_tr_b16 v[104:105], v6 offset:30720
    ds_read_b64_tr_b16 v[106:107], v6 offset:30976
    buffer_load_dwordx4 v5, s[12:15], s54 offen offset:1024 lds
    ds_read_b64_tr_b16 v[118:119], v126 offset:25856
    s_waitcnt lgkmcnt(12)
    v_dot2c_f32_bf16_e32 v48, s45, v176
    v_dot2c_f32_bf16_e32 v52, v176, v176
    v_dot2c_f32_bf16_e32 v49, s45, v177
    v_dot2c_f32_bf16_e32 v53, v177, v177
    s_add_u32 m0, s83, 0
    s_nop 0
    buffer_load_dwordx4 v120, s[8:11], s56 offen lds
    v_dot2c_f32_bf16_e32 v50, s45, v178
    v_dot2c_f32_bf16_e32 v54, v178, v178
    v_dot2c_f32_bf16_e32 v51, s45, v179
    v_dot2c_f32_bf16_e32 v55, v179, v179
    v_dot2c_f32_bf16_e32 v48, s45, v180
    v_dot2c_f32_bf16_e32 v52, v180, v180
    v_dot2c_f32_bf16_e32 v49, s45, v181
    v_dot2c_f32_bf16_e32 v53, v181, v181
    v_dot2c_f32_bf16_e32 v50, s45, v182
    v_dot2c_f32_bf16_e32 v54, v182, v182
    v_dot2c_f32_bf16_e32 v51, s45, v183
    v_dot2c_f32_bf16_e32 v55, v183, v183
    v_dot2c_f32_bf16_e32 v48, s45, v184
    v_dot2c_f32_bf16_e32 v52, v184, v184
    v_dot2c_f32_bf16_e32 v49, s45, v185
    v_dot2c_f32_bf16_e32 v53, v185, v185
    buffer_load_dwordx4 v121, s[8:11], s57 offen offset:1024 lds
    v_dot2c_f32_bf16_e32 v50, s45, v186
    v_dot2c_f32_bf16_e32 v54, v186, v186
    v_dot2c_f32_bf16_e32 v51, s45, v187
    v_dot2c_f32_bf16_e32 v55, v187, v187
    v_dot2c_f32_bf16_e32 v48, s45, v188
    v_dot2c_f32_bf16_e32 v52, v188, v188
    v_dot2c_f32_bf16_e32 v49, s45, v189
    v_dot2c_f32_bf16_e32 v53, v189, v189
    v_dot2c_f32_bf16_e32 v50, s45, v190
    v_dot2c_f32_bf16_e32 v54, v190, v190
    v_dot2c_f32_bf16_e32 v51, s45, v191
    v_dot2c_f32_bf16_e32 v55, v191, v191
    s_waitcnt lgkmcnt(9)
    v_dot2c_f32_bf16_e32 v56, s45, v112
    s_waitcnt lgkmcnt(3)
    v_dot2c_f32_bf16_e32 v57, s45, v116
    v_dot2c_f32_bf16_e32 v56, s45, v113
    v_dot2c_f32_bf16_e32 v57, s45, v117
    buffer_load_dwordx4 v120, s[8:11], s58 offen offset:2048 lds
    v_add_u32_e32 v120, 0x80, v120
    v_dot2c_f32_bf16_e32 v56, s45, v114
    s_waitcnt lgkmcnt(0)
    v_dot2c_f32_bf16_e32 v57, s45, v118
    v_dot2c_f32_bf16_e32 v56, s45, v115
    v_dot2c_f32_bf16_e32 v57, s45, v119
    s_waitcnt vmcnt(9)
    s_barrier
    v_mfma_f32_32x32x16_bf16 v[16:31], v[80:83], v[176:179], v[16:31]
    ds_read_b64_tr_b16 v[108:109], v6 offset:31744
    ds_read_b64_tr_b16 v[110:111], v6 offset:32000
    v_mfma_f32_32x32x16_bf16 v[32:47], v[84:87], v[176:179], v[32:47]
    ds_read_b64_tr_b16 v[80:81], v6 offset:32768
    ds_read_b64_tr_b16 v[82:83], v6 offset:33024
    ds_read_b128 v[192:195], v122 offset:4096
    ds_read_b128 v[196:199], v123 offset:4096
    v_mfma_f32_32x32x16_bf16 v[16:31], v[88:91], v[180:183], v[16:31]
    ds_read_b64_tr_b16 v[84:85], v6 offset:33792
    ds_read_b64_tr_b16 v[86:87], v6 offset:34048
    buffer_load_dwordx4 v121, s[8:11], s59 offen offset:3072 lds
    v_add_u32_e32 v121, 0x80, v121
    ds_read_b128 v[200:203], v124 offset:4096
    v_mfma_f32_32x32x16_bf16 v[32:47], v[92:95], v[180:183], v[32:47]
    ds_read_b64_tr_b16 v[88:89], v6 offset:34816
    ds_read_b64_tr_b16 v[90:91], v6 offset:35072
    ds_read_b128 v[204:207], v125 offset:4096
    v_mfma_f32_32x32x16_bf16 v[16:31], v[96:99], v[184:187], v[16:31]
    ds_read_b64_tr_b16 v[92:93], v6 offset:35840
    ds_read_b64_tr_b16 v[94:95], v6 offset:36096
    ds_read_b64_tr_b16 v[112:113], v126 offset:32768
    s_add_u32 m0, s53, 49152
    s_add_u32 s54, s52, 1180672
    buffer_load_dwordx4 v5, s[12:15], s54 offen lds
    v_mfma_f32_32x32x16_bf16 v[32:47], v[100:103], v[184:187], v[32:47]
    ds_read_b64_tr_b16 v[96:97], v6 offset:36864
    ds_read_b64_tr_b16 v[98:99], v6 offset:37120
    ds_read_b64_tr_b16 v[114:115], v126 offset:33024
    v_mfma_f32_32x32x16_bf16 v[16:31], v[104:107], v[188:191], v[16:31]
    ds_read_b64_tr_b16 v[100:101], v6 offset:37888
    ds_read_b64_tr_b16 v[102:103], v6 offset:38144
    ds_read_b64_tr_b16 v[116:117], v126 offset:33792
    s_waitcnt lgkmcnt(15)
    v_mfma_f32_32x32x16_bf16 v[32:47], v[108:111], v[188:191], v[32:47]
    ds_read_b64_tr_b16 v[104:105], v6 offset:38912
    ds_read_b64_tr_b16 v[106:107], v6 offset:39168
    buffer_load_dwordx4 v5, s[12:15], s54 offen offset:1024 lds
    ds_read_b64_tr_b16 v[118:119], v126 offset:34048
    s_waitcnt lgkmcnt(12)
    v_dot2c_f32_bf16_e32 v48, s45, v192
    v_dot2c_f32_bf16_e32 v52, v192, v192
    v_dot2c_f32_bf16_e32 v49, s45, v193
    v_dot2c_f32_bf16_e32 v53, v193, v193
    s_add_u32 m0, s83, 4096
    s_nop 0
    buffer_load_dwordx4 v120, s[8:11], s56 offen lds
    v_dot2c_f32_bf16_e32 v50, s45, v194
    v_dot2c_f32_bf16_e32 v54, v194, v194
    v_dot2c_f32_bf16_e32 v51, s45, v195
    v_dot2c_f32_bf16_e32 v55, v195, v195
    v_dot2c_f32_bf16_e32 v48, s45, v196
    v_dot2c_f32_bf16_e32 v52, v196, v196
    v_dot2c_f32_bf16_e32 v49, s45, v197
    v_dot2c_f32_bf16_e32 v53, v197, v197
    v_dot2c_f32_bf16_e32 v50, s45, v198
    v_dot2c_f32_bf16_e32 v54, v198, v198
    v_dot2c_f32_bf16_e32 v51, s45, v199
    v_dot2c_f32_bf16_e32 v55, v199, v199
    v_dot2c_f32_bf16_e32 v48, s45, v200
    v_dot2c_f32_bf16_e32 v52, v200, v200
    v_dot2c_f32_bf16_e32 v49, s45, v201
    v_dot2c_f32_bf16_e32 v53, v201, v201
    buffer_load_dwordx4 v121, s[8:11], s57 offen offset:1024 lds
    v_dot2c_f32_bf16_e32 v50, s45, v202
    v_dot2c_f32_bf16_e32 v54, v202, v202
    v_dot2c_f32_bf16_e32 v51, s45, v203
    v_dot2c_f32_bf16_e32 v55, v203, v203
    v_dot2c_f32_bf16_e32 v48, s45, v204
    v_dot2c_f32_bf16_e32 v52, v204, v204
    v_dot2c_f32_bf16_e32 v49, s45, v205
    v_dot2c_f32_bf16_e32 v53, v205, v205
    v_dot2c_f32_bf16_e32 v50, s45, v206
    v_dot2c_f32_bf16_e32 v54, v206, v206
    v_dot2c_f32_bf16_e32 v51, s45, v207
    v_dot2c_f32_bf16_e32 v55, v207, v207
    s_waitcnt lgkmcnt(9)
    v_dot2c_f32_bf16_e32 v56, s45, v112
    s_waitcnt lgkmcnt(3)
    v_dot2c_f32_bf16_e32 v57, s45, v116
    v_dot2c_f32_bf16_e32 v56, s45, v113
    v_dot2c_f32_bf16_e32 v57, s45, v117
    buffer_load_dwordx4 v120, s[8:11], s58 offen offset:2048 lds
    v_dot2c_f32_bf16_e32 v56, s45, v114
    s_waitcnt lgkmcnt(0)
    v_dot2c_f32_bf16_e32 v57, s45, v118
    v_dot2c_f32_bf16_e32 v56, s45, v115
    v_dot2c_f32_bf16_e32 v57, s45, v119
    s_waitcnt vmcnt(9)
    s_barrier
    v_mfma_f32_32x32x16_bf16 v[16:31], v[80:83], v[192:195], v[16:31]
    ds_read_b64_tr_b16 v[108:109], v6 offset:39936
    ds_read_b64_tr_b16 v[110:111], v6 offset:40192
    v_mfma_f32_32x32x16_bf16 v[32:47], v[84:87], v[192:195], v[32:47]
    ds_read_b64_tr_b16 v[80:81], v6 offset:40960
    ds_read_b64_tr_b16 v[82:83], v6 offset:41216
    ds_read_b128 v[208:211], v122 offset:8192
    buffer_load_dwordx4 v121, s[8:11], s59 offen offset:3072 lds
    ds_read_b128 v[212:215], v123 offset:8192
    v_mfma_f32_32x32x16_bf16 v[16:31], v[88:91], v[196:199], v[16:31]
    ds_read_b64_tr_b16 v[84:85], v6 offset:41984
    ds_read_b64_tr_b16 v[86:87], v6 offset:42240
    ds_read_b128 v[216:219], v124 offset:8192
    v_mfma_f32_32x32x16_bf16 v[32:47], v[92:95], v[196:199], v[32:47]
    ds_read_b64_tr_b16 v[88:89], v6 offset:43008
    ds_read_b64_tr_b16 v[90:91], v6 offset:43264
    ds_read_b128 v[220:223], v125 offset:8192
    v_mfma_f32_32x32x16_bf16 v[16:31], v[96:99], v[200:203], v[16:31]
    ds_read_b64_tr_b16 v[92:93], v6 offset:44032
    ds_read_b64_tr_b16 v[94:95], v6 offset:44288
    ds_read_b64_tr_b16 v[112:113], v126 offset:40960
    s_add_u32 m0, s53, 57344
    s_add_u32 s54, s52, 1377280
    buffer_load_dwordx4 v5, s[12:15], s54 offen lds
    v_mfma_f32_32x32x16_bf16 v[32:47], v[100:103], v[200:203], v[32:47]
    ds_read_b64_tr_b16 v[96:97], v6 offset:45056
    ds_read_b64_tr_b16 v[98:99], v6 offset:45312
    ds_read_b64_tr_b16 v[114:115], v126 offset:41216
    v_mfma_f32_32x32x16_bf16 v[16:31], v[104:107], v[204:207], v[16:31]
    ds_read_b64_tr_b16 v[100:101], v6 offset:46080
    ds_read_b64_tr_b16 v[102:103], v6 offset:46336
    ds_read_b64_tr_b16 v[116:117], v126 offset:41984
    s_waitcnt lgkmcnt(15)
    v_mfma_f32_32x32x16_bf16 v[32:47], v[108:111], v[204:207], v[32:47]
    ds_read_b64_tr_b16 v[104:105], v6 offset:47104
    ds_read_b64_tr_b16 v[106:107], v6 offset:47360
    buffer_load_dwordx4 v5, s[12:15], s54 offen offset:1024 lds
    ds_read_b64_tr_b16 v[118:119], v126 offset:42240
    s_waitcnt lgkmcnt(12)
    v_dot2c_f32_bf16_e32 v48, s45, v208
    v_dot2c_f32_bf16_e32 v52, v208, v208
    v_dot2c_f32_bf16_e32 v49, s45, v209
    v_dot2c_f32_bf16_e32 v53, v209, v209
    s_add_u32 m0, s48, 65536
    s_add_u32 s54, s52, 0
    buffer_load_dwordx4 v5, s[12:15], s54 offen lds
    v_dot2c_f32_bf16_e32 v50, s45, v210
    v_dot2c_f32_bf16_e32 v54, v210, v210
    v_dot2c_f32_bf16_e32 v51, s45, v211
    v_dot2c_f32_bf16_e32 v55, v211, v211
    v_dot2c_f32_bf16_e32 v48, s45, v212
    v_dot2c_f32_bf16_e32 v52, v212, v212
    v_dot2c_f32_bf16_e32 v49, s45, v213
    v_dot2c_f32_bf16_e32 v53, v213, v213
    v_dot2c_f32_bf16_e32 v50, s45, v214
    v_dot2c_f32_bf16_e32 v54, v214, v214
    v_dot2c_f32_bf16_e32 v51, s45, v215
    v_dot2c_f32_bf16_e32 v55, v215, v215
    v_dot2c_f32_bf16_e32 v48, s45, v216
    v_dot2c_f32_bf16_e32 v52, v216, v216
    v_dot2c_f32_bf16_e32 v49, s45, v217
    v_dot2c_f32_bf16_e32 v53, v217, v217
    s_add_u32 m0, s48, 69632
    s_add_u32 s54, s52, 196608
    buffer_load_dwordx4 v5, s[12:15], s54 offen lds
    v_dot2c_f32_bf16_e32 v50, s45, v218
    v_dot2c_f32_bf16_e32 v54, v218, v218
    v_dot2c_f32_bf16_e32 v51, s45, v219
    v_dot2c_f32_bf16_e32 v55, v219, v219
    v_dot2c_f32_bf16_e32 v48, s45, v220
    v_dot2c_f32_bf16_e32 v52, v220, v220
    v_dot2c_f32_bf16_e32 v49, s45, v221
    v_dot2c_f32_bf16_e32 v53, v221, v221
    v_dot2c_f32_bf16_e32 v50, s45, v222
    v_dot2c_f32_bf16_e32 v54, v222, v222
    v_dot2c_f32_bf16_e32 v51, s45, v223
    v_dot2c_f32_bf16_e32 v55, v223, v223
    s_waitcnt lgkmcnt(9)
    v_dot2c_f32_bf16_e32 v56, s45, v112
    s_waitcnt lgkmcnt(3)
    v_dot2c_f32_bf16_e32 v57, s45, v116
    v_dot2c_f32_bf16_e32 v56, s45, v113
    v_dot2c_f32_bf16_e32 v57, s45, v117
    s_add_u32 m0, s48, 73728
    s_add_u32 s54, s52, 393216
    buffer_load_dwordx4 v5, s[12:15], s54 offen lds
    v_dot2c_f32_bf16_e32 v56, s45, v114
    s_waitcnt lgkmcnt(0)
    v_dot2c_f32_bf16_e32 v57, s45, v118
    v_dot2c_f32_bf16_e32 v56, s45, v115
    v_dot2c_f32_bf16_e32 v57, s45, v119
    s_waitcnt vmcnt(9)
    s_barrier
    v_mfma_f32_32x32x16_bf16 v[16:31], v[80:83], v[208:211], v[16:31]
    ds_read_b64_tr_b16 v[108:109], v6 offset:48128
    ds_read_b64_tr_b16 v[110:111], v6 offset:48384
    v_mfma_f32_32x32x16_bf16 v[32:47], v[84:87], v[208:211], v[32:47]
    ds_read_b64_tr_b16 v[80:81], v6 offset:49152
    ds_read_b64_tr_b16 v[82:83], v6 offset:49408
    ds_read_b128 v[224:227], v122 offset:0
    s_add_u32 m0, s48, 77824
    s_add_u32 s54, s52, 589824
    buffer_load_dwordx4 v5, s[12:15], s54 offen lds
    v_mfma_f32_32x32x16_bf16 v[16:31], v[88:91], v[212:215], v[16:31]
    ds_read_b64_tr_b16 v[84:85], v6 offset:50176
    ds_read_b64_tr_b16 v[86:87], v6 offset:50432
    ds_read_b128 v[228:231], v123 offset:0
    ds_read_b128 v[232:235], v124 offset:0
    v_mfma_f32_32x32x16_bf16 v[32:47], v[92:95], v[212:215], v[32:47]
    ds_read_b64_tr_b16 v[88:89], v6 offset:51200
    ds_read_b64_tr_b16 v[90:91], v6 offset:51456
    ds_read_b128 v[236:239], v125 offset:0
    s_add_u32 m0, s48, 81920
    s_add_u32 s54, s52, 786432
    buffer_load_dwordx4 v5, s[12:15], s54 offen lds
    v_mfma_f32_32x32x16_bf16 v[16:31], v[96:99], v[216:219], v[16:31]
    ds_read_b64_tr_b16 v[92:93], v6 offset:52224
    ds_read_b64_tr_b16 v[94:95], v6 offset:52480
    ds_read_b64_tr_b16 v[112:113], v126 offset:49152
    v_mfma_f32_32x32x16_bf16 v[32:47], v[100:103], v[216:219], v[32:47]
    ds_read_b64_tr_b16 v[96:97], v6 offset:53248
    ds_read_b64_tr_b16 v[98:99], v6 offset:53504
    s_add_u32 m0, s48, 86016
    s_add_u32 s54, s52, 983040
    buffer_load_dwordx4 v5, s[12:15], s54 offen lds
    ds_read_b64_tr_b16 v[114:115], v126 offset:49408
    v_mfma_f32_32x32x16_bf16 v[16:31], v[104:107], v[220:223], v[16:31]
    ds_read_b64_tr_b16 v[100:101], v6 offset:54272
    ds_read_b64_tr_b16 v[102:103], v6 offset:54528
    ds_read_b64_tr_b16 v[116:117], v126 offset:50176
    s_waitcnt lgkmcnt(15)
    v_mfma_f32_32x32x16_bf16 v[32:47], v[108:111], v[220:223], v[32:47]
    ds_read_b64_tr_b16 v[104:105], v6 offset:55296
    ds_read_b64_tr_b16 v[106:107], v6 offset:55552
    s_add_u32 m0, s48, 90112
    s_add_u32 s54, s52, 1179648
    buffer_load_dwordx4 v5, s[12:15], s54 offen lds
    ds_read_b64_tr_b16 v[118:119], v126 offset:50432
    s_waitcnt lgkmcnt(12)
    v_dot2c_f32_bf16_e32 v48, s45, v224
    v_dot2c_f32_bf16_e32 v52, v224, v224
    v_dot2c_f32_bf16_e32 v49, s45, v225
    v_dot2c_f32_bf16_e32 v53, v225, v225
    s_add_u32 m0, s48, 94208
    s_add_u32 s54, s52, 1376256
    buffer_load_dwordx4 v5, s[12:15], s54 offen lds
    v_dot2c_f32_bf16_e32 v50, s45, v226
    v_dot2c_f32_bf16_e32 v54, v226, v226
    v_dot2c_f32_bf16_e32 v51, s45, v227
    v_dot2c_f32_bf16_e32 v55, v227, v227
    v_dot2c_f32_bf16_e32 v48, s45, v228
    v_dot2c_f32_bf16_e32 v52, v228, v228
    v_dot2c_f32_bf16_e32 v49, s45, v229
    v_dot2c_f32_bf16_e32 v53, v229, v229
    v_dot2c_f32_bf16_e32 v50, s45, v230
    v_dot2c_f32_bf16_e32 v54, v230, v230
    v_dot2c_f32_bf16_e32 v51, s45, v231
    v_dot2c_f32_bf16_e32 v55, v231, v231
    v_dot2c_f32_bf16_e32 v48, s45, v232
    v_dot2c_f32_bf16_e32 v52, v232, v232
    v_dot2c_f32_bf16_e32 v49, s45, v233
    v_dot2c_f32_bf16_e32 v53, v233, v233
    s_lshr_b32 s50, s39, 3
    s_lshl_b32 s88, s38, 1
    s_add_u32 s88, s88, s50
    s_lshl_b32 s88, s88, 2
    s_add_u32 s88, s88, s37
    s_min_u32 s51, s88, 111
    s_cmp_ge_u32 s51, 56
    s_cselect_b32 s89, 1, 0
    s_mul_i32 s50, s89, 56
    s_sub_u32 s51, s51, s50
    s_and_b32 s50, s51, 7
    s_lshl_b32 s89, s89, 3
    s_add_u32 s50, s50, s89
    s_mul_i32 s50, s50, 112
    s_lshr_b32 s51, s51, 3
    s_lshl_b32 s51, s51, 4
    s_add_u32 s50, s50, s51
    s_lshl_b32 s50, s50, 10
    s_lshl_b32 s51, s40, 7
    s_add_u32 s54, s50, s51
    s_add_u32 m0, s53, 147456
    s_nop 0
    buffer_load_dwordx4 v73, s[20:23], s54 offen nt lds
    v_dot2c_f32_bf16_e32 v50, s45, v234
    v_dot2c_f32_bf16_e32 v54, v234, v234
    v_dot2c_f32_bf16_e32 v51, s45, v235
    v_dot2c_f32_bf16_e32 v55, v235, v235
    v_dot2c_f32_bf16_e32 v48, s45, v236
    v_dot2c_f32_bf16_e32 v52, v236, v236
    v_dot2c_f32_bf16_e32 v49, s45, v237
    v_dot2c_f32_bf16_e32 v53, v237, v237
    v_dot2c_f32_bf16_e32 v50, s45, v238
    v_dot2c_f32_bf16_e32 v54, v238, v238
    v_dot2c_f32_bf16_e32 v51, s45, v239
    v_dot2c_f32_bf16_e32 v55, v239, v239
    s_waitcnt lgkmcnt(9)
    v_dot2c_f32_bf16_e32 v56, s45, v112
    s_waitcnt lgkmcnt(3)
    v_dot2c_f32_bf16_e32 v57, s45, v116
    v_dot2c_f32_bf16_e32 v56, s45, v113
    v_dot2c_f32_bf16_e32 v57, s45, v117
    s_add_u32 s54, s54, 7168
    buffer_load_dwordx4 v73, s[20:23], s54 offen offset:1024 nt lds
    v_dot2c_f32_bf16_e32 v56, s45, v114
    s_waitcnt lgkmcnt(0)
    v_dot2c_f32_bf16_e32 v57, s45, v118
    v_dot2c_f32_bf16_e32 v56, s45, v115
    v_dot2c_f32_bf16_e32 v57, s45, v119
    s_waitcnt vmcnt(10)
    s_barrier
    v_mfma_f32_32x32x16_bf16 v[16:31], v[80:83], v[224:227], v[16:31]
    ds_read_b64_tr_b16 v[108:109], v6 offset:56320
    ds_read_b64_tr_b16 v[110:111], v6 offset:56576
    v_mfma_f32_32x32x16_bf16 v[32:47], v[84:87], v[224:227], v[32:47]
    ds_read_b64_tr_b16 v[80:81], v6 offset:57344
    ds_read_b64_tr_b16 v[82:83], v6 offset:57600
    ds_read_b128 v[240:243], v122 offset:4096
    ds_read_b128 v[244:247], v123 offset:4096
    v_mfma_f32_32x32x16_bf16 v[16:31], v[88:91], v[228:231], v[16:31]
    ds_read_b64_tr_b16 v[84:85], v6 offset:58368
    ds_read_b64_tr_b16 v[86:87], v6 offset:58624
    ds_read_b128 v[248:251], v124 offset:4096
    v_mfma_f32_32x32x16_bf16 v[32:47], v[92:95], v[228:231], v[32:47]
    ds_read_b64_tr_b16 v[88:89], v6 offset:59392
    ds_read_b64_tr_b16 v[90:91], v6 offset:59648
    ds_read_b128 v[252:255], v125 offset:4096
    v_mfma_f32_32x32x16_bf16 v[16:31], v[96:99], v[232:235], v[16:31]
    ds_read_b64_tr_b16 v[92:93], v6 offset:60416
    ds_read_b64_tr_b16 v[94:95], v6 offset:60672
    s_lshl_b32 s50, s38, 1
    s_add_u32 s50, s50, s47
    s_mul_i32 s50, s50, 57344
    s_mul_i32 s51, s39, 224
    s_add_u32 s54, s50, s51
    s_lshl_b32 s51, s46, 7
    s_add_u32 s51, s51, s83
    s_add_u32 m0, s51, 8192
    s_nop 0
    buffer_load_dwordx4 v76, s[24:27], s54 offen nt lds
    v_mfma_f32_32x32x16_bf16 v[32:47], v[100:103], v[232:235], v[32:47]
    ds_read_b64_tr_b16 v[96:97], v6 offset:61440
    ds_read_b64_tr_b16 v[98:99], v6 offset:61696
    ds_read_b64_tr_b16 v[112:113], v126 offset:57344
    buffer_load_dwordx4 v77, s[24:27], s54 offen offset:1024 nt lds
    ds_read_b64_tr_b16 v[114:115], v126 offset:57600
    v_mfma_f32_32x32x16_bf16 v[16:31], v[104:107], v[236:239], v[16:31]
    ds_read_b64_tr_b16 v[100:101], v6 offset:62464
    ds_read_b64_tr_b16 v[102:103], v6 offset:62720
    buffer_load_dwordx4 v78, s[24:27], s54 offen offset:2048 nt lds
    ds_read_b64_tr_b16 v[116:117], v126 offset:58368
    s_waitcnt lgkmcnt(15)
    v_mfma_f32_32x32x16_bf16 v[32:47], v[108:111], v[236:239], v[32:47]
    ds_read_b64_tr_b16 v[104:105], v6 offset:63488
    ds_read_b64_tr_b16 v[106:107], v6 offset:63744
    s_mov_b32 exec_hi, 0
    buffer_load_dwordx4 v79, s[24:27], s54 offen offset:3072 nt lds
    s_mov_b32 exec_hi, -1
    ds_read_b64_tr_b16 v[118:119], v126 offset:58624
    s_waitcnt lgkmcnt(12)
    v_dot2c_f32_bf16_e32 v48, s45, v240
    v_dot2c_f32_bf16_e32 v52, v240, v240
    v_dot2c_f32_bf16_e32 v49, s45, v241
    v_dot2c_f32_bf16_e32 v53, v241, v241
    v_dot2c_f32_bf16_e32 v50, s45, v242
    v_dot2c_f32_bf16_e32 v54, v242, v242
    v_dot2c_f32_bf16_e32 v51, s45, v243
    v_dot2c_f32_bf16_e32 v55, v243, v243
    v_dot2c_f32_bf16_e32 v48, s45, v244
    v_dot2c_f32_bf16_e32 v52, v244, v244
    v_dot2c_f32_bf16_e32 v49, s45, v245
    v_dot2c_f32_bf16_e32 v53, v245, v245
    v_dot2c_f32_bf16_e32 v50, s45, v246
    v_dot2c_f32_bf16_e32 v54, v246, v246
    v_dot2c_f32_bf16_e32 v51, s45, v247
    v_dot2c_f32_bf16_e32 v55, v247, v247
    v_dot2c_f32_bf16_e32 v48, s45, v248
    v_dot2c_f32_bf16_e32 v52, v248, v248
    v_dot2c_f32_bf16_e32 v49, s45, v249
    v_dot2c_f32_bf16_e32 v53, v249, v249
    v_dot2c_f32_bf16_e32 v50, s45, v250
    v_dot2c_f32_bf16_e32 v54, v250, v250
    v_dot2c_f32_bf16_e32 v51, s45, v251
    v_dot2c_f32_bf16_e32 v55, v251, v251
    v_dot2c_f32_bf16_e32 v48, s45, v252
    v_dot2c_f32_bf16_e32 v52, v252, v252
    v_dot2c_f32_bf16_e32 v49, s45, v253
    v_dot2c_f32_bf16_e32 v53, v253, v253
    v_dot2c_f32_bf16_e32 v50, s45, v254
    v_dot2c_f32_bf16_e32 v54, v254, v254
    v_dot2c_f32_bf16_e32 v51, s45, v255
    v_dot2c_f32_bf16_e32 v55, v255, v255
    s_waitcnt lgkmcnt(7)
    v_dot2c_f32_bf16_e32 v56, s45, v112
    s_waitcnt lgkmcnt(3)
    v_dot2c_f32_bf16_e32 v57, s45, v116
    v_dot2c_f32_bf16_e32 v56, s45, v113
    v_dot2c_f32_bf16_e32 v57, s45, v117
    v_dot2c_f32_bf16_e32 v56, s45, v114
    s_waitcnt lgkmcnt(0)
    v_dot2c_f32_bf16_e32 v57, s45, v118
    v_dot2c_f32_bf16_e32 v56, s45, v115
    v_dot2c_f32_bf16_e32 v57, s45, v119
    v_mfma_f32_32x32x16_bf16 v[16:31], v[80:83], v[240:243], v[16:31]
    ds_read_b64_tr_b16 v[108:109], v6 offset:64512
    ds_read_b64_tr_b16 v[110:111], v6 offset:64768
    ds_write_b32 v66, v56
    ds_write_b32 v66, v57 offset:1024
    ds_read_b64_tr_b16 a[220:221], v72 offset:0
    ds_read_b64_tr_b16 a[222:223], v72 offset:512
    v_mfma_f32_32x32x16_bf16 v[32:47], v[84:87], v[240:243], v[32:47]
    v_add_f32_e32 v48, v48, v49
    v_add_f32_e32 v50, v50, v51
    v_add_f32_e32 v52, v52, v53
    v_add_f32_e32 v54, v54, v55
    v_mfma_f32_32x32x16_bf16 v[16:31], v[88:91], v[244:247], v[16:31]
    v_add_f32_e32 v48, v48, v50
    v_add_f32_e32 v52, v52, v54
    s_nop 1
    v_permlane32_swap_b32_e32 v48, v52
    v_mfma_f32_32x32x16_bf16 v[32:47], v[92:95], v[244:247], v[32:47]
    v_add_f32_e32 v48, v48, v52
    v_mov_b32_e32 v52, v48
    s_nop 1
    v_permlane32_swap_b32_e32 v48, v52
    v_mfma_f32_32x32x16_bf16 v[16:31], v[96:99], v[248:251], v[16:31]
    v_mul_f32_e32 v49, 0x3b000000, v48
    v_mul_f32_e32 v50, v49, v49
    v_mul_f32_e32 v52, 0x3b000000, v52
    v_mfma_f32_32x32x16_bf16 v[32:47], v[100:103], v[248:251], v[32:47]
    v_sub_f32_e32 v52, v52, v50
    v_max_f32_e32 v52, 0, v52
    v_add_f32_e32 v52, 0x3727c5ac, v52
    v_rsq_f32_e32 v8, v52
    v_mfma_f32_32x32x16_bf16 v[16:31], v[104:107], v[252:255], v[16:31]
    v_mul_f32_e32 v49, v11, v48
    v_cvt_pk_bf16_f32 v13, v49, 0
    v_mul_f32_e32 v10, v52, v8
    s_waitcnt lgkmcnt(4)
    v_mfma_f32_32x32x16_bf16 v[32:47], v[108:111], v[252:255], v[32:47]
    v_mul_f32_e32 v9, 0x3fb8aa3b, v8
    v_lshlrev_b32_e32 v50, 16, v13
    v_sub_f32_e32 v50, v49, v50
    v_cvt_pk_bf16_f32 v12, v49, v50
    s_waitcnt lgkmcnt(0)
    s_barrier
    ds_read_b128 v[80:83], v65 offset:0
    ds_read_b128 v[84:87], v65 offset:16
    ds_read_b128 v[88:91], v65 offset:1024
    ds_read_b128 v[92:95], v65 offset:1040
    s_waitcnt lgkmcnt(3)
    v_pk_add_f32 v[80:81], v[80:81], v[82:83]
    s_waitcnt lgkmcnt(2)
    v_pk_add_f32 v[84:85], v[84:85], v[86:87]
    v_pk_add_f32 v[80:81], v[80:81], v[84:85]
    v_add_f32_e32 v80, v80, v81
    v_cvt_pk_bf16_f32 v82, v80, v80
    v_and_b32_e32 v81, 0xffff0000, v82
    v_sub_f32_e32 v81, v80, v81
    v_cvt_pk_bf16_f32 v83, v81, 0
    v_accvgpr_write_b32 a248, v82
    v_accvgpr_write_b32 a249, v83
    s_waitcnt lgkmcnt(1)
    v_pk_add_f32 v[88:89], v[88:89], v[90:91]
    s_waitcnt lgkmcnt(0)
    v_pk_add_f32 v[92:93], v[92:93], v[94:95]
    v_pk_add_f32 v[88:89], v[88:89], v[92:93]
    v_add_f32_e32 v88, v88, v89
    v_cvt_pk_bf16_f32 v90, v88, v88
    v_and_b32_e32 v89, 0xffff0000, v90
    v_sub_f32_e32 v89, v88, v89
    v_cvt_pk_bf16_f32 v91, v89, 0
    v_accvgpr_write_b32 a250, v90
    v_accvgpr_write_b32 a251, v91
    v_mfma_f32_32x32x8_bf16 v[16:31], a[248:249], v[12:13], v[16:31]
    s_nop 0
    v_mfma_f32_32x32x8_bf16 v[32:47], a[250:251], v[12:13], v[32:47]
    v_lshrrev_b32_e32 v121, 5, v0
    v_lshlrev_b32_e32 v121, 7, v121
    v_xor_b32_e32 v120, v121, v1
    s_add_u32 s50, s48, 0
    v_add_u32_e32 v120, s50, v120
    v_bfe_u32 v122, v0, 2, 3
    v_lshlrev_b32_e32 v5, 10, v122
    v_lshrrev_b32_e32 v122, 5, v0
    v_lshl_add_u32 v5, v122, 6, v5
    v_and_b32_e32 v122, 3, v0
    v_lshl_add_u32 v5, v122, 4, v5
    v_cvt_pk_bf16_f32 v64, v16, v17
    v_cvt_pk_bf16_f32 v65, v18, v19
    v_cvt_pk_bf16_f32 v66, v20, v21
    v_cvt_pk_bf16_f32 v67, v22, v23
    v_cvt_pk_bf16_f32 v68, v24, v25
    v_cvt_pk_bf16_f32 v69, v26, v27
    v_cvt_pk_bf16_f32 v70, v28, v29
    v_cvt_pk_bf16_f32 v71, v30, v31
    v_mfma_f32_32x32x16_bf16 v[48:63], a[240:243], v[64:67], 0
    s_nop 0
    v_mfma_f32_32x32x16_bf16 v[48:63], a[244:247], v[68:71], v[48:63]
    s_mul_i32 s50, s81, 512
    s_mov_b64 exec, 0xf
    buffer_load_dword a255, v4, s[16:19], s50 offen
    s_mov_b64 exec, -1
    v_mul_f32_e32 v32, v8, v32
    v_mul_f32_e32 v33, v8, v33
    v_mul_f32_e32 v34, v8, v34
    v_mul_f32_e32 v35, v8, v35
    v_mul_f32_e32 v36, v8, v36
    v_mul_f32_e32 v37, v8, v37
    v_mul_f32_e32 v38, v8, v38
    v_mul_f32_e32 v39, v8, v39
    v_cvt_pk_bf16_f32 v72, v32, v33
    v_cvt_pk_bf16_f32 v73, v34, v35
    v_cvt_pk_bf16_f32 v74, v36, v37
    v_cvt_pk_bf16_f32 v75, v38, v39
    ds_write_b128 v120, v[72:75] offset:16384
    v_mul_f32_e32 v40, v8, v40
    v_mul_f32_e32 v41, v8, v41
    v_mul_f32_e32 v42, v8, v42
    v_mul_f32_e32 v43, v8, v43
    v_mul_f32_e32 v44, v8, v44
    v_mul_f32_e32 v45, v8, v45
    v_mul_f32_e32 v46, v8, v46
    v_mul_f32_e32 v47, v8, v47
    v_cvt_pk_bf16_f32 v76, v40, v41
    v_cvt_pk_bf16_f32 v77, v42, v43
    v_cvt_pk_bf16_f32 v78, v44, v45
    v_cvt_pk_bf16_f32 v79, v46, v47
    ds_write_b128 v120, v[76:79] offset:20480
    v_max3_f32 v112, v48, v49, v50
    v_min3_f32 v114, v48, v49, v50
    v_max3_f32 v113, v56, v57, v58
    v_min3_f32 v115, v56, v57, v58
    v_max3_f32 v112, v112, v51, v52
    v_min3_f32 v114, v114, v51, v52
    v_max3_f32 v113, v113, v59, v60
    v_min3_f32 v115, v115, v59, v60
    v_max3_f32 v112, v112, v53, v54
    v_min3_f32 v114, v114, v53, v54
    v_max3_f32 v113, v113, v61, v62
    v_min3_f32 v115, v115, v61, v62
    v_max_f32_e32 v112, v112, v55
    v_min_f32_e32 v114, v114, v55
    v_max_f32_e32 v113, v113, v63
    v_min_f32_e32 v115, v115, v63
    s_nop 0
    v_permlane32_swap_b32_e32 v112, v113
    v_permlane32_swap_b32_e32 v114, v115
    v_max_f32_e32 v112, v112, v113
    v_min_f32_e32 v114, v114, v115
    v_mul_f32_e64 v112, -v112, v9
    v_mul_f32_e32 v114, v114, v9
    v_mov_b32_e32 v116, v112
    s_mul_i32 s50, s81, 512
    s_mov_b64 exec, 0xf
    buffer_load_dword a255, v4, s[4:7], s50 offen
    s_mov_b64 exec, -1
    v_mov_b32_e32 v118, v114
    v_permlane32_swap_b32_e32 v112, v116
    s_nop 0
    v_permlane32_swap_b32_e32 v114, v118
    v_pk_fma_f32 v[80:81], v[48:49], v[8:9], v[112:113] op_sel:[0,1,0] op_sel_hi:[1,1,0]
    v_pk_fma_f32 v[82:83], v[50:51], v[8:9], v[112:113] op_sel:[0,1,0] op_sel_hi:[1,1,0]
    v_pk_fma_f32 v[84:85], v[52:53], v[8:9], v[112:113] op_sel:[0,1,0] op_sel_hi:[1,1,0]
    v_pk_fma_f32 v[86:87], v[54:55], v[8:9], v[112:113] op_sel:[0,1,0] op_sel_hi:[1,1,0]
    v_pk_fma_f32 v[88:89], v[48:49], v[8:9], v[114:115] op_sel:[0,1,0] op_sel_hi:[1,1,0] neg_lo:[1,0,0] neg_hi:[1,0,0]
    v_pk_fma_f32 v[90:91], v[50:51], v[8:9], v[114:115] op_sel:[0,1,0] op_sel_hi:[1,1,0] neg_lo:[1,0,0] neg_hi:[1,0,0]
    v_pk_fma_f32 v[92:93], v[52:53], v[8:9], v[114:115] op_sel:[0,1,0] op_sel_hi:[1,1,0] neg_lo:[1,0,0] neg_hi:[1,0,0]
    v_pk_fma_f32 v[94:95], v[54:55], v[8:9], v[114:115] op_sel:[0,1,0] op_sel_hi:[1,1,0] neg_lo:[1,0,0] neg_hi:[1,0,0]
    v_pk_fma_f32 v[96:97], v[56:57], v[8:9], v[116:117] op_sel:[0,1,0] op_sel_hi:[1,1,0]
    v_pk_fma_f32 v[98:99], v[58:59], v[8:9], v[116:117] op_sel:[0,1,0] op_sel_hi:[1,1,0]
    v_pk_fma_f32 v[100:101], v[60:61], v[8:9], v[116:117] op_sel:[0,1,0] op_sel_hi:[1,1,0]
    v_pk_fma_f32 v[102:103], v[62:63], v[8:9], v[116:117] op_sel:[0,1,0] op_sel_hi:[1,1,0]
    v_pk_fma_f32 v[104:105], v[56:57], v[8:9], v[118:119] op_sel:[0,1,0] op_sel_hi:[1,1,0] neg_lo:[1,0,0] neg_hi:[1,0,0]
    v_pk_fma_f32 v[106:107], v[58:59], v[8:9], v[118:119] op_sel:[0,1,0] op_sel_hi:[1,1,0] neg_lo:[1,0,0] neg_hi:[1,0,0]
    v_pk_fma_f32 v[108:109], v[60:61], v[8:9], v[118:119] op_sel:[0,1,0] op_sel_hi:[1,1,0] neg_lo:[1,0,0] neg_hi:[1,0,0]
    v_pk_fma_f32 v[110:111], v[62:63], v[8:9], v[118:119] op_sel:[0,1,0] op_sel_hi:[1,1,0] neg_lo:[1,0,0] neg_hi:[1,0,0]
    v_exp_f32_e32 v80, v80
    v_exp_f32_e32 v81, v81
    v_exp_f32_e32 v82, v82
    v_exp_f32_e32 v83, v83
    v_exp_f32_e32 v84, v84
    v_exp_f32_e32 v85, v85
    v_exp_f32_e32 v86, v86
    v_exp_f32_e32 v87, v87
    v_exp_f32_e32 v88, v88
    v_exp_f32_e32 v89, v89
    v_exp_f32_e32 v90, v90
    v_exp_f32_e32 v91, v91
    v_exp_f32_e32 v92, v92
    v_exp_f32_e32 v93, v93
    v_exp_f32_e32 v94, v94
    v_exp_f32_e32 v95, v95
    v_lshlrev_b32_e32 v123, 10, v0
    s_and_b32 s50, s81, 127
    s_mul_i32 s50, s50, 4096
    s_mov_b64 exec, 0xf
    buffer_load_dword a255, v123, s[16:19], s50 offen offset:384
    s_mov_b64 exec, -1
    v_exp_f32_e32 v96, v96
    v_exp_f32_e32 v97, v97
    v_exp_f32_e32 v98, v98
    v_exp_f32_e32 v99, v99
    v_exp_f32_e32 v100, v100
    v_exp_f32_e32 v101, v101
    v_exp_f32_e32 v102, v102
    v_exp_f32_e32 v103, v103
    v_exp_f32_e32 v104, v104
    v_exp_f32_e32 v105, v105
    v_exp_f32_e32 v106, v106
    v_exp_f32_e32 v107, v107
    v_exp_f32_e32 v108, v108
    v_exp_f32_e32 v109, v109
    v_exp_f32_e32 v110, v110
    v_exp_f32_e32 v111, v111
    v_pk_add_f32 v[48:49], v[80:81], v[82:83]
    v_pk_add_f32 v[50:51], v[84:85], v[86:87]
    v_pk_add_f32 v[52:53], v[88:89], v[90:91]
    v_pk_add_f32 v[54:55], v[92:93], v[94:95]
    v_pk_add_f32 v[56:57], v[96:97], v[98:99]
    v_pk_add_f32 v[58:59], v[100:101], v[102:103]
    v_pk_add_f32 v[60:61], v[104:105], v[106:107]
    v_pk_add_f32 v[62:63], v[108:109], v[110:111]
    v_pk_add_f32 v[48:49], v[48:49], v[50:51]
    v_pk_add_f32 v[52:53], v[52:53], v[54:55]
    v_pk_add_f32 v[56:57], v[56:57], v[58:59]
    v_pk_add_f32 v[60:61], v[60:61], v[62:63]
    v_add_f32_e32 v112, v48, v49
    v_add_f32_e32 v114, v52, v53
    v_add_f32_e32 v116, v56, v57
    v_add_f32_e32 v118, v60, v61
    v_permlane32_swap_b32_e32 v112, v114
    s_nop 0
    v_permlane32_swap_b32_e32 v116, v118
    v_add_f32_e32 v112, v112, v114
    v_add_f32_e32 v116, v116, v118
    v_rcp_f32_e32 v112, v112
    v_rcp_f32_e32 v116, v116
    v_mov_b32_e32 v114, v112
    v_mov_b32_e32 v118, v116
    s_nop 0
    v_permlane32_swap_b32_e32 v112, v114
    v_permlane32_swap_b32_e32 v116, v118
    v_pk_mul_f32 v[80:81], v[80:81], v[112:113] op_sel_hi:[1,0]
    v_pk_mul_f32 v[82:83], v[82:83], v[112:113] op_sel_hi:[1,0]
    v_pk_mul_f32 v[84:85], v[84:85], v[112:113] op_sel_hi:[1,0]
    v_pk_mul_f32 v[86:87], v[86:87], v[112:113] op_sel_hi:[1,0]
    v_cvt_pk_bf16_f32 v16, v80, v81
    v_cvt_pk_bf16_f32 v17, v82, v83
    v_cvt_pk_bf16_f32 v18, v84, v85
    v_cvt_pk_bf16_f32 v19, v86, v87
    ds_write_b128 v120, v[16:19] offset:0
    v_pk_mul_f32 v[88:89], v[88:89], v[114:115] op_sel_hi:[1,0]
    v_pk_mul_f32 v[90:91], v[90:91], v[114:115] op_sel_hi:[1,0]
    v_pk_mul_f32 v[92:93], v[92:93], v[114:115] op_sel_hi:[1,0]
    v_pk_mul_f32 v[94:95], v[94:95], v[114:115] op_sel_hi:[1,0]
    v_cvt_pk_bf16_f32 v20, v88, v89
    v_cvt_pk_bf16_f32 v21, v90, v91
    v_cvt_pk_bf16_f32 v22, v92, v93
    v_cvt_pk_bf16_f32 v23, v94, v95
    ds_write_b128 v120, v[20:23] offset:4096
    v_pk_mul_f32 v[96:97], v[96:97], v[116:117] op_sel_hi:[1,0]
    v_pk_mul_f32 v[98:99], v[98:99], v[116:117] op_sel_hi:[1,0]
    v_pk_mul_f32 v[100:101], v[100:101], v[116:117] op_sel_hi:[1,0]
    v_pk_mul_f32 v[102:103], v[102:103], v[116:117] op_sel_hi:[1,0]
    v_cvt_pk_bf16_f32 v24, v96, v97
    v_cvt_pk_bf16_f32 v25, v98, v99
    v_cvt_pk_bf16_f32 v26, v100, v101
    v_cvt_pk_bf16_f32 v27, v102, v103
    ds_write_b128 v120, v[24:27] offset:8192
    v_pk_mul_f32 v[104:105], v[104:105], v[118:119] op_sel_hi:[1,0]
    v_pk_mul_f32 v[106:107], v[106:107], v[118:119] op_sel_hi:[1,0]
    v_pk_mul_f32 v[108:109], v[108:109], v[118:119] op_sel_hi:[1,0]
    v_pk_mul_f32 v[110:111], v[110:111], v[118:119] op_sel_hi:[1,0]
    v_cvt_pk_bf16_f32 v28, v104, v105
    v_cvt_pk_bf16_f32 v29, v106, v107
    v_cvt_pk_bf16_f32 v30, v108, v109
    v_cvt_pk_bf16_f32 v31, v110, v111
    ds_write_b128 v120, v[28:31] offset:12288
    v_bfe_u32 v123, v0, 1, 1
    v_lshrrev_b32_e32 v121, 2, v0
    v_lshlrev_b32_e32 v121, 4, v121
    v_mul_u32_u24_e32 v123, 0x280, v123
    v_xor_b32_e32 v121, v121, v123
    v_and_b32_e32 v123, 1, v0
    v_lshl_add_u32 v123, v123, 3, v121
    s_add_u32 s50, s49, 0
    v_add_u32_e32 v121, s50, v123
    s_lshl_b32 s50, s47, 12
    s_add_u32 s50, s50, 16384
    v_add_u32_e32 v122, s50, v123
    s_waitcnt lgkmcnt(0)
    s_barrier
    ds_read_b64_tr_b16 v[80:81], v121 offset:0
    ds_read_b64_tr_b16 v[82:83], v121 offset:256
    ds_read_b64_tr_b16 v[84:85], v122 offset:0
    ds_read_b64_tr_b16 v[86:87], v122 offset:256
    v_mov_b32_e32 v124, s45
    v_mov_b32_e32 v125, s45
    v_mov_b32_e32 v126, s45
    v_mov_b32_e32 v127, s45
    ds_read_b64_tr_b16 v[88:89], v121 offset:1024
    ds_read_b64_tr_b16 v[90:91], v121 offset:1280
    ds_read_b64_tr_b16 v[92:93], v122 offset:1024
    ds_read_b64_tr_b16 v[94:95], v122 offset:1280
    ds_read_b64_tr_b16 v[96:97], v121 offset:2048
    ds_read_b64_tr_b16 v[98:99], v121 offset:2304
    ds_read_b64_tr_b16 v[100:101], v122 offset:2048
    ds_read_b64_tr_b16 v[102:103], v122 offset:2304
    ds_read_b64_tr_b16 v[104:105], v121 offset:3072
    ds_read_b64_tr_b16 v[106:107], v121 offset:3328
    ds_read_b64_tr_b16 v[108:109], v122 offset:3072
    ds_read_b64_tr_b16 v[110:111], v122 offset:3328
    s_waitcnt lgkmcnt(12)
    v_mfma_f32_16x16x32_bf16 v[112:115], v[80:83], v[84:87], 0
    v_mfma_f32_16x16x32_bf16 v[116:119], v[80:83], v[124:127], 0
    s_waitcnt lgkmcnt(8)
    v_mfma_f32_16x16x32_bf16 v[112:115], v[88:91], v[92:95], v[112:115]
    v_mfma_f32_16x16x32_bf16 v[116:119], v[88:91], v[124:127], v[116:119]
    s_waitcnt lgkmcnt(4)
    v_mfma_f32_16x16x32_bf16 v[112:115], v[96:99], v[100:103], v[112:115]
    v_mfma_f32_16x16x32_bf16 v[116:119], v[96:99], v[124:127], v[116:119]
    s_waitcnt lgkmcnt(0)
    v_mfma_f32_16x16x32_bf16 v[112:115], v[104:107], v[108:111], v[112:115]
    v_mfma_f32_16x16x32_bf16 v[116:119], v[104:107], v[124:127], v[116:119]
    s_add_u32 s51, s77, s38
    s_lshl_b32 s58, s51, 10
    s_add_u32 s58, s58, 2097152
    s_lshl_b32 s59, s51, 6
    s_add_u32 s59, s59, 65536
    v_mov_b32_e32 v123, 0xfff
    s_nop 0
    v_bfi_b32 v112, v123, s36, v112
    buffer_store_dwordx4 v[112:115], v1, s[4:7], s58 offen sc1
    v_bfi_b32 v116, v123, s36, v116
    s_mov_b32 exec_lo, 0x10001
    s_mov_b32 exec_hi, 0x10001
    buffer_store_dwordx4 v[116:119], v0, s[4:7], s59 offen sc1
    s_mov_b64 exec, -1
    s_getreg_b32 s50, hwreg(HW_REG_XCC_ID, 0, 4)
    s_lshl_b32 s50, s50, 28
    s_xor_b32 s79, s36, s50
    s_cmp_lg_u32 s37, 0
    s_cbranch_scc1 L_skip_1
    s_lshl_b32 s50, s38, 10
    s_lshl_b32 s51, s39, 6
    s_add_u32 s50, s50, s51
    s_add_u32 s50, s50, 16384
    v_mov_b32_e32 v14, s79
    v_lshlrev_b32_e32 v15, 2, v0
    s_mov_b64 exec, 0xffff
    buffer_store_dword v14, v15, s[4:7], s50 offen sc1
    s_mov_b64 exec, -1
L_skip_1:
    v_bfe_u32 v65, v0, 2, 2
    v_lshrrev_b32_e32 v66, 5, v0
    v_lshl_add_u32 v65, v66, 2, v65
    v_mul_u32_u24_e32 v64, 64, v65
    v_bfe_u32 v65, v0, 4, 1
    v_lshl_add_u32 v64, v65, 5, v64
    v_and_b32_e32 v65, 3, v0
    v_lshl_add_u32 v64, v65, 3, v64
    s_lshl_b32 s50, s38, 1
    s_add_u32 s51, s50, s46
    s_lshl_b32 s51, s51, 10
    s_add_u32 s50, s51, 65536
    v_add_u32_e32 v64, s50, v64
    s_add_u32 s50, s48, 65536
    v_add_u32_e32 v65, s50, v6
    v_bfe_u32 v18, v0, 2, 2
    v_lshrrev_b32_e32 v19, 5, v0
    v_lshl_add_u32 v18, v19, 2, v18
    v_mul_u32_u24_e32 v16, 224, v18
    v_bfe_u32 v18, v0, 4, 1
    v_lshl_add_u32 v16, v18, 5, v16
    v_and_b32_e32 v18, 3, v0
    v_lshl_add_u32 v16, v18, 3, v16
    v_bfe_u32 v18, v0, 4, 1
    v_mul_u32_u24_e32 v18, 12384, v18
    s_lshl_b32 s50, s37, 6
    s_add_u32 s50, s50, 106496
    v_add3_u32 v16, v16, v18, s50
    v_mov_b32_e32 v20, 0
    v_mov_b32_e32 v21, 0
    s_cmp_eq_u32 s37, 3
    s_cselect_b32 s50, 0x10000000, 0
    v_or_b32_e32 v22, s50, v1
    v_bfe_u32 v41, v0, 2, 2
    v_lshrrev_b32_e32 v42, 5, v0
    v_lshl_add_u32 v41, v42, 2, v41
    v_mul_u32_u24_e32 v40, 64, v41
    v_bfe_u32 v41, v0, 4, 1
    v_lshl_add_u32 v40, v41, 5, v40
    v_and_b32_e32 v41, 3, v0
    v_lshl_add_u32 v40, v41, 3, v40
    s_add_u32 s50, s53, 147456
    v_add_u32_e32 v40, s50, v40
    s_lshr_b32 s50, s39, 3
    s_lshl_b32 s88, s38, 1
    s_add_u32 s88, s88, s50
    s_lshl_b32 s88, s88, 2
    s_add_u32 s88, s88, s37
    s_min_u32 s51, s88, 111
    s_cmp_ge_u32 s51, 56
    s_cselect_b32 s89, 1, 0
    s_mul_i32 s50, s89, 56
    s_sub_u32 s51, s51, s50
    s_cmp_ge_u32 s88, 112
    s_cselect_b32 s50, 0x10000000, 0
    v_or_b32_e32 v41, s50, v1
    s_lshl_b32 s50, s40, 1
    s_add_u32 s50, s50, s89
    s_mul_i32 s50, s50, 114688
    s_lshl_b32 s51, s51, 10
    s_add_u32 s50, s50, s51
    s_add_u32 s88, s50, 12582912
    s_add_u32 s89, s88, 57344
    s_waitcnt vmcnt(5)
    s_barrier
    ds_read_b64_tr_b16 v[48:49], v16 offset:0
    ds_read_b64_tr_b16 v[50:51], v16 offset:1792
    ds_read_b64_tr_b16 v[52:53], v16 offset:24576
    ds_read_b64_tr_b16 v[54:55], v16 offset:26368
    ds_read_b64_tr_b16 v[56:57], v16 offset:32
    ds_read_b64_tr_b16 v[58:59], v16 offset:1824
    ds_read_b64_tr_b16 v[60:61], v16 offset:24608
    ds_read_b64_tr_b16 v[62:63], v16 offset:26400
    ds_read_b64_tr_b16 v[32:33], v40 offset:0
    ds_read_b64_tr_b16 v[34:35], v40 offset:1024
    ds_read_b64_tr_b16 v[36:37], v40 offset:512
    ds_read_b64_tr_b16 v[38:39], v40 offset:1536
    s_waitcnt lgkmcnt(10)
    buffer_store_dwordx4 v[48:51], v1, s[4:7], s84 offen sc1
    v_dot2c_f32_bf16_e32 v20, s45, v48
    s_waitcnt lgkmcnt(7)
    v_dot2c_f32_bf16_e32 v21, s45, v56
    v_dot2c_f32_bf16_e32 v20, s45, v49
    v_dot2c_f32_bf16_e32 v21, s45, v57
    v_dot2c_f32_bf16_e32 v20, s45, v50
    s_waitcnt lgkmcnt(6)
    v_dot2c_f32_bf16_e32 v21, s45, v58
    v_dot2c_f32_bf16_e32 v20, s45, v51
    v_dot2c_f32_bf16_e32 v21, s45, v59
    v_dot2c_f32_bf16_e32 v20, s45, v52
    s_waitcnt lgkmcnt(5)
    v_dot2c_f32_bf16_e32 v21, s45, v60
    buffer_store_dwordx4 v[52:55], v1, s[4:7], s85 offen sc1
    v_dot2c_f32_bf16_e32 v20, s45, v53
    v_dot2c_f32_bf16_e32 v21, s45, v61
    v_dot2c_f32_bf16_e32 v20, s45, v54
    s_waitcnt lgkmcnt(4)
    v_dot2c_f32_bf16_e32 v21, s45, v62
    v_dot2c_f32_bf16_e32 v20, s45, v55
    v_dot2c_f32_bf16_e32 v21, s45, v63
    s_nop 2
    v_permlane32_swap_b32_e32 v20, v21
    v_add_f32_e32 v20, v20, v21
    buffer_store_dwordx4 v[56:59], v22, s[4:7], s86 offen sc1
    v_lshlrev_b32_e32 v21, 2, v0
    s_lshl_b32 s50, s39, 14
    s_lshl_b32 s51, s41, 8
    s_add_u32 s50, s50, s51
    s_add_u32 s50, s50, 524288
    buffer_store_dword v20, v21, s[4:7], s50 offen sc1
    s_add_u32 m0, s48, 0
    s_add_u32 s54, s80, 0
    buffer_load_dwordx4 v5, s[16:19], s54 offen lds
    ds_read_b64_tr_b16 v[80:81], v65 offset:0
    ds_read_b64_tr_b16 v[82:83], v65 offset:256
    ds_read_b64_tr_b16 v[84:85], v65 offset:4096
    ds_read_b64_tr_b16 v[86:87], v65 offset:4352
    ds_read_b64_tr_b16 v[88:89], v65 offset:8192
    ds_read_b64_tr_b16 v[90:91], v65 offset:8448
    ds_read_b64_tr_b16 v[92:93], v65 offset:12288
    ds_read_b64_tr_b16 v[94:95], v65 offset:12544
    ds_read_b64_tr_b16 v[96:97], v65 offset:16384
    ds_read_b64_tr_b16 v[98:99], v65 offset:16640
    ds_read_b64_tr_b16 v[100:101], v65 offset:20480
    ds_read_b64_tr_b16 v[102:103], v65 offset:20736
    ds_read_b64_tr_b16 v[104:105], v65 offset:24576
    ds_read_b64_tr_b16 v[106:107], v65 offset:24832
    ds_read_b64_tr_b16 v[108:109], v65 offset:28672
    ds_read_b64_tr_b16 v[110:111], v65 offset:28928
    ds_read_b64_tr_b16 a[216:217], v64 offset:0
    ds_read_b64_tr_b16 a[218:219], v64 offset:512
    v_mov_b32_e32 v66, 0
    v_mov_b32_e32 v67, 0
    v_and_b32_e32 v72, 31, v0
    v_lshrrev_b32_e32 v73, 5, v0
    v_lshlrev_b32_e32 v72, 5, v72
    v_add_u32_e32 v72, 157696, v72
    v_lshl_add_u32 v73, v73, 2, v72
    s_lshl_b32 s50, s37, 3
    v_add_u32_e32 v73, s50, v73
    buffer_store_dwordx4 v[60:63], v22, s[4:7], s87 offen sc1
    s_waitcnt lgkmcnt(15)
    v_dot2c_f32_bf16_e32 v66, s45, v80
    v_dot2c_f32_bf16_e32 v67, s45, v81
    s_waitcnt lgkmcnt(15)
    v_dot2c_f32_bf16_e32 v66, s45, v82
    v_dot2c_f32_bf16_e32 v67, s45, v83
    s_waitcnt lgkmcnt(15)
    v_dot2c_f32_bf16_e32 v66, s45, v84
    v_dot2c_f32_bf16_e32 v67, s45, v85
    s_waitcnt lgkmcnt(14)
    v_dot2c_f32_bf16_e32 v66, s45, v86
    v_dot2c_f32_bf16_e32 v67, s45, v87
    s_add_u32 m0, s48, 32768
    s_add_u32 s54, s80, 262144
    buffer_load_dwordx4 v5, s[16:19], s54 offen lds
    s_waitcnt lgkmcnt(13)
    v_dot2c_f32_bf16_e32 v66, s45, v88
    v_dot2c_f32_bf16_e32 v67, s45, v89
    s_waitcnt lgkmcnt(12)
    v_dot2c_f32_bf16_e32 v66, s45, v90
    v_dot2c_f32_bf16_e32 v67, s45, v91
    s_waitcnt lgkmcnt(11)
    v_dot2c_f32_bf16_e32 v66, s45, v92
    v_dot2c_f32_bf16_e32 v67, s45, v93
    s_waitcnt lgkmcnt(10)
    v_dot2c_f32_bf16_e32 v66, s45, v94
    v_dot2c_f32_bf16_e32 v67, s45, v95
    buffer_store_dwordx4 v[32:35], v41, s[4:7], s88 offen sc1
    s_waitcnt lgkmcnt(9)
    v_dot2c_f32_bf16_e32 v66, s45, v96
    v_dot2c_f32_bf16_e32 v67, s45, v97
    s_waitcnt lgkmcnt(8)
    v_dot2c_f32_bf16_e32 v66, s45, v98
    v_dot2c_f32_bf16_e32 v67, s45, v99
    s_waitcnt lgkmcnt(7)
    v_dot2c_f32_bf16_e32 v66, s45, v100
    v_dot2c_f32_bf16_e32 v67, s45, v101
    s_waitcnt lgkmcnt(6)
    v_dot2c_f32_bf16_e32 v66, s45, v102
    v_dot2c_f32_bf16_e32 v67, s45, v103
    s_add_u32 m0, s48, 4096
    s_add_u32 s54, s80, 32768
    buffer_load_dwordx4 v5, s[16:19], s54 offen lds
    s_waitcnt lgkmcnt(5)
    v_dot2c_f32_bf16_e32 v66, s45, v104
    v_dot2c_f32_bf16_e32 v67, s45, v105
    s_waitcnt lgkmcnt(4)
    v_dot2c_f32_bf16_e32 v66, s45, v106
    v_dot2c_f32_bf16_e32 v67, s45, v107
    s_waitcnt lgkmcnt(3)
    v_dot2c_f32_bf16_e32 v66, s45, v108
    v_dot2c_f32_bf16_e32 v67, s45, v109
    s_waitcnt lgkmcnt(2)
    v_dot2c_f32_bf16_e32 v66, s45, v110
    v_dot2c_f32_bf16_e32 v67, s45, v111
    buffer_store_dwordx4 v[36:39], v41, s[4:7], s89 offen sc1
    s_nop 1
    v_add_f32_e32 v66, v66, v67
    ds_write_b32 v73, v66
    v_add_u32_e32 v126, 65536, v6
    ds_read_b64_tr_b16 v[80:81], v126 offset:0
    ds_read_b64_tr_b16 v[82:83], v126 offset:256
    ds_read_b64_tr_b16 v[84:85], v126 offset:1024
    ds_read_b64_tr_b16 v[86:87], v126 offset:1280
    ds_read_b64_tr_b16 v[88:89], v126 offset:2048
    ds_read_b64_tr_b16 v[90:91], v126 offset:2304
    ds_read_b64_tr_b16 v[92:93], v126 offset:3072
    ds_read_b64_tr_b16 v[94:95], v126 offset:3328
    ds_read_b64_tr_b16 v[96:97], v126 offset:4096
    ds_read_b64_tr_b16 v[98:99], v126 offset:4352
    s_waitcnt lgkmcnt(8)
    v_mfma_f32_32x32x16_bf16 v[32:47], v[80:83], v[128:131], 0
    ds_read_b64_tr_b16 v[100:101], v126 offset:5120
    ds_read_b64_tr_b16 v[102:103], v126 offset:5376
    v_lshrrev_b32_e32 v25, 2, v0
    v_and_b32_e32 v26, 3, v0
    v_lshlrev_b32_e32 v25, 10, v25
    s_waitcnt lgkmcnt(8)
    v_mfma_f32_32x32x16_bf16 v[32:47], v[84:87], v[132:135], v[32:47]
    ds_read_b64_tr_b16 v[104:105], v126 offset:6144
    ds_read_b64_tr_b16 v[106:107], v126 offset:6400
    v_lshl_add_u32 v25, v26, 4, v25
    v_lshrrev_b32_e32 v27, 4, v0
    v_lshlrev_b32_e32 v28, 5, v27
    s_waitcnt lgkmcnt(8)
    v_mfma_f32_32x32x16_bf16 v[32:47], v[88:91], v[136:139], v[32:47]
    ds_read_b64_tr_b16 v[108:109], v126 offset:7168
    ds_read_b64_tr_b16 v[110:111], v126 offset:7424
    v_lshl_add_u32 v28, v26, 3, v28
    s_add_u32 s50, s48, 160256
    v_add_u32_e32 v28, s50, v28
    s_waitcnt lgkmcnt(8)
    v_mfma_f32_32x32x16_bf16 v[32:47], v[92:95], v[140:143], v[32:47]
    ds_read_b64_tr_b16 v[80:81], v126 offset:8192
    ds_read_b64_tr_b16 v[82:83], v126 offset:8448
    s_add_u32 m0, s48, 36864
    s_add_u32 s54, s80, 294912
    buffer_load_dwordx4 v5, s[16:19], s54 offen lds
    s_waitcnt lgkmcnt(8)
    v_mfma_f32_32x32x16_bf16 v[32:47], v[96:99], v[144:147], v[32:47]
    ds_read_b64_tr_b16 v[84:85], v126 offset:9216
    ds_read_b64_tr_b16 v[86:87], v126 offset:9472
    s_waitcnt lgkmcnt(8)
    v_mfma_f32_32x32x16_bf16 v[32:47], v[100:103], v[148:151], v[32:47]
    ds_read_b64_tr_b16 v[88:89], v126 offset:10240
    ds_read_b64_tr_b16 v[90:91], v126 offset:10496
    s_waitcnt lgkmcnt(8)
    v_mfma_f32_32x32x16_bf16 v[32:47], v[104:107], v[152:155], v[32:47]
    ds_read_b64_tr_b16 v[92:93], v126 offset:11264
    ds_read_b64_tr_b16 v[94:95], v126 offset:11520
    s_add_u32 m0, s48, 8192
    s_add_u32 s54, s80, 65536
    buffer_load_dwordx4 v5, s[16:19], s54 offen lds
    s_waitcnt lgkmcnt(8)
    v_mfma_f32_32x32x16_bf16 v[32:47], v[108:111], v[156:159], v[32:47]
    ds_read_b64_tr_b16 v[96:97], v126 offset:12288
    ds_read_b64_tr_b16 v[98:99], v126 offset:12544
    v_cmp_gt_u32_e32 vcc, 16, v0
    v_mov_b32_e32 v29, 0xfff
    s_nop 0
    v_cndmask_b32_e32 v27, 0, v29, vcc
    s_waitcnt lgkmcnt(8)
    v_mfma_f32_32x32x16_bf16 v[32:47], v[80:83], v[160:163], v[32:47]
    ds_read_b64_tr_b16 v[100:101], v126 offset:13312
    ds_read_b64_tr_b16 v[102:103], v126 offset:13568
    s_waitcnt lgkmcnt(8)
    v_mfma_f32_32x32x16_bf16 v[32:47], v[84:87], v[164:167], v[32:47]
    ds_read_b64_tr_b16 v[104:105], v126 offset:14336
    ds_read_b64_tr_b16 v[106:107], v126 offset:14592
    s_add_u32 m0, s48, 40960
    s_add_u32 s54, s80, 327680
    buffer_load_dwordx4 v5, s[16:19], s54 offen lds
    s_lshl_b32 s56, s77, 10
    s_lshl_b32 s50, s38, 6
    s_add_u32 s56, s56, s50
    s_add_u32 s56, s56, 2097152
    s_waitcnt lgkmcnt(8)
    v_mfma_f32_32x32x16_bf16 v[32:47], v[88:91], v[168:171], v[32:47]
    ds_read_b64_tr_b16 v[108:109], v126 offset:15360
    ds_read_b64_tr_b16 v[110:111], v126 offset:15616
    s_lshl_b32 s57, s77, 6
    s_add_u32 s58, s57, 131072
    s_add_u32 s57, s57, 65536
    s_waitcnt lgkmcnt(8)
    v_mfma_f32_32x32x16_bf16 v[32:47], v[92:95], v[172:175], v[32:47]
    ds_read_b64_tr_b16 v[80:81], v126 offset:16384
    ds_read_b64_tr_b16 v[82:83], v126 offset:16640
    v_and_b32_e32 v15, 15, v0
    v_lshlrev_b32_e32 v15, 6, v15
    s_lshl_b32 s59, s38, 10
    s_add_u32 s59, s59, 16384
    s_waitcnt lgkmcnt(8)
    v_mfma_f32_32x32x16_bf16 v[32:47], v[96:99], v[176:179], v[32:47]
    ds_read_b64_tr_b16 v[84:85], v126 offset:17408
    ds_read_b64_tr_b16 v[86:87], v126 offset:17664
    s_add_u32 m0, s48, 12288
    s_add_u32 s54, s80, 98304
    buffer_load_dwordx4 v5, s[16:19], s54 offen lds
    s_waitcnt lgkmcnt(8)
    v_mfma_f32_32x32x16_bf16 v[32:47], v[100:103], v[180:183], v[32:47]
    ds_read_b64_tr_b16 v[88:89], v126 offset:18432
    ds_read_b64_tr_b16 v[90:91], v126 offset:18688
    s_barrier
    ds_read_b128 v[112:115], v72
    s_waitcnt lgkmcnt(9)
    v_mfma_f32_32x32x16_bf16 v[32:47], v[104:107], v[184:187], v[32:47]
    ds_read_b64_tr_b16 v[92:93], v126 offset:19456
    ds_read_b64_tr_b16 v[94:95], v126 offset:19712
    ds_read_b128 v[116:119], v72 offset:16
    s_waitcnt lgkmcnt(0)
    v_add_f32_e32 v112, v112, v116
    v_mfma_f32_32x32x16_bf16 v[32:47], v[108:111], v[188:191], v[32:47]
    ds_read_b64_tr_b16 v[96:97], v126 offset:20480
    ds_read_b64_tr_b16 v[98:99], v126 offset:20736
    s_add_u32 m0, s48, 45056
    s_add_u32 s54, s80, 360448
    buffer_load_dwordx4 v5, s[16:19], s54 offen lds
    v_mfma_f32_32x32x16_bf16 v[32:47], v[80:83], v[192:195], v[32:47]
    ds_read_b64_tr_b16 v[100:101], v126 offset:21504
    ds_read_b64_tr_b16 v[102:103], v126 offset:21760
    v_add_f32_e32 v113, v113, v117
    v_add_f32_e32 v114, v114, v118
    v_mfma_f32_32x32x16_bf16 v[32:47], v[84:87], v[196:199], v[32:47]
    ds_read_b64_tr_b16 v[104:105], v126 offset:22528
    ds_read_b64_tr_b16 v[106:107], v126 offset:22784
    s_add_u32 m0, s48, 16384
    s_add_u32 s54, s80, 131072
    buffer_load_dwordx4 v5, s[16:19], s54 offen lds
    v_mfma_f32_32x32x16_bf16 v[32:47], v[88:91], v[200:203], v[32:47]
    ds_read_b64_tr_b16 v[108:109], v126 offset:23552
    ds_read_b64_tr_b16 v[110:111], v126 offset:23808
    v_add_f32_e32 v115, v115, v119
    v_add_f32_e32 v112, v112, v114
    v_mfma_f32_32x32x16_bf16 v[32:47], v[92:95], v[204:207], v[32:47]
    ds_read_b64_tr_b16 v[80:81], v126 offset:24576
    ds_read_b64_tr_b16 v[82:83], v126 offset:24832
    s_waitcnt lgkmcnt(8)
    v_mfma_f32_32x32x16_bf16 v[32:47], v[96:99], v[208:211], v[32:47]
    ds_read_b64_tr_b16 v[84:85], v126 offset:25600
    ds_read_b64_tr_b16 v[86:87], v126 offset:25856
    s_add_u32 m0, s48, 49152
    s_add_u32 s54, s80, 393216
    buffer_load_dwordx4 v5, s[16:19], s54 offen lds
    s_waitcnt lgkmcnt(8)
    v_mfma_f32_32x32x16_bf16 v[32:47], v[100:103], v[212:215], v[32:47]
    ds_read_b64_tr_b16 v[88:89], v126 offset:26624
    ds_read_b64_tr_b16 v[90:91], v126 offset:26880
    v_add_f32_e32 v113, v113, v115
    v_add_f32_e32 v112, v112, v113
    s_waitcnt lgkmcnt(8)
    v_mfma_f32_32x32x16_bf16 v[32:47], v[104:107], v[216:219], v[32:47]
    ds_read_b64_tr_b16 v[92:93], v126 offset:27648
    ds_read_b64_tr_b16 v[94:95], v126 offset:27904
    v_cvt_pk_bf16_f32 v114, v112, v112
    s_waitcnt lgkmcnt(8)
    v_mfma_f32_32x32x16_bf16 v[32:47], v[108:111], v[220:223], v[32:47]
    ds_read_b64_tr_b16 v[96:97], v126 offset:28672
    ds_read_b64_tr_b16 v[98:99], v126 offset:28928
    s_add_u32 m0, s48, 20480
    s_add_u32 s54, s80, 163840
    buffer_load_dwordx4 v5, s[16:19], s54 offen lds
    s_waitcnt lgkmcnt(8)
    v_mfma_f32_32x32x16_bf16 v[32:47], v[80:83], v[224:227], v[32:47]
    ds_read_b64_tr_b16 v[100:101], v126 offset:29696
    ds_read_b64_tr_b16 v[102:103], v126 offset:29952
    v_and_b32_e32 v113, 0xffff0000, v114
    v_sub_f32_e32 v113, v112, v113
    s_waitcnt lgkmcnt(8)
    v_mfma_f32_32x32x16_bf16 v[32:47], v[84:87], v[228:231], v[32:47]
    ds_read_b64_tr_b16 v[104:105], v126 offset:30720
    ds_read_b64_tr_b16 v[106:107], v126 offset:30976
    v_cvt_pk_bf16_f32 v115, v113, 0
    s_waitcnt lgkmcnt(8)
    v_mfma_f32_32x32x16_bf16 v[32:47], v[88:91], v[232:235], v[32:47]
    ds_read_b64_tr_b16 v[108:109], v126 offset:31744
    ds_read_b64_tr_b16 v[110:111], v126 offset:32000
    s_add_u32 m0, s48, 53248
    s_add_u32 s54, s80, 425984
    buffer_load_dwordx4 v5, s[16:19], s54 offen lds
    s_waitcnt lgkmcnt(8)
    v_mfma_f32_32x32x16_bf16 v[32:47], v[92:95], v[236:239], v[32:47]
    v_accvgpr_write_b32 a252, v114
    v_accvgpr_write_b32 a253, v115
    s_add_u32 m0, s48, 24576
    s_add_u32 s54, s80, 196608
    buffer_load_dwordx4 v5, s[16:19], s54 offen lds
    s_waitcnt lgkmcnt(6)
    v_mfma_f32_32x32x16_bf16 v[32:47], v[96:99], v[240:243], v[32:47]
    buffer_load_dwordx4 v[16:19], v25, s[4:7], s56 offen sc1
    s_waitcnt lgkmcnt(4)
    v_mfma_f32_32x32x16_bf16 v[32:47], v[100:103], v[244:247], v[32:47]
    buffer_load_dwordx4 v[20:23], v1, s[4:7], s57 offen sc1
    s_waitcnt lgkmcnt(2)
    v_mfma_f32_32x32x16_bf16 v[32:47], v[104:107], v[248:251], v[32:47]
    buffer_load_dword v24, v15, s[4:7], s59 offen sc1
    s_waitcnt lgkmcnt(0)
    v_mfma_f32_32x32x16_bf16 v[32:47], v[108:111], v[252:255], v[32:47]
    v_mfma_f32_32x32x8_bf16 v[32:47], a[252:253], v[12:13], v[32:47]
    s_waitcnt vmcnt(13)
    s_barrier
    s_cmp_lg_u32 s37, 0
    s_cbranch_scc1 L_skip_2
    s_lshl_b32 s50, s39, 10
    s_lshl_b32 s51, s38, 6
    s_add_u32 s50, s50, s51
    s_add_u32 s50, s50, 32768
    v_mov_b32_e32 v14, s36
    v_lshlrev_b32_e32 v124, 2, v0
    s_mov_b64 exec, 0xffff
    buffer_store_dword v14, v124, s[4:7], s50 offen sc1
    s_mov_b64 exec, -1
L_skip_2:
    v_lshrrev_b32_e32 v124, 2, v0
    v_and_b32_e32 v125, 3, v0
    v_lshlrev_b32_e32 v124, 10, v124
    v_lshl_add_u32 v124, v125, 4, v124
    s_lshl_b32 s50, s42, 15
    s_lshl_b32 s51, s40, 7
    s_add_u32 s50, s50, s51
    s_lshl_b32 s51, s46, 6
    s_add_u32 s54, s50, s51
    s_add_u32 m0, s53, 147456
    s_nop 0
    buffer_load_dwordx4 v124, s[8:11], s54 offen lds
    s_add_u32 s54, s54, 15360
    buffer_load_dwordx4 v124, s[8:11], s54 offen offset:1024 lds
    buffer_store_dwordx4 v[128:131], v1, s[4:7], s68 offen offset:0 sc1
    buffer_store_dwordx4 v[128:131], v1, s[4:7], s68 offen offset:1024 sc1
    v_and_b32_e32 v120, 15, v0
    v_lshrrev_b32_e32 v121, 4, v0
    v_lshlrev_b32_e32 v120, 5, v120
    v_lshl_add_u32 v120, v121, 3, v120
    s_add_u32 s50, s48, 159744
    v_add_u32_e32 v120, s50, v120
    v_and_b32_e32 v123, 31, v0
    v_and_b32_e32 v122, 19, v0
    v_cmp_gt_u32_e32 vcc, 16, v123
    v_lshrrev_b32_e32 v124, 5, v0
    s_nop 0
    v_cndmask_b32_e32 v122, v122, v123, vcc
    v_lshlrev_b32_e32 v122, 5, v122
    v_lshl_add_u32 v122, v124, 4, v122
    v_add_u32_e32 v122, 159744, v122
    v_cvt_pk_bf16_f32 v64, v32, v33
    v_cvt_pk_bf16_f32 v65, v34, v35
    v_cvt_pk_bf16_f32 v66, v36, v37
    v_cvt_pk_bf16_f32 v67, v38, v39
    v_cvt_pk_bf16_f32 v68, v40, v41
    v_cvt_pk_bf16_f32 v69, v42, v43
    v_cvt_pk_bf16_f32 v70, v44, v45
    v_cvt_pk_bf16_f32 v71, v46, v47
    v_mfma_f32_32x32x16_bf16 v[48:63], a[240:243], v[64:67], 0
    s_nop 0
    v_mfma_f32_32x32x16_bf16 v[48:63], a[244:247], v[68:71], v[48:63]
L_chk_5:
    s_waitcnt vmcnt(6)
    v_xor_b32_e32 v16, s78, v16
    s_waitcnt vmcnt(5)
    v_xor_b32_e32 v20, s78, v20
    v_or_b32_e32 v29, v16, v20
    v_and_b32_e32 v29, 0xfff, v29
    s_waitcnt vmcnt(4)
    v_xor_b32_e32 v30, s36, v24
    v_lshl_or_b32 v29, v30, 4, v29
    v_cmp_ne_u32_e32 vcc, 0, v29
    s_cbranch_vccnz L_retry_6
    v_add_f32_dpp v16, v16, v16 row_ror:4 row_mask:0xf bank_mask:0xf
    v_add_f32_dpp v17, v17, v17 row_ror:4 row_mask:0xf bank_mask:0xf
    v_add_f32_dpp v18, v18, v18 row_ror:4 row_mask:0xf bank_mask:0xf
    v_add_f32_dpp v19, v19, v19 row_ror:4 row_mask:0xf bank_mask:0xf
    v_add_f32_dpp v16, v16, v16 row_ror:8 row_mask:0xf bank_mask:0xf
    v_add_f32_dpp v17, v17, v17 row_ror:8 row_mask:0xf bank_mask:0xf
    v_add_f32_dpp v18, v18, v18 row_ror:8 row_mask:0xf bank_mask:0xf
    v_add_f32_dpp v19, v19, v19 row_ror:8 row_mask:0xf bank_mask:0xf
    v_add_f32_dpp v20, v20, v20 row_ror:4 row_mask:0xf bank_mask:0xf
    v_add_f32_dpp v21, v21, v21 row_ror:4 row_mask:0xf bank_mask:0xf
    v_add_f32_dpp v22, v22, v22 row_ror:4 row_mask:0xf bank_mask:0xf
    v_add_f32_dpp v23, v23, v23 row_ror:4 row_mask:0xf bank_mask:0xf
    v_permlane16_swap_b32_e32 v16, v17
    v_permlane16_swap_b32_e32 v18, v19
    v_add_f32_e32 v16, v16, v17
    v_add_f32_e32 v18, v18, v19
    s_lshl_b32 s50, s38, 6
    s_add_u32 s50, s50, s58
    v_permlane32_swap_b32_e32 v16, v18
    v_add_f32_e32 v16, v16, v18
    v_bfi_b32 v16, v27, s36, v16
    v_mov_b32_e32 v18, v16
    s_nop 1
    v_permlane32_swap_b32_e32 v16, v18
    v_mov_b32_e32 v17, v16
    v_mov_b32_e32 v19, v18
    s_nop 0
    v_permlane16_swap_b32_e32 v16, v17
    v_permlane16_swap_b32_e32 v18, v19
    s_mov_b64 exec, 15
    buffer_store_dwordx4 v[16:19], v1, s[4:7], s50 offen sc1
    s_mov_b64 exec, -1
    v_add_f32_dpp v20, v20, v20 row_ror:8 row_mask:0xf bank_mask:0xf
    v_add_f32_dpp v21, v21, v21 row_ror:8 row_mask:0xf bank_mask:0xf
    v_add_f32_dpp v22, v22, v22 row_ror:8 row_mask:0xf bank_mask:0xf
    v_add_f32_dpp v23, v23, v23 row_ror:8 row_mask:0xf bank_mask:0xf
    v_cvt_pk_bf16_f32 v18, v20, v21
    v_cvt_pk_bf16_f32 v19, v22, v23
    ds_write_b64 v28, v[18:19]
    v_cmp_ne_u32_e32 vcc, s79, v24
    s_cmp_lg_u64 vcc, 0
    s_cselect_b32 s43, 0x2000000, 0
    s_lshr_b32 s50, s43, 1
    s_add_u32 s68, s68, s50
    s_add_u32 s69, s69, s50
    s_add_u32 s68, s68, s43
    s_add_u32 s69, s69, s43
    s_add_u32 m0, s48, 57344
    s_add_u32 s54, s80, 458752
    buffer_load_dwordx4 v5, s[16:19], s54 offen lds
    v_max3_f32 v112, v48, v49, v50
    v_min3_f32 v114, v48, v49, v50
    v_max3_f32 v113, v56, v57, v58
    v_min3_f32 v115, v56, v57, v58
    v_max3_f32 v112, v112, v51, v52
    v_min3_f32 v114, v114, v51, v52
    v_max3_f32 v113, v113, v59, v60
    v_min3_f32 v115, v115, v59, v60
    v_max3_f32 v112, v112, v53, v54
    v_min3_f32 v114, v114, v53, v54
    v_max3_f32 v113, v113, v61, v62
    v_min3_f32 v115, v115, v61, v62
    v_max_f32_e32 v112, v112, v55
    v_min_f32_e32 v114, v114, v55
    v_max_f32_e32 v113, v113, v63
    v_min_f32_e32 v115, v115, v63
    s_nop 0
    v_permlane32_swap_b32_e32 v112, v113
    v_permlane32_swap_b32_e32 v114, v115
    v_max_f32_e32 v112, v112, v113
    v_min_f32_e32 v114, v114, v115
    v_mul_f32_e64 v112, -v112, v9
    s_add_u32 m0, s48, 28672
    s_add_u32 s54, s80, 229376
    buffer_load_dwordx4 v5, s[16:19], s54 offen lds
    v_mul_f32_e32 v114, v114, v9
    v_mov_b32_e32 v116, v112
    v_mov_b32_e32 v118, v114
    s_nop 0
    v_permlane32_swap_b32_e32 v112, v116
    v_permlane32_swap_b32_e32 v114, v118
    v_pk_fma_f32 v[80:81], v[48:49], v[8:9], v[112:113] op_sel:[0,1,0] op_sel_hi:[1,1,0]
    v_pk_fma_f32 v[82:83], v[50:51], v[8:9], v[112:113] op_sel:[0,1,0] op_sel_hi:[1,1,0]
    v_pk_fma_f32 v[84:85], v[52:53], v[8:9], v[112:113] op_sel:[0,1,0] op_sel_hi:[1,1,0]
    v_pk_fma_f32 v[86:87], v[54:55], v[8:9], v[112:113] op_sel:[0,1,0] op_sel_hi:[1,1,0]
    v_pk_fma_f32 v[88:89], v[48:49], v[8:9], v[114:115] op_sel:[0,1,0] op_sel_hi:[1,1,0] neg_lo:[1,0,0] neg_hi:[1,0,0]
    v_pk_fma_f32 v[90:91], v[50:51], v[8:9], v[114:115] op_sel:[0,1,0] op_sel_hi:[1,1,0] neg_lo:[1,0,0] neg_hi:[1,0,0]
    v_pk_fma_f32 v[92:93], v[52:53], v[8:9], v[114:115] op_sel:[0,1,0] op_sel_hi:[1,1,0] neg_lo:[1,0,0] neg_hi:[1,0,0]
    v_pk_fma_f32 v[94:95], v[54:55], v[8:9], v[114:115] op_sel:[0,1,0] op_sel_hi:[1,1,0] neg_lo:[1,0,0] neg_hi:[1,0,0]
    v_pk_fma_f32 v[96:97], v[56:57], v[8:9], v[116:117] op_sel:[0,1,0] op_sel_hi:[1,1,0]
    v_pk_fma_f32 v[98:99], v[58:59], v[8:9], v[116:117] op_sel:[0,1,0] op_sel_hi:[1,1,0]
    v_pk_fma_f32 v[100:101], v[60:61], v[8:9], v[116:117] op_sel:[0,1,0] op_sel_hi:[1,1,0]
    v_pk_fma_f32 v[102:103], v[62:63], v[8:9], v[116:117] op_sel:[0,1,0] op_sel_hi:[1,1,0]
    v_pk_fma_f32 v[104:105], v[56:57], v[8:9], v[118:119] op_sel:[0,1,0] op_sel_hi:[1,1,0] neg_lo:[1,0,0] neg_hi:[1,0,0]
    v_pk_fma_f32 v[106:107], v[58:59], v[8:9], v[118:119] op_sel:[0,1,0] op_sel_hi:[1,1,0] neg_lo:[1,0,0] neg_hi:[1,0,0]
    s_add_u32 m0, s48, 61440
    s_add_u32 s54, s80, 491520
    buffer_load_dwordx4 v5, s[16:19], s54 offen lds
    v_pk_fma_f32 v[108:109], v[60:61], v[8:9], v[118:119] op_sel:[0,1,0] op_sel_hi:[1,1,0] neg_lo:[1,0,0] neg_hi:[1,0,0]
    v_pk_fma_f32 v[110:111], v[62:63], v[8:9], v[118:119] op_sel:[0,1,0] op_sel_hi:[1,1,0] neg_lo:[1,0,0] neg_hi:[1,0,0]
    v_exp_f32_e32 v80, v80
    v_exp_f32_e32 v81, v81
    v_exp_f32_e32 v82, v82
    v_exp_f32_e32 v83, v83
    v_exp_f32_e32 v84, v84
    v_exp_f32_e32 v85, v85
    v_exp_f32_e32 v86, v86
    v_exp_f32_e32 v87, v87
    v_exp_f32_e32 v88, v88
    v_exp_f32_e32 v89, v89
    v_exp_f32_e32 v90, v90
    v_exp_f32_e32 v91, v91
    v_and_b32_e32 v77, 15, v0
    v_bfe_u32 v76, v0, 4, 1
    v_lshlrev_b32_e32 v77, 6, v77
    v_lshl_add_u32 v77, v76, 13, v77
    s_lshl_b32 s88, s40, 10
    s_add_u32 s88, s88, 32768
    buffer_load_dword v76, v77, s[4:7], s88 offen offset:0 sc1
    v_exp_f32_e32 v92, v92
    v_exp_f32_e32 v93, v93
    v_exp_f32_e32 v94, v94
    v_exp_f32_e32 v95, v95
    v_exp_f32_e32 v96, v96
    v_exp_f32_e32 v97, v97
    v_exp_f32_e32 v98, v98
    v_exp_f32_e32 v99, v99
    v_exp_f32_e32 v100, v100
    v_exp_f32_e32 v101, v101
    v_exp_f32_e32 v102, v102
    v_exp_f32_e32 v103, v103
    buffer_store_dwordx4 v[128:131], v1, s[4:7], s64 offen offset:0 sc1
    v_exp_f32_e32 v104, v104
    v_exp_f32_e32 v105, v105
    v_exp_f32_e32 v106, v106
    v_exp_f32_e32 v107, v107
    v_exp_f32_e32 v108, v108
    v_exp_f32_e32 v109, v109
    v_exp_f32_e32 v110, v110
    v_exp_f32_e32 v111, v111
    v_pk_add_f32 v[48:49], v[80:81], v[82:83]
    v_pk_add_f32 v[50:51], v[84:85], v[86:87]
    v_pk_add_f32 v[52:53], v[88:89], v[90:91]
    v_pk_add_f32 v[54:55], v[92:93], v[94:95]
    v_pk_add_f32 v[56:57], v[96:97], v[98:99]
    v_pk_add_f32 v[58:59], v[100:101], v[102:103]
    v_pk_add_f32 v[60:61], v[104:105], v[106:107]
    buffer_store_dwordx4 v[128:131], v1, s[4:7], s64 offen offset:1024 sc1
    v_pk_add_f32 v[62:63], v[108:109], v[110:111]
    v_pk_add_f32 v[48:49], v[48:49], v[50:51]
    v_pk_add_f32 v[52:53], v[52:53], v[54:55]
    v_pk_add_f32 v[56:57], v[56:57], v[58:59]
    v_pk_add_f32 v[60:61], v[60:61], v[62:63]
    v_add_f32_e32 v112, v48, v49
    v_add_f32_e32 v114, v52, v53
    v_add_f32_e32 v116, v56, v57
    v_add_f32_e32 v118, v60, v61
    v_permlane32_swap_b32_e32 v112, v114
    s_nop 0
    v_permlane32_swap_b32_e32 v116, v118
    v_add_f32_e32 v112, v112, v114
    v_add_f32_e32 v116, v116, v118
    v_rcp_f32_e32 v112, v112
    v_rcp_f32_e32 v116, v116
    v_mov_b32_e32 v114, v112
    v_mov_b32_e32 v118, v116
    s_nop 0
    v_permlane32_swap_b32_e32 v112, v114
    v_permlane32_swap_b32_e32 v116, v118
    s_and_b32 s50, s66, 0xfffffe00
    s_mov_b32 exec_hi, 0
    buffer_store_dwordx4 v[128:131], v1, s[4:7], s50 offen sc1
    s_mov_b32 exec_hi, -1
    v_pk_mul_f32 v[80:81], v[80:81], v[112:113] op_sel_hi:[1,0]
    v_pk_mul_f32 v[82:83], v[82:83], v[112:113] op_sel_hi:[1,0]
    v_pk_mul_f32 v[84:85], v[84:85], v[112:113] op_sel_hi:[1,0]
    v_pk_mul_f32 v[86:87], v[86:87], v[112:113] op_sel_hi:[1,0]
    v_cvt_pk_bf16_f32 v16, v80, v81
    v_cvt_pk_bf16_f32 v17, v82, v83
    v_cvt_pk_bf16_f32 v18, v84, v85
    v_cvt_pk_bf16_f32 v19, v86, v87
    v_pk_mul_f32 v[88:89], v[88:89], v[114:115] op_sel_hi:[1,0]
    v_pk_mul_f32 v[90:91], v[90:91], v[114:115] op_sel_hi:[1,0]
    v_pk_mul_f32 v[92:93], v[92:93], v[114:115] op_sel_hi:[1,0]
    v_pk_mul_f32 v[94:95], v[94:95], v[114:115] op_sel_hi:[1,0]
    v_cvt_pk_bf16_f32 v20, v88, v89
    v_cvt_pk_bf16_f32 v21, v90, v91
    v_cvt_pk_bf16_f32 v22, v92, v93
    v_cvt_pk_bf16_f32 v23, v94, v95
    v_pk_mul_f32 v[96:97], v[96:97], v[116:117] op_sel_hi:[1,0]
    v_pk_mul_f32 v[98:99], v[98:99], v[116:117] op_sel_hi:[1,0]
    v_pk_mul_f32 v[100:101], v[100:101], v[116:117] op_sel_hi:[1,0]
    v_pk_mul_f32 v[102:103], v[102:103], v[116:117] op_sel_hi:[1,0]
    s_mov_b64 exec, 0xffff
    buffer_load_dword a255, v4, s[4:7], s68 offen sc1
    s_mov_b64 exec, -1
    v_cvt_pk_bf16_f32 v24, v96, v97
    v_cvt_pk_bf16_f32 v25, v98, v99
    v_cvt_pk_bf16_f32 v26, v100, v101
    v_cvt_pk_bf16_f32 v27, v102, v103
    v_pk_mul_f32 v[104:105], v[104:105], v[118:119] op_sel_hi:[1,0]
    v_pk_mul_f32 v[106:107], v[106:107], v[118:119] op_sel_hi:[1,0]
    v_pk_mul_f32 v[108:109], v[108:109], v[118:119] op_sel_hi:[1,0]
    v_pk_mul_f32 v[110:111], v[110:111], v[118:119] op_sel_hi:[1,0]
    v_cvt_pk_bf16_f32 v28, v104, v105
    v_cvt_pk_bf16_f32 v29, v106, v107
    v_cvt_pk_bf16_f32 v30, v108, v109
    v_cvt_pk_bf16_f32 v31, v110, v111
    buffer_load_dwordx4 v[32:35], v1, s[4:7], s58 offen sc1
    v_and_b32_e32 v72, 31, v0
    v_lshrrev_b32_e32 v64, 5, v0
    v_lshlrev_b32_e32 v72, 6, v72
    v_lshl_add_u32 v72, v64, 3, v72
    s_add_u32 s50, s53, 147456
    v_add_u32_e32 v72, s50, v72
    s_waitcnt vmcnt(12)
    ds_read_b64 v[64:65], v72 offset:0
    ds_read_b64 v[66:67], v72 offset:16
    ds_read_b64 v[68:69], v72 offset:32
    ds_read_b64 v[70:71], v72 offset:48
    s_waitcnt lgkmcnt(3)
    v_lshlrev_b32_e32 v72, 16, v64
    v_and_b32_e32 v64, 0xffff0000, v64
    v_accvgpr_write_b32 a224, v72
    v_accvgpr_write_b32 a225, v64
    v_lshlrev_b32_e32 v72, 16, v65
    v_and_b32_e32 v65, 0xffff0000, v65
    v_accvgpr_write_b32 a226, v72
    v_accvgpr_write_b32 a227, v65
    s_waitcnt lgkmcnt(2)
    v_lshlrev_b32_e32 v72, 16, v66
    v_and_b32_e32 v66, 0xffff0000, v66
    v_accvgpr_write_b32 a228, v72
    v_accvgpr_write_b32 a229, v66
    v_lshlrev_b32_e32 v72, 16, v67
    v_and_b32_e32 v67, 0xffff0000, v67
    v_accvgpr_write_b32 a230, v72
    v_accvgpr_write_b32 a231, v67
    s_waitcnt lgkmcnt(1)
    v_lshlrev_b32_e32 v72, 16, v68
    v_and_b32_e32 v68, 0xffff0000, v68
    v_accvgpr_write_b32 a232, v72
    v_accvgpr_write_b32 a233, v68
    v_lshlrev_b32_e32 v72, 16, v69
    v_and_b32_e32 v69, 0xffff0000, v69
    v_accvgpr_write_b32 a234, v72
    v_accvgpr_write_b32 a235, v69
    s_waitcnt lgkmcnt(0)
    v_lshlrev_b32_e32 v72, 16, v70
    v_and_b32_e32 v70, 0xffff0000, v70
    v_accvgpr_write_b32 a236, v72
    v_accvgpr_write_b32 a237, v70
    v_lshlrev_b32_e32 v72, 16, v71
    v_and_b32_e32 v71, 0xffff0000, v71
    v_accvgpr_write_b32 a238, v72
    v_accvgpr_write_b32 a239, v71
    s_waitcnt vmcnt(6)
    s_barrier
    s_waitcnt vmcnt(5)
    v_cmp_ne_u32_e32 vcc, s36, v76
    s_cbranch_vccnz L_spin_3
L_back_4:
    v_lshrrev_b32_e32 v78, 4, v0
    v_mul_u32_u24_e32 v78, 768, v78
    v_add_u32_e32 v78, v78, v1
    v_bfe_u32 v76, v0, 2, 2
    v_lshlrev_b32_e32 v74, 6, v76
    v_lshrrev_b32_e32 v76, 5, v0
    v_lshl_add_u32 v74, v76, 10, v74
    v_bfe_u32 v76, v0, 4, 1
    v_lshl_add_u32 v74, v76, 5, v74
    v_and_b32_e32 v76, 3, v0
    v_lshl_add_u32 v74, v76, 3, v74
    s_mul_i32 s50, s46, 33280
    s_add_u32 s50, s50, 0
    v_add_u32_e32 v74, s50, v74
    s_lshl_b32 s50, s39, 14
    s_lshl_b32 s51, s37, 8
    s_add_u32 s50, s50, s51
    s_add_u32 s50, s50, 524288
    buffer_load_dwordx4 v[96:99], v78, s[4:7], s50 offen sc1
    v_xor_b32_e32 v75, 0x200, v74
    ds_read_b64_tr_b16 v[128:129], v75 offset:0
    ds_read_b64_tr_b16 v[130:131], v75 offset:256
    ds_read_b64_tr_b16 v[132:133], v74 offset:0
    ds_read_b64_tr_b16 v[134:135], v74 offset:256
    ds_read_b64_tr_b16 v[136:137], v75 offset:2048
    ds_read_b64_tr_b16 v[138:139], v75 offset:2304
    ds_read_b64_tr_b16 v[140:141], v74 offset:2048
    ds_read_b64_tr_b16 v[142:143], v74 offset:2304
    ds_read_b64_tr_b16 v[144:145], v75 offset:4096
    s_lshl_b32 s50, s39, 14
    s_lshl_b32 s51, s37, 8
    s_add_u32 s50, s50, s51
    s_add_u32 s50, s50, 528384
    buffer_load_dwordx4 v[100:103], v78, s[4:7], s50 offen sc1
    ds_read_b64_tr_b16 v[146:147], v75 offset:4352
    ds_read_b64_tr_b16 v[148:149], v74 offset:4096
    ds_read_b64_tr_b16 v[150:151], v74 offset:4352
    ds_read_b64_tr_b16 v[152:153], v75 offset:6144
    ds_read_b64_tr_b16 v[154:155], v75 offset:6400
    ds_read_b64_tr_b16 v[156:157], v74 offset:6144
    ds_read_b64_tr_b16 v[158:159], v74 offset:6400
    ds_read_b64_tr_b16 v[160:161], v75 offset:8192
    ds_read_b64_tr_b16 v[162:163], v75 offset:8448
    ds_read_b64_tr_b16 v[164:165], v74 offset:8192
    s_lshl_b32 s50, s39, 14
    s_lshl_b32 s51, s37, 8
    s_add_u32 s50, s50, s51
    s_add_u32 s50, s50, 532480
    buffer_load_dwordx4 v[104:107], v78, s[4:7], s50 offen sc1
    ds_read_b64_tr_b16 v[166:167], v74 offset:8448
    ds_read_b64_tr_b16 v[168:169], v75 offset:10240
    ds_read_b64_tr_b16 v[170:171], v75 offset:10496
    ds_read_b64_tr_b16 v[172:173], v74 offset:10240
    ds_read_b64_tr_b16 v[174:175], v74 offset:10496
    ds_read_b64_tr_b16 v[176:177], v75 offset:12288
    ds_read_b64_tr_b16 v[178:179], v75 offset:12544
    ds_read_b64_tr_b16 v[180:181], v74 offset:12288
    ds_read_b64_tr_b16 v[182:183], v74 offset:12544
    s_lshl_b32 s50, s39, 14
    s_lshl_b32 s51, s37, 8
    s_add_u32 s50, s50, s51
    s_add_u32 s50, s50, 536576
    buffer_load_dwordx4 v[108:111], v78, s[4:7], s50 offen sc1
    ds_read_b64_tr_b16 v[184:185], v75 offset:14336
    ds_read_b64_tr_b16 v[186:187], v75 offset:14592
    ds_read_b64_tr_b16 v[188:189], v74 offset:14336
    ds_read_b64_tr_b16 v[190:191], v74 offset:14592
    ds_read_b64_tr_b16 v[192:193], v75 offset:16384
    ds_read_b64_tr_b16 v[194:195], v75 offset:16640
    ds_read_b64_tr_b16 v[196:197], v74 offset:16384
    ds_read_b64_tr_b16 v[198:199], v74 offset:16640
    ds_read_b64_tr_b16 v[200:201], v75 offset:18432
    ds_read_b64_tr_b16 v[202:203], v75 offset:18688
    s_add_u32 m0, s49, 98304
    s_add_u32 s54, s60, 0
    buffer_load_dwordx4 v1, s[4:7], s54 offen lds
    ds_read_b64_tr_b16 v[204:205], v74 offset:18432
    ds_read_b64_tr_b16 v[206:207], v74 offset:18688
    ds_read_b64_tr_b16 v[208:209], v75 offset:20480
    ds_read_b64_tr_b16 v[210:211], v75 offset:20736
    ds_read_b64_tr_b16 v[212:213], v74 offset:20480
    ds_read_b64_tr_b16 v[214:215], v74 offset:20736
    ds_read_b64_tr_b16 v[216:217], v75 offset:22528
    ds_read_b64_tr_b16 v[218:219], v75 offset:22784
    ds_read_b64_tr_b16 v[220:221], v74 offset:22528
    buffer_load_dwordx4 v1, s[4:7], s54 offen offset:1024 lds
    ds_read_b64_tr_b16 v[222:223], v74 offset:22784
    ds_read_b64_tr_b16 v[224:225], v75 offset:24576
    ds_read_b64_tr_b16 v[226:227], v75 offset:24832
    ds_read_b64_tr_b16 v[228:229], v74 offset:24576
    ds_read_b64_tr_b16 v[230:231], v74 offset:24832
    ds_read_b64_tr_b16 v[232:233], v75 offset:26624
    ds_read_b64_tr_b16 v[234:235], v75 offset:26880
    ds_read_b64_tr_b16 v[236:237], v74 offset:26624
    ds_read_b64_tr_b16 v[238:239], v74 offset:26880
    ds_read_b64_tr_b16 v[240:241], v75 offset:28672
    buffer_load_dwordx4 v1, s[4:7], s54 offen offset:2048 lds
    ds_read_b64_tr_b16 v[242:243], v75 offset:28928
    ds_read_b64_tr_b16 v[244:245], v74 offset:28672
    ds_read_b64_tr_b16 v[246:247], v74 offset:28928
    ds_read_b64_tr_b16 v[248:249], v75 offset:30720
    ds_read_b64_tr_b16 v[250:251], v75 offset:30976
    ds_read_b64_tr_b16 v[252:253], v74 offset:30720
    ds_read_b64_tr_b16 v[254:255], v74 offset:30976
L_chk_7:
    s_waitcnt vmcnt(7)
    v_xor_b32_e32 v32, s78, v32
    v_and_b32_e32 v36, 0xfff, v32
    v_cmp_ne_u32_e32 vcc, 0, v36
    v_cvt_pk_bf16_f32 v38, v32, v33
    v_cvt_pk_bf16_f32 v39, v34, v35
    s_cbranch_vccnz L_retry_8
    ds_write_b64 v120, v[38:39]
    s_waitcnt lgkmcnt(0)
    s_barrier
    ds_read_b128 v[80:83], v122 offset:0
    ds_read_b128 v[84:87], v122 offset:1024
    ds_read_b128 v[88:91], v122 offset:2048
    ds_read_b128 v[92:95], v122 offset:3072
    s_add_u32 m0, s49, 98304
    s_add_u32 s54, s60, 0
    buffer_load_dwordx4 v1, s[4:7], s54 offen offset:3072 lds
    s_add_u32 m0, s49, 114688
    s_add_u32 s54, s60, 16384
    buffer_load_dwordx4 v1, s[4:7], s54 offen lds
    s_waitcnt lgkmcnt(3)
    v_mfma_f32_32x32x16_bf16 v[32:47], v[80:83], v[16:19], 0
    s_waitcnt lgkmcnt(2)
    v_mfma_f32_32x32x16_bf16 v[32:47], v[84:87], v[20:23], v[32:47]
    s_waitcnt lgkmcnt(1)
    v_mfma_f32_32x32x16_bf16 v[48:63], v[88:91], v[24:27], 0
    s_waitcnt lgkmcnt(0)
    v_mfma_f32_32x32x16_bf16 v[48:63], v[92:95], v[28:31], v[48:63]
    s_nop 7
    v_add_f32_e32 v40, v40, v41
    v_add_f32_e32 v42, v42, v43
    v_add_f32_e32 v40, 0x358637bd, v40
    v_add_f32_e32 v40, v40, v42
    v_rcp_f32_e32 v40, v40
    s_nop 0
    v_mul_f32_e32 v32, v40, v32
    v_mul_f32_e32 v33, v40, v33
    v_mul_f32_e32 v34, v40, v34
    v_mul_f32_e32 v35, v40, v35
    v_mul_f32_e32 v36, v40, v36
    v_mul_f32_e32 v37, v40, v37
    v_mul_f32_e32 v38, v40, v38
    v_mul_f32_e32 v39, v40, v39
    v_cvt_pk_bf16_f32 v44, v32, v33
    v_cvt_pk_bf16_f32 v45, v34, v35
    v_cvt_pk_bf16_f32 v46, v36, v37
    v_cvt_pk_bf16_f32 v47, v38, v39
    buffer_store_dwordx4 v[44:47], v1, s[4:7], s68 offen offset:0
    v_add_f32_e32 v56, v56, v57
    v_add_f32_e32 v58, v58, v59
    v_add_f32_e32 v56, 0x358637bd, v56
    v_add_f32_e32 v56, v56, v58
    v_rcp_f32_e32 v56, v56
    s_nop 0
    v_pk_mul_f32 v[48:49], v[48:49], v[56:57] op_sel_hi:[1,0]
    v_pk_mul_f32 v[50:51], v[50:51], v[56:57] op_sel_hi:[1,0]
    v_pk_mul_f32 v[52:53], v[52:53], v[56:57] op_sel_hi:[1,0]
    v_pk_mul_f32 v[54:55], v[54:55], v[56:57] op_sel_hi:[1,0]
    v_cvt_pk_bf16_f32 v60, v48, v49
    v_cvt_pk_bf16_f32 v61, v50, v51
    v_cvt_pk_bf16_f32 v62, v52, v53
    v_cvt_pk_bf16_f32 v63, v54, v55
    buffer_store_dwordx4 v[60:63], v1, s[4:7], s68 offen offset:1024
    s_mov_b64 exec, 0xffff
    buffer_load_dword a255, v4, s[4:7], s64 offen sc1
    s_mov_b64 exec, -1
    s_and_b32 s50, s66, 0xfffffe00
    s_mov_b64 exec, 0xf
    buffer_load_dword a255, v4, s[4:7], s50 offen sc1
    s_mov_b64 exec, -1
    s_add_u32 m0, s49, 114688
    s_add_u32 s54, s60, 16384
    buffer_load_dwordx4 v1, s[4:7], s54 offen offset:1024 lds
    buffer_load_dwordx4 v1, s[4:7], s54 offen offset:2048 lds
    buffer_load_dwordx4 v1, s[4:7], s54 offen offset:3072 lds
    s_xor_b32 s50, s49, 4096
    s_add_u32 s50, s50, 0
    v_add_u32_e32 v112, s50, v1
    s_add_u32 s50, s49, 0
    v_add_u32_e32 v113, s50, v1
    v_and_b32_e32 v114, 31, v0
    v_lshrrev_b32_e32 v115, 5, v0
    v_lshlrev_b32_e32 v114, 4, v114
    v_lshl_add_u32 v114, v115, 2, v114
    s_add_u32 s64, s64, s43
    s_add_u32 s65, s65, s43
    s_add_u32 s66, s66, s43
    s_add_u32 s67, s67, s43
    v_accvgpr_read_b32 v16, a224
    v_accvgpr_read_b32 v17, a225
    v_accvgpr_read_b32 v18, a226
    v_accvgpr_read_b32 v19, a227
    v_accvgpr_read_b32 v20, a228
    v_accvgpr_read_b32 v21, a229
    v_accvgpr_read_b32 v22, a230
    v_accvgpr_read_b32 v23, a231
    v_accvgpr_read_b32 v24, a232
    v_accvgpr_read_b32 v25, a233
    v_accvgpr_read_b32 v26, a234
    v_accvgpr_read_b32 v27, a235
    v_accvgpr_read_b32 v28, a236
    v_accvgpr_read_b32 v29, a237
    v_accvgpr_read_b32 v30, a238
    v_accvgpr_read_b32 v31, a239
    v_and_b32_e32 v15, 7, v0
    v_lshlrev_b32_e32 v15, 2, v15
    s_mov_b32 s52, s69
    v_mov_b32_e32 v14, s36
    s_cmp_lg_u32 s43, 0
    s_mov_b64 exec, 1
    s_waitcnt vmcnt(5)
    s_cbranch_scc1 L_slow_9
    buffer_store_dword v14, off, s[4:7], s73 offset:384
L_back_10:
    s_mov_b64 exec, -1
    v_add_f32_e32 v96, v96, v104
    v_add_f32_e32 v97, v97, v105
    v_add_f32_e32 v98, v98, v106
    v_add_f32_e32 v99, v99, v107
    v_add_f32_e32 v100, v100, v108
    v_add_f32_e32 v101, v101, v109
    v_add_f32_e32 v102, v102, v110
    v_add_f32_e32 v103, v103, v111
    v_add_f32_e32 v96, v96, v100
    v_add_f32_e32 v97, v97, v101
    v_add_f32_e32 v98, v98, v102
    v_add_f32_e32 v99, v99, v103
    v_permlane16_swap_b32_e32 v96, v97
    s_nop 0
    v_permlane16_swap_b32_e32 v98, v99
    v_add_f32_e32 v96, v96, v97
    v_add_f32_e32 v98, v98, v99
    v_and_b32_e32 v100, 15, v0
    v_lshrrev_b32_e32 v101, 4, v0
    v_permlane32_swap_b32_e32 v96, v98
    v_add_f32_e32 v96, v96, v98
    v_lshl_add_u32 v100, v100, 2, v101
    v_cvt_pk_bf16_f32 v98, v96, v96
    v_and_b32_e32 v97, 0xffff0000, v98
    v_sub_f32_e32 v97, v96, v97
    v_cvt_pk_bf16_f32 v99, v97, 0
    s_lshl_b32 s50, s37, 9
    s_add_u32 s50, s50, 155648
    v_lshl_add_u32 v100, v100, 3, s50
    ds_write_b64 v100, v[98:99]
L_poll_11:
    s_add_u32 s44, s44, 1
    s_cbranch_scc1 L_abort
    buffer_load_dword v14, v15, s[4:7], s74 offen offset:384 sc1
    s_waitcnt vmcnt(0)
    v_cmp_ne_u32_e32 vcc, s36, v14
    s_cbranch_vccnz L_poll_11
    buffer_load_dwordx4 v[80:83], v1, s[4:7], s52 offen offset:0 sc1
    buffer_load_dwordx4 v[84:87], v1, s[4:7], s52 offen offset:1024 sc1
    buffer_load_dwordx4 v[88:91], v1, s[4:7], s52 offen offset:2048 sc1
    buffer_load_dwordx4 v[92:95], v1, s[4:7], s52 offen offset:3072 sc1
    s_add_u32 s52, s52, 4096
    buffer_load_dwordx4 v[96:99], v1, s[4:7], s52 offen offset:0 sc1
    buffer_load_dwordx4 v[100:103], v1, s[4:7], s52 offen offset:1024 sc1
    buffer_load_dwordx4 v[104:107], v1, s[4:7], s52 offen offset:2048 sc1
    buffer_load_dwordx4 v[108:111], v1, s[4:7], s52 offen offset:3072 sc1
    s_waitcnt vmcnt(7)
    v_mfma_f32_32x32x16_bf16 v[32:47], v[128:131], v[80:83], 0
    v_mfma_f32_32x32x16_bf16 v[16:31], v[132:135], v[80:83], v[16:31]
    s_add_u32 s52, s52, 4096
    buffer_load_dwordx4 v[48:51], v1, s[4:7], s52 offen offset:0 sc1
    s_waitcnt vmcnt(7)
    v_mfma_f32_32x32x16_bf16 v[32:47], v[136:139], v[84:87], v[32:47]
    v_mfma_f32_32x32x16_bf16 v[16:31], v[140:143], v[84:87], v[16:31]
    buffer_load_dwordx4 v[52:55], v1, s[4:7], s52 offen offset:1024 sc1
    s_waitcnt vmcnt(7)
    v_mfma_f32_32x32x16_bf16 v[32:47], v[144:147], v[88:91], v[32:47]
    v_mfma_f32_32x32x16_bf16 v[16:31], v[148:151], v[88:91], v[16:31]
    buffer_load_dwordx4 v[56:59], v1, s[4:7], s52 offen offset:2048 sc1
    s_waitcnt vmcnt(7)
    v_mfma_f32_32x32x16_bf16 v[32:47], v[152:155], v[92:95], v[32:47]
    v_mfma_f32_32x32x16_bf16 v[16:31], v[156:159], v[92:95], v[16:31]
    buffer_load_dwordx4 v[60:63], v1, s[4:7], s52 offen offset:3072 sc1
    s_waitcnt vmcnt(7)
    v_mfma_f32_32x32x16_bf16 v[32:47], v[160:163], v[96:99], v[32:47]
    v_mfma_f32_32x32x16_bf16 v[16:31], v[164:167], v[96:99], v[16:31]
    s_add_u32 s52, s52, 4096
    buffer_load_dwordx4 v[64:67], v1, s[4:7], s52 offen offset:0 sc1
    s_waitcnt vmcnt(7)
    v_mfma_f32_32x32x16_bf16 v[32:47], v[168:171], v[100:103], v[32:47]
    v_mfma_f32_32x32x16_bf16 v[16:31], v[172:175], v[100:103], v[16:31]
    buffer_load_dwordx4 v[68:71], v1, s[4:7], s52 offen offset:1024 sc1
    s_waitcnt vmcnt(7)
    v_mfma_f32_32x32x16_bf16 v[32:47], v[176:179], v[104:107], v[32:47]
    v_mfma_f32_32x32x16_bf16 v[16:31], v[180:183], v[104:107], v[16:31]
    buffer_load_dwordx4 v[72:75], v1, s[4:7], s52 offen offset:2048 sc1
    s_waitcnt vmcnt(7)
    v_mfma_f32_32x32x16_bf16 v[32:47], v[184:187], v[108:111], v[32:47]
    v_mfma_f32_32x32x16_bf16 v[16:31], v[188:191], v[108:111], v[16:31]
    buffer_load_dwordx4 v[76:79], v1, s[4:7], s52 offen offset:3072 sc1
    s_waitcnt vmcnt(7)
    v_mfma_f32_32x32x16_bf16 v[32:47], v[192:195], v[48:51], v[32:47]
    v_mfma_f32_32x32x16_bf16 v[16:31], v[196:199], v[48:51], v[16:31]
    s_add_u32 m0, s49, 131072
    s_add_u32 s54, s60, 32768
    buffer_load_dwordx4 v1, s[4:7], s54 offen lds
    s_waitcnt vmcnt(7)
    v_mfma_f32_32x32x16_bf16 v[32:47], v[200:203], v[52:55], v[32:47]
    v_mfma_f32_32x32x16_bf16 v[16:31], v[204:207], v[52:55], v[16:31]
    s_waitcnt vmcnt(6)
    v_mfma_f32_32x32x16_bf16 v[32:47], v[208:211], v[56:59], v[32:47]
    buffer_load_dwordx4 v1, s[4:7], s54 offen offset:1024 lds
    v_mfma_f32_32x32x16_bf16 v[16:31], v[212:215], v[56:59], v[16:31]
    s_waitcnt vmcnt(6)
    v_mfma_f32_32x32x16_bf16 v[32:47], v[216:219], v[60:63], v[32:47]
    buffer_load_dwordx4 v1, s[4:7], s54 offen offset:2048 lds
    v_mfma_f32_32x32x16_bf16 v[16:31], v[220:223], v[60:63], v[16:31]
    s_waitcnt vmcnt(6)
    v_mfma_f32_32x32x16_bf16 v[32:47], v[224:227], v[64:67], v[32:47]
    buffer_load_dwordx4 v1, s[4:7], s54 offen offset:3072 lds
    v_mfma_f32_32x32x16_bf16 v[16:31], v[228:231], v[64:67], v[16:31]
    s_waitcnt vmcnt(6)
    v_mfma_f32_32x32x16_bf16 v[32:47], v[232:235], v[68:71], v[32:47]
    s_waitcnt vmcnt(5)
    v_mfma_f32_32x32x16_bf16 v[32:47], v[240:243], v[72:75], v[32:47]
    s_add_u32 m0, s49, 65536
    s_add_u32 s54, s60, 49152
    buffer_load_dwordx4 v1, s[4:7], s54 offen lds
    s_waitcnt vmcnt(5)
    v_mfma_f32_32x32x16_bf16 v[32:47], v[248:251], v[76:79], v[32:47]
    v_mfma_f32_32x32x16_bf16 v[16:31], v[236:239], v[68:71], v[16:31]
    v_mfma_f32_32x32x16_bf16 v[16:31], v[244:247], v[72:75], v[16:31]
    buffer_load_dwordx4 v1, s[4:7], s54 offen offset:1024 lds
    v_mfma_f32_32x32x16_bf16 v[16:31], v[252:255], v[76:79], v[16:31]
    s_nop 7
    ds_write_b128 v112, v[32:35] offset:0
    ds_write_b128 v112, v[36:39] offset:1024
    ds_write_b128 v112, v[40:43] offset:2048
    ds_write_b128 v112, v[44:47] offset:3072
    s_waitcnt lgkmcnt(0)
    s_barrier
    ds_read_b128 v[48:51], v113 offset:0
    ds_read_b128 v[52:55], v113 offset:1024
    ds_read_b128 v[56:59], v113 offset:2048
    ds_read_b128 v[60:63], v113 offset:3072
    s_waitcnt lgkmcnt(3)
    v_pk_add_f32 v[16:17], v[16:17], v[48:49]
    v_pk_add_f32 v[18:19], v[18:19], v[50:51]
    s_waitcnt lgkmcnt(2)
    v_pk_add_f32 v[20:21], v[20:21], v[52:53]
    v_pk_add_f32 v[22:23], v[22:23], v[54:55]
    v_cvt_pk_bf16_f32 v32, v16, v17
    v_cvt_pk_bf16_f32 v33, v18, v19
    v_cvt_pk_bf16_f32 v34, v20, v21
    v_cvt_pk_bf16_f32 v35, v22, v23
    buffer_store_dwordx4 v[32:35], v1, s[4:7], s64 offen offset:0
    s_waitcnt lgkmcnt(1)
    v_pk_add_f32 v[24:25], v[24:25], v[56:57]
    v_pk_add_f32 v[26:27], v[26:27], v[58:59]
    s_waitcnt lgkmcnt(0)
    v_pk_add_f32 v[28:29], v[28:29], v[60:61]
    v_pk_add_f32 v[30:31], v[30:31], v[62:63]
    v_cvt_pk_bf16_f32 v36, v24, v25
    v_cvt_pk_bf16_f32 v37, v26, v27
    v_cvt_pk_bf16_f32 v38, v28, v29
    v_cvt_pk_bf16_f32 v39, v30, v31
    buffer_store_dwordx4 v[36:39], v1, s[4:7], s64 offen offset:1024
    v_pk_add_f32 v[48:49], v[16:17], v[18:19]
    v_pk_mul_f32 v[50:51], v[16:17], v[16:17]
    v_pk_fma_f32 v[50:51], v[18:19], v[18:19], v[50:51]
    v_pk_add_f32 v[48:49], v[48:49], v[20:21]
    v_pk_fma_f32 v[50:51], v[20:21], v[20:21], v[50:51]
    v_pk_add_f32 v[48:49], v[48:49], v[22:23]
    v_pk_fma_f32 v[50:51], v[22:23], v[22:23], v[50:51]
    v_pk_add_f32 v[48:49], v[48:49], v[24:25]
    v_pk_fma_f32 v[50:51], v[24:25], v[24:25], v[50:51]
    v_pk_add_f32 v[48:49], v[48:49], v[26:27]
    v_pk_fma_f32 v[50:51], v[26:27], v[26:27], v[50:51]
    v_pk_add_f32 v[48:49], v[48:49], v[28:29]
    v_pk_fma_f32 v[50:51], v[28:29], v[28:29], v[50:51]
    v_pk_add_f32 v[48:49], v[48:49], v[30:31]
    v_pk_fma_f32 v[50:51], v[30:31], v[30:31], v[50:51]
    v_add_f32_e32 v48, v48, v49
    v_add_f32_e32 v50, v50, v51
    s_nop 1
    v_permlane32_swap_b32_e32 v48, v50
    v_add_f32_e32 v48, v48, v50
    buffer_store_dword v48, v114, s[4:7], s66 offen
    s_add_u32 m0, s49, 65536
    s_add_u32 s54, s60, 49152
    buffer_load_dwordx4 v1, s[4:7], s54 offen offset:2048 lds
    buffer_load_dwordx4 v1, s[4:7], s54 offen offset:3072 lds
    s_add_u32 m0, s49, 81920
    s_add_u32 s54, s60, 65536
    buffer_load_dwordx4 v1, s[4:7], s54 offen lds
    buffer_load_dwordx4 v1, s[4:7], s54 offen offset:1024 lds
    v_accvgpr_write_b32 a224, v16
    v_accvgpr_write_b32 a225, v17
    v_accvgpr_write_b32 a226, v18
    v_accvgpr_write_b32 a227, v19
    v_accvgpr_write_b32 a228, v20
    v_accvgpr_write_b32 a229, v21
    v_accvgpr_write_b32 a230, v22
    v_accvgpr_write_b32 a231, v23
    v_accvgpr_write_b32 a232, v24
    v_accvgpr_write_b32 a233, v25
    v_accvgpr_write_b32 a234, v26
    v_accvgpr_write_b32 a235, v27
    v_accvgpr_write_b32 a236, v28
    v_accvgpr_write_b32 a237, v29
    v_accvgpr_write_b32 a238, v30
    v_accvgpr_write_b32 a239, v31
    v_and_b32_e32 v15, 15, v0
    v_lshlrev_b32_e32 v15, 2, v15
    s_mov_b32 s52, s65
    v_and_b32_e32 v4, 31, v0
    v_lshrrev_b32_e32 v116, 5, v0
    v_lshlrev_b32_e32 v4, 4, v4
    v_lshl_add_u32 v4, v116, 11, v4
    s_add_u32 s70, s70, s43
    s_add_u32 s61, s61, s43
    v_and_b32_e32 v5, 31, v0
    v_lshlrev_b32_e32 v5, 3, v5
    v_add_u32_e32 v5, 155648, v5
    ds_read_b128 v[80:83], v2 offset:32768
    ds_read_b128 v[84:87], v2 offset:33792
    ds_read_b128 v[88:91], v2 offset:34816
    ds_read_b128 v[92:95], v2 offset:35840
    ds_read_b128 v[96:99], v2 offset:36864
    ds_read_b128 v[100:103], v2 offset:37888
    ds_read_b128 v[104:107], v2 offset:38912
    v_mov_b32_e32 v14, s36
    s_cmp_lg_u32 s43, 0
    s_mov_b64 exec, 1
    s_waitcnt vmcnt(4)
    s_cbranch_scc1 L_slow_12
    buffer_store_dword v14, off, s[4:7], s71 offset:0
L_back_13:
    s_mov_b64 exec, -1
L_poll_14:
    s_add_u32 s44, s44, 1
    s_cbranch_scc1 L_abort
    buffer_load_dword v14, v15, s[4:7], s72 offen offset:0 sc1
    s_waitcnt vmcnt(0)
    v_cmp_ne_u32_e32 vcc, s36, v14
    s_cbranch_vccnz L_poll_14
    buffer_load_dwordx4 v[128:131], v1, s[4:7], s52 offen offset:0 sc1
    buffer_load_dwordx4 v[132:135], v1, s[4:7], s52 offen offset:1024 sc1
    buffer_load_dwordx4 v[136:139], v1, s[4:7], s52 offen offset:2048 sc1
    buffer_load_dwordx4 v[140:143], v1, s[4:7], s52 offen offset:3072 sc1
    s_add_u32 s52, s52, 4096
    buffer_load_dwordx4 v[144:147], v1, s[4:7], s52 offen offset:0 sc1
    buffer_load_dwordx4 v[148:151], v1, s[4:7], s52 offen offset:1024 sc1
    buffer_load_dwordx4 v[152:155], v1, s[4:7], s52 offen offset:2048 sc1
    v_and_b32_e32 v15, 31, v0
    v_lshlrev_b32_e32 v15, 2, v15
    s_waitcnt lgkmcnt(3)
    s_waitcnt vmcnt(6)
    v_mfma_f32_32x32x16_bf16 v[16:31], v[80:83], v[128:131], 0
    ds_read_b128 v[108:111], v2 offset:39936
    v_mfma_f32_32x32x16_bf16 v[32:47], v[84:87], v[128:131], 0
    ds_read_b128 v[80:83], v2 offset:40960
    buffer_load_dwordx4 v[156:159], v1, s[4:7], s52 offen offset:3072 sc1
    v_mfma_f32_32x32x16_bf16 v[48:63], v[88:91], v[128:131], 0
    ds_read_b128 v[84:87], v2 offset:41984
    s_waitcnt vmcnt(6)
    v_mfma_f32_32x32x16_bf16 v[16:31], v[92:95], v[132:135], v[16:31]
    ds_read_b128 v[88:91], v2 offset:43008
    s_add_u32 m0, s49, 81920
    s_add_u32 s54, s60, 65536
    buffer_load_dwordx4 v1, s[4:7], s54 offen offset:2048 lds
    s_waitcnt lgkmcnt(3)
    v_mfma_f32_32x32x16_bf16 v[32:47], v[96:99], v[132:135], v[32:47]
    ds_read_b128 v[92:95], v2 offset:44032
    s_add_u32 s52, s52, 4096
    buffer_load_dwordx4 v[160:163], v1, s[4:7], s52 offen offset:0 sc1
    v_mfma_f32_32x32x16_bf16 v[48:63], v[100:103], v[132:135], v[48:63]
    ds_read_b128 v[96:99], v2 offset:45056
    s_waitcnt vmcnt(7)
    v_mfma_f32_32x32x16_bf16 v[16:31], v[104:107], v[136:139], v[16:31]
    ds_read_b128 v[100:103], v2 offset:46080
    buffer_load_dwordx4 v[164:167], v1, s[4:7], s52 offen offset:1024 sc1
    v_mfma_f32_32x32x16_bf16 v[32:47], v[108:111], v[136:139], v[32:47]
    ds_read_b128 v[104:107], v2 offset:47104
    s_waitcnt lgkmcnt(3)
    v_mfma_f32_32x32x16_bf16 v[48:63], v[80:83], v[136:139], v[48:63]
    ds_read_b128 v[108:111], v2 offset:48128
    s_waitcnt vmcnt(7)
    v_mfma_f32_32x32x16_bf16 v[16:31], v[84:87], v[140:143], v[16:31]
    ds_read_b128 v[80:83], v2 offset:49152
    buffer_load_dwordx4 v[168:171], v1, s[4:7], s52 offen offset:2048 sc1
    buffer_load_dwordx4 v1, s[4:7], s54 offen offset:3072 lds
    v_mfma_f32_32x32x16_bf16 v[32:47], v[88:91], v[140:143], v[32:47]
    ds_read_b128 v[84:87], v2 offset:50176
    v_mfma_f32_32x32x16_bf16 v[48:63], v[92:95], v[140:143], v[48:63]
    ds_read_b128 v[88:91], v2 offset:51200
    buffer_load_dwordx4 v[172:175], v1, s[4:7], s52 offen offset:3072 sc1
    s_waitcnt lgkmcnt(3)
    s_waitcnt vmcnt(9)
    v_mfma_f32_32x32x16_bf16 v[16:31], v[96:99], v[144:147], v[16:31]
    ds_read_b128 v[92:95], v2 offset:52224
    v_mfma_f32_32x32x16_bf16 v[32:47], v[100:103], v[144:147], v[32:47]
    ds_read_b128 v[96:99], v2 offset:53248
    v_mfma_f32_32x32x16_bf16 v[48:63], v[104:107], v[144:147], v[48:63]
    ds_read_b128 v[100:103], v2 offset:54272
    s_add_u32 s52, s52, 4096
    buffer_load_dwordx4 v[176:179], v1, s[4:7], s52 offen offset:0 sc1
    s_waitcnt vmcnt(9)
    v_mfma_f32_32x32x16_bf16 v[16:31], v[108:111], v[148:151], v[16:31]
    ds_read_b128 v[104:107], v2 offset:55296
    s_add_u32 m0, s49, 16384
    s_add_u32 s54, s60, 81920
    buffer_load_dwordx4 v1, s[4:7], s54 offen lds
    s_waitcnt lgkmcnt(3)
    v_mfma_f32_32x32x16_bf16 v[32:47], v[80:83], v[148:151], v[32:47]
    ds_read_b128 v[108:111], v2 offset:56320
    v_mfma_f32_32x32x16_bf16 v[48:63], v[84:87], v[148:151], v[48:63]
    ds_read_b128 v[80:83], v2 offset:57344
    buffer_load_dwordx4 v[180:183], v1, s[4:7], s52 offen offset:1024 sc1
    s_waitcnt vmcnt(10)
    v_mfma_f32_32x32x16_bf16 v[16:31], v[88:91], v[152:155], v[16:31]
    ds_read_b128 v[84:87], v2 offset:58368
    v_mfma_f32_32x32x16_bf16 v[32:47], v[92:95], v[152:155], v[32:47]
    ds_read_b128 v[88:91], v2 offset:59392
    buffer_load_dwordx4 v[184:187], v1, s[4:7], s52 offen offset:2048 sc1
    s_waitcnt lgkmcnt(3)
    v_mfma_f32_32x32x16_bf16 v[48:63], v[96:99], v[152:155], v[48:63]
    ds_read_b128 v[92:95], v2 offset:60416
    buffer_load_dwordx4 v1, s[4:7], s54 offen offset:1024 lds
    s_waitcnt vmcnt(11)
    v_mfma_f32_32x32x16_bf16 v[16:31], v[100:103], v[156:159], v[16:31]
    ds_read_b128 v[96:99], v2 offset:61440
    buffer_load_dwordx4 v[188:191], v1, s[4:7], s52 offen offset:3072 sc1
    v_mfma_f32_32x32x16_bf16 v[32:47], v[104:107], v[156:159], v[32:47]
    ds_read_b128 v[100:103], v2 offset:62464
    v_mfma_f32_32x32x16_bf16 v[48:63], v[108:111], v[156:159], v[48:63]
    ds_read_b128 v[104:107], v2 offset:63488
    s_waitcnt lgkmcnt(3)
    s_waitcnt vmcnt(10)
    v_mfma_f32_32x32x16_bf16 v[16:31], v[80:83], v[160:163], v[16:31]
    ds_read_b128 v[108:111], v2 offset:64512
    buffer_load_dwordx4 v1, s[4:7], s54 offen offset:2048 lds
    s_barrier
    v_mfma_f32_32x32x16_bf16 v[32:47], v[84:87], v[160:163], v[32:47]
    ds_read_b128 v[80:83], v3 offset:0
    s_add_u32 s52, s52, 4096
    buffer_load_dwordx4 v[192:195], v1, s[4:7], s52 offen offset:0 sc1
    v_mfma_f32_32x32x16_bf16 v[48:63], v[88:91], v[160:163], v[48:63]
    ds_read_b128 v[84:87], v3 offset:1024
    s_waitcnt vmcnt(11)
    v_mfma_f32_32x32x16_bf16 v[16:31], v[92:95], v[164:167], v[16:31]
    ds_read_b128 v[88:91], v3 offset:2048
    buffer_load_dwordx4 v[196:199], v1, s[4:7], s52 offen offset:1024 sc1
    s_waitcnt lgkmcnt(3)
    v_mfma_f32_32x32x16_bf16 v[32:47], v[96:99], v[164:167], v[32:47]
    ds_read_b128 v[92:95], v3 offset:3072
    buffer_load_dwordx4 v1, s[4:7], s54 offen offset:3072 lds
    v_mfma_f32_32x32x16_bf16 v[48:63], v[100:103], v[164:167], v[48:63]
    ds_read_b128 v[96:99], v3 offset:4096
    s_waitcnt vmcnt(12)
    v_mfma_f32_32x32x16_bf16 v[16:31], v[104:107], v[168:171], v[16:31]
    ds_read_b128 v[100:103], v3 offset:5120
    buffer_load_dwordx4 v[200:203], v1, s[4:7], s52 offen offset:2048 sc1
    v_mfma_f32_32x32x16_bf16 v[32:47], v[108:111], v[168:171], v[32:47]
    ds_read_b128 v[104:107], v3 offset:6144
    s_waitcnt lgkmcnt(3)
    v_mfma_f32_32x32x16_bf16 v[48:63], v[80:83], v[168:171], v[48:63]
    ds_read_b128 v[108:111], v3 offset:7168
    buffer_load_dwordx4 v[204:207], v1, s[4:7], s52 offen offset:3072 sc1
    s_waitcnt vmcnt(12)
    v_mfma_f32_32x32x16_bf16 v[16:31], v[84:87], v[172:175], v[16:31]
    ds_read_b128 v[80:83], v3 offset:8192
    s_add_u32 m0, s49, 32768
    s_add_u32 s54, s60, 98304
    buffer_load_dwordx4 v1, s[4:7], s54 offen lds
    v_mfma_f32_32x32x16_bf16 v[32:47], v[88:91], v[172:175], v[32:47]
    ds_read_b128 v[84:87], v3 offset:9216
    buffer_load_dwordx4 v[112:115], v4, s[4:7], s67 offen offset:0 sc1
    v_mfma_f32_32x32x16_bf16 v[48:63], v[92:95], v[172:175], v[48:63]
    ds_read_b128 v[88:91], v3 offset:10240
    s_waitcnt lgkmcnt(3)
    s_waitcnt vmcnt(13)
    v_mfma_f32_32x32x16_bf16 v[16:31], v[96:99], v[176:179], v[16:31]
    ds_read_b128 v[92:95], v3 offset:11264
    buffer_load_dwordx4 v[116:119], v4, s[4:7], s67 offen offset:512 sc1
    v_mfma_f32_32x32x16_bf16 v[32:47], v[100:103], v[176:179], v[32:47]
    ds_read_b128 v[96:99], v3 offset:12288
    v_mfma_f32_32x32x16_bf16 v[48:63], v[104:107], v[176:179], v[48:63]
    ds_read_b128 v[100:103], v3 offset:13312
    s_waitcnt vmcnt(12)
    v_mfma_f32_32x32x16_bf16 v[16:31], v[108:111], v[180:183], v[16:31]
    ds_read_b128 v[104:107], v3 offset:14336
    buffer_load_dwordx4 v[120:123], v4, s[4:7], s67 offen offset:1024 sc1
    buffer_load_dwordx4 v1, s[4:7], s54 offen offset:1024 lds
    s_waitcnt lgkmcnt(3)
    v_mfma_f32_32x32x16_bf16 v[32:47], v[80:83], v[180:183], v[32:47]
    ds_read_b128 v[108:111], v3 offset:15360
    v_mfma_f32_32x32x16_bf16 v[48:63], v[84:87], v[180:183], v[48:63]
    ds_read_b128 v[80:83], v2 offset:0
    buffer_load_dwordx4 v[124:127], v4, s[4:7], s67 offen offset:1536 sc1
    s_waitcnt vmcnt(14)
    v_mfma_f32_32x32x16_bf16 v[16:31], v[88:91], v[184:187], v[16:31]
    ds_read_b128 v[84:87], v2 offset:1024
    v_mfma_f32_32x32x16_bf16 v[32:47], v[92:95], v[184:187], v[32:47]
    ds_read_b128 v[88:91], v2 offset:2048
    buffer_load_dwordx4 v1, s[4:7], s54 offen offset:2048 lds
    s_waitcnt lgkmcnt(3)
    v_mfma_f32_32x32x16_bf16 v[48:63], v[96:99], v[184:187], v[48:63]
    ds_read_b128 v[92:95], v2 offset:3072
    s_add_u32 s52, s52, 4096
    buffer_load_dwordx4 v[208:211], v1, s[4:7], s52 offen offset:0 sc1
    s_waitcnt vmcnt(14)
    v_mfma_f32_32x32x16_bf16 v[16:31], v[100:103], v[188:191], v[16:31]
    ds_read_b128 v[96:99], v2 offset:4096
    v_mfma_f32_32x32x16_bf16 v[32:47], v[104:107], v[188:191], v[32:47]
    ds_read_b128 v[100:103], v2 offset:5120
    v_mfma_f32_32x32x16_bf16 v[48:63], v[108:111], v[188:191], v[48:63]
    ds_read_b128 v[104:107], v2 offset:6144
    buffer_load_dwordx4 v1, s[4:7], s54 offen offset:3072 lds
    s_waitcnt lgkmcnt(3)
    s_waitcnt vmcnt(13)
    v_mfma_f32_32x32x16_bf16 v[16:31], v[80:83], v[192:195], v[16:31]
    ds_read_b128 v[108:111], v2 offset:7168
    buffer_load_dwordx4 v[212:215], v1, s[4:7], s52 offen offset:1024 sc1
    v_mfma_f32_32x32x16_bf16 v[32:47], v[84:87], v[192:195], v[32:47]
    ds_read_b128 v[80:83], v2 offset:8192
    buffer_load_dwordx4 v[216:219], v1, s[4:7], s52 offen offset:2048 sc1
    v_mfma_f32_32x32x16_bf16 v[48:63], v[88:91], v[192:195], v[48:63]
    ds_read_b128 v[84:87], v2 offset:9216
    s_waitcnt vmcnt(14)
    v_mfma_f32_32x32x16_bf16 v[16:31], v[92:95], v[196:199], v[16:31]
    ds_read_b128 v[88:91], v2 offset:10240
    s_waitcnt lgkmcnt(3)
    v_mfma_f32_32x32x16_bf16 v[32:47], v[96:99], v[196:199], v[32:47]
    ds_read_b128 v[92:95], v2 offset:11264
    buffer_load_dwordx4 v[220:223], v1, s[4:7], s52 offen offset:3072 sc1
    v_mfma_f32_32x32x16_bf16 v[48:63], v[100:103], v[196:199], v[48:63]
    ds_read_b128 v[96:99], v2 offset:12288
    s_add_u32 m0, s49, 49152
    s_add_u32 s54, s60, 114688
    buffer_load_dwordx4 v1, s[4:7], s54 offen lds
    s_waitcnt vmcnt(14)
    v_mfma_f32_32x32x16_bf16 v[16:31], v[104:107], v[200:203], v[16:31]
    ds_read_b128 v[100:103], v2 offset:13312
    s_add_u32 s52, s52, 4096
    buffer_load_dwordx4 v[224:227], v1, s[4:7], s52 offen offset:0 sc1
    v_mfma_f32_32x32x16_bf16 v[32:47], v[108:111], v[200:203], v[32:47]
    ds_read_b128 v[104:107], v2 offset:14336
    s_waitcnt lgkmcnt(3)
    v_mfma_f32_32x32x16_bf16 v[48:63], v[80:83], v[200:203], v[48:63]
    ds_read_b128 v[108:111], v2 offset:15360
    s_barrier
    s_waitcnt vmcnt(14)
    v_mfma_f32_32x32x16_bf16 v[16:31], v[84:87], v[204:207], v[16:31]
    ds_read_b128 v[80:83], v2 offset:16384
    buffer_load_dwordx4 v[228:231], v1, s[4:7], s52 offen offset:1024 sc1
    v_mfma_f32_32x32x16_bf16 v[32:47], v[88:91], v[204:207], v[32:47]
    ds_read_b128 v[84:87], v2 offset:17408
    buffer_load_dwordx4 v1, s[4:7], s54 offen offset:1024 lds
    v_mfma_f32_32x32x16_bf16 v[48:63], v[92:95], v[204:207], v[48:63]
    ds_read_b128 v[88:91], v2 offset:18432
    s_waitcnt lgkmcnt(3)
    s_waitcnt vmcnt(8)
    v_mfma_f32_32x32x16_bf16 v[16:31], v[96:99], v[208:211], v[16:31]
    ds_read_b128 v[92:95], v2 offset:19456
    buffer_load_dwordx4 v[232:235], v1, s[4:7], s52 offen offset:2048 sc1
    v_mfma_f32_32x32x16_bf16 v[32:47], v[100:103], v[208:211], v[32:47]
    ds_read_b128 v[96:99], v2 offset:20480
    v_mfma_f32_32x32x16_bf16 v[48:63], v[104:107], v[208:211], v[48:63]
    ds_read_b128 v[100:103], v2 offset:21504
    buffer_load_dwordx4 v1, s[4:7], s54 offen offset:2048 lds
    buffer_load_dwordx4 v[236:239], v1, s[4:7], s52 offen offset:3072 sc1
    s_waitcnt vmcnt(9)
    v_mfma_f32_32x32x16_bf16 v[16:31], v[108:111], v[212:215], v[16:31]
    ds_read_b128 v[104:107], v2 offset:22528
    s_waitcnt lgkmcnt(3)
    v_mfma_f32_32x32x16_bf16 v[32:47], v[80:83], v[212:215], v[32:47]
    ds_read_b128 v[108:111], v2 offset:23552
    v_mfma_f32_32x32x16_bf16 v[48:63], v[84:87], v[212:215], v[48:63]
    ds_read_b128 v[80:83], v2 offset:24576
    s_add_u32 s52, s52, 4096
    buffer_load_dwordx4 v[240:243], v1, s[4:7], s52 offen offset:0 sc1
    s_waitcnt vmcnt(9)
    v_mfma_f32_32x32x16_bf16 v[16:31], v[88:91], v[216:219], v[16:31]
    ds_read_b128 v[84:87], v2 offset:25600
    buffer_load_dwordx4 v1, s[4:7], s54 offen offset:3072 lds
    v_mfma_f32_32x32x16_bf16 v[32:47], v[92:95], v[216:219], v[32:47]
    ds_read_b128 v[88:91], v2 offset:26624
    s_waitcnt lgkmcnt(3)
    v_mfma_f32_32x32x16_bf16 v[48:63], v[96:99], v[216:219], v[48:63]
    ds_read_b128 v[92:95], v2 offset:27648
    buffer_load_dwordx4 v[244:247], v1, s[4:7], s52 offen offset:1024 sc1
    s_waitcnt vmcnt(10)
    v_mfma_f32_32x32x16_bf16 v[16:31], v[100:103], v[220:223], v[16:31]
    ds_read_b128 v[96:99], v2 offset:28672
    v_mfma_f32_32x32x16_bf16 v[32:47], v[104:107], v[220:223], v[32:47]
    ds_read_b128 v[100:103], v2 offset:29696
    buffer_load_dwordx4 v[248:251], v1, s[4:7], s52 offen offset:2048 sc1
    v_mfma_f32_32x32x16_bf16 v[48:63], v[108:111], v[220:223], v[48:63]
    ds_read_b128 v[104:107], v2 offset:30720
    s_waitcnt lgkmcnt(3)
    s_waitcnt vmcnt(9)
    v_mfma_f32_32x32x16_bf16 v[16:31], v[80:83], v[224:227], v[16:31]
    ds_read_b128 v[108:111], v2 offset:31744
    s_add_u32 m0, s49, 0
    s_add_u32 s54, s60, 131072
    buffer_load_dwordx4 v1, s[4:7], s54 offen lds
    v_mfma_f32_32x32x16_bf16 v[32:47], v[84:87], v[224:227], v[32:47]
    ds_read_b128 v[80:83], v1 offset:16384
    buffer_load_dwordx4 v[252:255], v1, s[4:7], s52 offen offset:3072 sc1
    v_mfma_f32_32x32x16_bf16 v[48:63], v[88:91], v[224:227], v[48:63]
    ds_read_b128 v[84:87], v1 offset:17408
    s_mul_i32 s50, s39, 98304
    s_lshl_b32 s51, s38, 12
    s_add_u32 s50, s50, s51
    s_add_u32 s50, s50, s48
    s_add_u32 s50, s50, 8388608
    buffer_store_dwordx4 a[220:223], v1, s[4:7], s50 offen sc1
    s_waitcnt vmcnt(11)
    v_mfma_f32_32x32x16_bf16 v[16:31], v[92:95], v[228:231], v[16:31]
    ds_read_b128 v[88:91], v1 offset:18432
    s_waitcnt lgkmcnt(3)
    v_mfma_f32_32x32x16_bf16 v[32:47], v[96:99], v[228:231], v[32:47]
    ds_read_b128 v[92:95], v1 offset:19456
    v_add_f32_e32 v112, v112, v120
    buffer_load_dwordx4 v1, s[4:7], s54 offen offset:1024 lds
    v_add_f32_e32 v113, v113, v121
    v_add_f32_e32 v114, v114, v122
    v_mfma_f32_32x32x16_bf16 v[48:63], v[100:103], v[228:231], v[48:63]
    ds_read_b128 v[96:99], v1 offset:20480
    s_lshl_b32 s50, s38, 1
    s_add_u32 s51, s50, s46
    s_lshl_b32 s51, s51, 10
    s_mul_i32 s50, s39, 98304
    s_add_u32 s50, s50, s51
    s_add_u32 s50, s50, 8454144
    s_cmp_lg_u32 s47, 0
    s_cbranch_scc1 L_apskip
    buffer_store_dwordx4 a[216:219], v1, s[4:7], s50 offen sc1
L_apskip:
    s_waitcnt vmcnt(10)
    v_mfma_f32_32x32x16_bf16 v[16:31], v[104:107], v[232:235], v[16:31]
    ds_read_b128 v[100:103], v1 offset:21504
    v_add_f32_e32 v115, v115, v123
    v_add_f32_e32 v116, v116, v124
    v_add_f32_e32 v117, v117, v125
    v_add_f32_e32 v118, v118, v126
    v_add_f32_e32 v119, v119, v127
    v_mfma_f32_32x32x16_bf16 v[32:47], v[108:111], v[232:235], v[32:47]
    ds_read_b128 v[104:107], v1 offset:22528
    v_add_f32_e32 v112, v112, v116
    v_add_f32_e32 v113, v113, v117
    buffer_load_dwordx4 v1, s[4:7], s54 offen offset:2048 lds
    s_waitcnt lgkmcnt(3)
    v_mfma_f32_32x32x16_bf16 v[48:63], v[80:83], v[232:235], v[48:63]
    ds_read_b128 v[108:111], v1 offset:23552
    v_add_f32_e32 v114, v114, v118
    v_add_f32_e32 v115, v115, v119
    v_add_f32_e32 v112, v112, v114
    v_add_f32_e32 v113, v113, v115
    s_waitcnt vmcnt(9)
    v_mfma_f32_32x32x16_bf16 v[16:31], v[84:87], v[236:239], v[16:31]
    ds_read_b128 v[80:83], v1 offset:24576
    v_permlane32_swap_b32_e32 v112, v113
    v_add_f32_e32 v112, v112, v113
    v_mov_b32_e32 v113, v112
    v_mfma_f32_32x32x16_bf16 v[32:47], v[88:91], v[236:239], v[32:47]
    ds_read_b128 v[84:87], v1 offset:25600
    v_permlane32_swap_b32_e32 v112, v113
    v_mul_f32_e32 v114, 0x3b000000, v112
    v_mul_f32_e32 v115, v114, v114
    v_mul_f32_e32 v113, 0x3b000000, v113
    v_mfma_f32_32x32x16_bf16 v[48:63], v[92:95], v[236:239], v[48:63]
    ds_read_b128 v[88:91], v1 offset:26624
    buffer_load_dwordx4 v1, s[4:7], s54 offen offset:3072 lds
    v_sub_f32_e32 v113, v113, v115
    s_waitcnt lgkmcnt(3)
    s_waitcnt vmcnt(9)
    v_mfma_f32_32x32x16_bf16 v[16:31], v[96:99], v[240:243], v[16:31]
    ds_read_b128 v[92:95], v1 offset:27648
    v_max_f32_e32 v113, 0, v113
    v_add_f32_e32 v113, 0x3727c5ac, v113
    v_rsq_f32_e32 v8, v113
    v_mul_f32_e32 v114, v11, v112
    v_mfma_f32_32x32x16_bf16 v[32:47], v[100:103], v[240:243], v[32:47]
    ds_read_b128 v[96:99], v1 offset:28672
    v_cvt_pk_bf16_f32 v13, v114, 0
    v_mul_f32_e32 v10, v113, v8
    v_mul_f32_e32 v9, 0xbfb8aa3b, v8
    v_lshlrev_b32_e32 v115, 16, v13
    v_sub_f32_e32 v115, v114, v115
    v_mfma_f32_32x32x16_bf16 v[48:63], v[104:107], v[240:243], v[48:63]
    ds_read_b128 v[100:103], v1 offset:29696
    v_cvt_pk_bf16_f32 v12, v114, v115
    s_waitcnt vmcnt(7)
    v_mfma_f32_32x32x16_bf16 v[16:31], v[108:111], v[244:247], v[16:31]
    ds_read_b128 v[104:107], v1 offset:30720
    s_waitcnt lgkmcnt(3)
    v_mfma_f32_32x32x16_bf16 v[32:47], v[80:83], v[244:247], v[32:47]
    ds_read_b128 v[108:111], v1 offset:31744
    s_barrier
    v_mfma_f32_32x32x16_bf16 v[48:63], v[84:87], v[244:247], v[48:63]
    ds_read_b128 v[80:83], v1 offset:32768
    s_add_u32 m0, s49, 98304
    s_add_u32 s54, s60, 147456
    buffer_load_dwordx4 v1, s[4:7], s54 offen lds
    s_waitcnt vmcnt(7)
    v_mfma_f32_32x32x16_bf16 v[16:31], v[88:91], v[248:251], v[16:31]
    ds_read_b128 v[84:87], v1 offset:33792
    ds_read_b64 v[118:119], v5 offset:0
    v_mfma_f32_32x32x16_bf16 v[32:47], v[92:95], v[248:251], v[32:47]
    ds_read_b128 v[88:91], v1 offset:34816
    ds_read_b64 v[120:121], v5 offset:256
    s_waitcnt lgkmcnt(5)
    v_mfma_f32_32x32x16_bf16 v[48:63], v[96:99], v[248:251], v[48:63]
    ds_read_b128 v[92:95], v1 offset:35840
    buffer_load_dwordx4 a[0:3], v1, s[4:7], s55 offen offset:0
    s_waitcnt vmcnt(6)
    v_mfma_f32_32x32x16_bf16 v[16:31], v[100:103], v[252:255], v[16:31]
    ds_read_b128 v[96:99], v1 offset:36864
    ds_read_b64 v[122:123], v5 offset:512
    buffer_load_dwordx4 v1, s[4:7], s54 offen offset:1024 lds
    v_mfma_f32_32x32x16_bf16 v[32:47], v[104:107], v[252:255], v[32:47]
    ds_read_b128 v[100:103], v1 offset:37888
    ds_read_b64 v[124:125], v5 offset:768
    v_mfma_f32_32x32x16_bf16 v[48:63], v[108:111], v[252:255], v[48:63]
    ds_read_b128 v[104:107], v1 offset:38912
    s_waitcnt lgkmcnt(8)
    v_mfma_f32_32x32x8_bf16 v[16:31], v[118:119], v[12:13], v[16:31]
    buffer_load_dwordx4 a[4:7], v1, s[4:7], s55 offen offset:1024
    buffer_load_dwordx4 v1, s[4:7], s54 offen offset:2048 lds
    s_waitcnt lgkmcnt(6)
    v_mfma_f32_32x32x8_bf16 v[32:47], v[120:121], v[12:13], v[32:47]
    s_waitcnt lgkmcnt(3)
    v_mfma_f32_32x32x8_bf16 v[48:63], v[122:123], v[12:13], v[48:63]
    s_waitcnt lgkmcnt(1)
    v_mfma_f32_32x32x8_bf16 v[64:79], v[124:125], v[12:13], 0
    v_mfma_f32_32x32x16_bf16 v[64:79], v[80:83], v[128:131], v[64:79]
    ds_read_b128 v[108:111], v1 offset:39936
    buffer_load_dwordx4 v1, s[4:7], s54 offen offset:3072 lds
    v_mfma_f32_32x32x16_bf16 v[64:79], v[84:87], v[132:135], v[64:79]
    ds_read_b128 v[80:83], v1 offset:40960
    v_mul_f32_e32 v16, v9, v16
    v_mul_f32_e32 v17, v9, v17
    buffer_load_dwordx4 a[8:11], v1, s[4:7], s55 offen offset:2048
    v_mul_f32_e32 v18, v9, v18
    v_mfma_f32_32x32x16_bf16 v[64:79], v[88:91], v[136:139], v[64:79]
    ds_read_b128 v[84:87], v1 offset:41984
    v_mul_f32_e32 v19, v9, v19
    v_exp_f32_e32 v16, v16
    v_exp_f32_e32 v17, v17
    v_mfma_f32_32x32x16_bf16 v[64:79], v[92:95], v[140:143], v[64:79]
    ds_read_b128 v[88:91], v1 offset:43008
    v_exp_f32_e32 v18, v18
    v_exp_f32_e32 v19, v19
    s_waitcnt lgkmcnt(3)
    v_mfma_f32_32x32x16_bf16 v[64:79], v[96:99], v[144:147], v[64:79]
    ds_read_b128 v[92:95], v1 offset:44032
    v_fma_f32 v16, v16, v10, v10
    v_fma_f32 v17, v17, v10, v10
    v_fma_f32 v18, v18, v10, v10
    v_fma_f32 v19, v19, v10, v10
    v_mfma_f32_32x32x16_bf16 v[64:79], v[100:103], v[148:151], v[64:79]
    ds_read_b128 v[96:99], v1 offset:45056
    v_rcp_f32_e32 v16, v16
    v_rcp_f32_e32 v17, v17
    v_mfma_f32_32x32x16_bf16 v[64:79], v[104:107], v[152:155], v[64:79]
    ds_read_b128 v[100:103], v1 offset:46080
    s_add_u32 m0, s49, 114688
    s_add_u32 s54, s60, 163840
    buffer_load_dwordx4 v1, s[4:7], s54 offen lds
    v_mfma_f32_32x32x16_bf16 v[64:79], v[108:111], v[156:159], v[64:79]
    ds_read_b128 v[104:107], v1 offset:47104
    buffer_load_dwordx4 a[12:15], v1, s[4:7], s55 offen offset:3072
    v_rcp_f32_e32 v18, v18
    s_waitcnt lgkmcnt(3)
    v_mfma_f32_32x32x16_bf16 v[64:79], v[80:83], v[160:163], v[64:79]
    ds_read_b128 v[108:111], v1 offset:48128
    v_rcp_f32_e32 v19, v19
    v_mul_f32_e32 v16, v24, v16
    v_mul_f32_e32 v17, v25, v17
    v_mul_f32_e32 v18, v26, v18
    v_mfma_f32_32x32x16_bf16 v[64:79], v[84:87], v[164:167], v[64:79]
    ds_read_b128 v[80:83], v1 offset:49152
    v_mul_f32_e32 v19, v27, v19
    v_cvt_pk_bf16_f32 v16, v16, v17
    v_cvt_pk_bf16_f32 v17, v18, v19
    v_mul_f32_e32 v20, v9, v20
    v_mul_f32_e32 v21, v9, v21
    v_mfma_f32_32x32x16_bf16 v[64:79], v[88:91], v[168:171], v[64:79]
    ds_read_b128 v[84:87], v1 offset:50176
    v_mul_f32_e32 v22, v9, v22
    v_mul_f32_e32 v23, v9, v23
    v_exp_f32_e32 v20, v20
    v_mfma_f32_32x32x16_bf16 v[64:79], v[92:95], v[172:175], v[64:79]
    ds_read_b128 v[88:91], v1 offset:51200
    v_exp_f32_e32 v21, v21
    buffer_load_dwordx4 v1, s[4:7], s54 offen offset:1024 lds
    s_waitcnt lgkmcnt(3)
    v_mfma_f32_32x32x16_bf16 v[64:79], v[96:99], v[176:179], v[64:79]
    ds_read_b128 v[92:95], v1 offset:52224
    v_exp_f32_e32 v22, v22
    v_exp_f32_e32 v23, v23
    v_fma_f32 v20, v20, v10, v10
    v_mfma_f32_32x32x16_bf16 v[64:79], v[100:103], v[180:183], v[64:79]
    ds_read_b128 v[96:99], v1 offset:53248
    s_add_u32 s55, s55, 4096
    buffer_load_dwordx4 a[16:19], v1, s[4:7], s55 offen offset:0
    v_fma_f32 v21, v21, v10, v10
    v_fma_f32 v22, v22, v10, v10
    v_mfma_f32_32x32x16_bf16 v[64:79], v[104:107], v[184:187], v[64:79]
    ds_read_b128 v[100:103], v1 offset:54272
    v_fma_f32 v23, v23, v10, v10
    v_rcp_f32_e32 v20, v20
    v_rcp_f32_e32 v21, v21
    v_mfma_f32_32x32x16_bf16 v[64:79], v[108:111], v[188:191], v[64:79]
    ds_read_b128 v[104:107], v1 offset:55296
    v_rcp_f32_e32 v22, v22
    buffer_load_dwordx4 v1, s[4:7], s54 offen offset:2048 lds
    s_waitcnt lgkmcnt(3)
    v_mfma_f32_32x32x16_bf16 v[64:79], v[80:83], v[192:195], v[64:79]
    ds_read_b128 v[108:111], v1 offset:56320
    v_rcp_f32_e32 v23, v23
    v_mul_f32_e32 v20, v28, v20
    v_mul_f32_e32 v21, v29, v21
    v_mul_f32_e32 v22, v30, v22
    v_mfma_f32_32x32x16_bf16 v[64:79], v[84:87], v[196:199], v[64:79]
    ds_read_b128 v[80:83], v1 offset:57344
    v_mul_f32_e32 v23, v31, v23
    v_cvt_pk_bf16_f32 v18, v20, v21
    v_cvt_pk_bf16_f32 v19, v22, v23
    buffer_load_dwordx4 a[20:23], v1, s[4:7], s55 offen offset:1024
    v_mfma_f32_32x32x16_bf16 v[64:79], v[88:91], v[200:203], v[64:79]
    ds_read_b128 v[84:87], v1 offset:58368
    s_add_u32 s50, s70, 0
    buffer_store_dwordx4 v[16:19], v1, s[4:7], s50 offen
    v_mul_f32_e32 v32, v9, v32
    v_mul_f32_e32 v33, v9, v33
    v_mfma_f32_32x32x16_bf16 v[64:79], v[92:95], v[204:207], v[64:79]
    ds_read_b128 v[88:91], v1 offset:59392
    v_mul_f32_e32 v34, v9, v34
    buffer_load_dwordx4 v1, s[4:7], s54 offen offset:3072 lds
    v_mul_f32_e32 v35, v9, v35
    s_waitcnt lgkmcnt(3)
    v_mfma_f32_32x32x16_bf16 v[64:79], v[96:99], v[208:211], v[64:79]
    ds_read_b128 v[92:95], v1 offset:60416
    v_exp_f32_e32 v32, v32
    v_exp_f32_e32 v33, v33
    v_mfma_f32_32x32x16_bf16 v[64:79], v[100:103], v[212:215], v[64:79]
    ds_read_b128 v[96:99], v1 offset:61440
    v_exp_f32_e32 v34, v34
    v_exp_f32_e32 v35, v35
    v_fma_f32 v32, v32, v10, v10
    v_mfma_f32_32x32x16_bf16 v[64:79], v[104:107], v[216:219], v[64:79]
    ds_read_b128 v[100:103], v1 offset:62464
    v_fma_f32 v33, v33, v10, v10
    v_fma_f32 v34, v34, v10, v10
    v_fma_f32 v35, v35, v10, v10
    v_rcp_f32_e32 v32, v32
    v_mfma_f32_32x32x16_bf16 v[64:79], v[108:111], v[220:223], v[64:79]
    ds_read_b128 v[104:107], v1 offset:63488
    ds_read_b64 v[118:119], v5 offset:1024
    v_rcp_f32_e32 v33, v33
    s_waitcnt lgkmcnt(4)
    v_mfma_f32_32x32x16_bf16 v[64:79], v[80:83], v[224:227], v[64:79]
    ds_read_b128 v[108:111], v1 offset:64512
    s_waitcnt vmcnt(17)
    v_rcp_f32_e32 v34, v34
    buffer_load_dwordx4 a[24:27], v1, s[4:7], s55 offen offset:2048
    v_rcp_f32_e32 v35, v35
    s_add_u32 m0, s49, 131072
    s_add_u32 s54, s60, 180224
    buffer_load_dwordx4 v1, s[4:7], s54 offen lds
    s_waitcnt vmcnt(11)
    s_barrier
    v_mfma_f32_32x32x16_bf16 v[64:79], v[84:87], v[228:231], v[64:79]
    ds_read_b128 v[80:83], v1 offset:0
    v_mul_f32_e32 v32, v40, v32
    v_mul_f32_e32 v33, v41, v33
    v_mul_f32_e32 v34, v42, v34
    v_mul_f32_e32 v35, v43, v35
    v_cvt_pk_bf16_f32 v32, v32, v33
    v_mfma_f32_32x32x16_bf16 v[64:79], v[88:91], v[232:235], v[64:79]
    ds_read_b128 v[84:87], v1 offset:1024
    v_cvt_pk_bf16_f32 v33, v34, v35
    v_mul_f32_e32 v36, v9, v36
    v_mul_f32_e32 v37, v9, v37
    v_mul_f32_e32 v38, v9, v38
    v_mul_f32_e32 v39, v9, v39
    v_mfma_f32_32x32x16_bf16 v[64:79], v[92:95], v[236:239], v[64:79]
    ds_read_b128 v[88:91], v1 offset:2048
    s_cmp_lg_u32 s37, 0
    s_cbranch_scc1 L_skip_23
    s_lshl_b32 s50, s39, 10
    s_lshl_b32 s51, s38, 6
    s_add_u32 s50, s50, s51
    s_add_u32 s50, s50, 49152
    v_mov_b32_e32 v14, s36
    v_lshlrev_b32_e32 v116, 2, v0
    s_mov_b64 exec, 0xffff
    buffer_store_dword v14, v116, s[4:7], s50 offen sc1
    s_mov_b64 exec, -1
L_skip_23:
    v_exp_f32_e32 v36, v36
    s_waitcnt lgkmcnt(3)
    v_mfma_f32_32x32x16_bf16 v[64:79], v[96:99], v[240:243], v[64:79]
    ds_read_b128 v[92:95], v1 offset:3072
    v_exp_f32_e32 v37, v37
    v_exp_f32_e32 v38, v38
    buffer_load_dwordx4 a[28:31], v1, s[4:7], s55 offen offset:3072
    v_mfma_f32_32x32x16_bf16 v[64:79], v[100:103], v[244:247], v[64:79]
    ds_read_b128 v[96:99], v1 offset:4096
    v_exp_f32_e32 v39, v39
    v_fma_f32 v36, v36, v10, v10
    v_fma_f32 v37, v37, v10, v10
    v_fma_f32 v38, v38, v10, v10
    v_mfma_f32_32x32x16_bf16 v[64:79], v[104:107], v[248:251], v[64:79]
    ds_read_b128 v[100:103], v1 offset:5120
    buffer_load_dwordx4 v1, s[4:7], s54 offen offset:1024 lds
    v_fma_f32 v39, v39, v10, v10
    v_rcp_f32_e32 v36, v36
    v_mfma_f32_32x32x16_bf16 v[64:79], v[108:111], v[252:255], v[64:79]
    ds_read_b128 v[104:107], v1 offset:6144
    v_rcp_f32_e32 v37, v37
    v_rcp_f32_e32 v38, v38
    v_rcp_f32_e32 v39, v39
    v_mul_f32_e32 v36, v44, v36
    v_mul_f32_e32 v37, v45, v37
    v_mul_f32_e32 v38, v46, v38
    v_mul_f32_e32 v39, v47, v39
    v_cvt_pk_bf16_f32 v34, v36, v37
    v_cvt_pk_bf16_f32 v35, v38, v39
    s_add_u32 s50, s70, 32768
    buffer_store_dwordx4 v[32:35], v1, s[4:7], s50 offen
    v_mfma_f32_32x32x8_bf16 v[16:31], v[118:119], v[12:13], 0
    buffer_load_dwordx4 v1, s[4:7], s54 offen offset:2048 lds
    s_add_u32 s55, s55, 4096
    buffer_load_dwordx4 a[32:35], v1, s[4:7], s55 offen offset:0
    s_waitcnt lgkmcnt(3)
    v_mfma_f32_32x32x16_bf16 v[16:31], v[80:83], v[128:131], v[16:31]
    ds_read_b128 v[108:111], v1 offset:7168
    v_mfma_f32_32x32x16_bf16 v[16:31], v[84:87], v[132:135], v[16:31]
    ds_read_b128 v[80:83], v1 offset:8192
    buffer_load_dwordx4 v1, s[4:7], s54 offen offset:3072 lds
    v_mfma_f32_32x32x16_bf16 v[16:31], v[88:91], v[136:139], v[16:31]
    ds_read_b128 v[84:87], v1 offset:9216
    v_mul_f32_e32 v48, v9, v48
    v_mul_f32_e32 v49, v9, v49
    v_mul_f32_e32 v50, v9, v50
    v_mul_f32_e32 v51, v9, v51
    v_mfma_f32_32x32x16_bf16 v[16:31], v[92:95], v[140:143], v[16:31]
    ds_read_b128 v[88:91], v1 offset:10240
    v_exp_f32_e32 v48, v48
    v_exp_f32_e32 v49, v49
    s_waitcnt lgkmcnt(3)
    v_mfma_f32_32x32x16_bf16 v[16:31], v[96:99], v[144:147], v[16:31]
    ds_read_b128 v[92:95], v1 offset:11264
    v_exp_f32_e32 v50, v50
    v_exp_f32_e32 v51, v51
    v_fma_f32 v48, v48, v10, v10
    v_mfma_f32_32x32x16_bf16 v[16:31], v[100:103], v[148:151], v[16:31]
    ds_read_b128 v[96:99], v1 offset:12288
    buffer_load_dwordx4 a[36:39], v1, s[4:7], s55 offen offset:1024
    v_fma_f32 v49, v49, v10, v10
    v_fma_f32 v50, v50, v10, v10
    v_fma_f32 v51, v51, v10, v10
    v_mfma_f32_32x32x16_bf16 v[16:31], v[104:107], v[152:155], v[16:31]
    ds_read_b128 v[100:103], v1 offset:13312
    v_rcp_f32_e32 v48, v48
    v_rcp_f32_e32 v49, v49
    v_mfma_f32_32x32x16_bf16 v[16:31], v[108:111], v[156:159], v[16:31]
    ds_read_b128 v[104:107], v1 offset:14336
    s_add_u32 m0, s49, 65536
    s_add_u32 s54, s60, 196608
    buffer_load_dwordx4 v1, s[4:7], s54 offen lds
    s_waitcnt lgkmcnt(3)
    v_mfma_f32_32x32x16_bf16 v[16:31], v[80:83], v[160:163], v[16:31]
    ds_read_b128 v[108:111], v1 offset:15360
    v_rcp_f32_e32 v50, v50
    v_rcp_f32_e32 v51, v51
    v_mul_f32_e32 v48, v56, v48
    v_mfma_f32_32x32x16_bf16 v[16:31], v[84:87], v[164:167], v[16:31]
    ds_read_b128 v[80:83], v2 offset:32768
    v_mul_f32_e32 v49, v57, v49
    v_mul_f32_e32 v50, v58, v50
    v_mul_f32_e32 v51, v59, v51
    v_cvt_pk_bf16_f32 v48, v48, v49
    v_cvt_pk_bf16_f32 v49, v50, v51
    v_mfma_f32_32x32x16_bf16 v[16:31], v[88:91], v[168:171], v[16:31]
    ds_read_b128 v[84:87], v2 offset:33792
    v_mul_f32_e32 v52, v9, v52
    buffer_load_dwordx4 a[40:43], v1, s[4:7], s55 offen offset:2048
    v_mul_f32_e32 v53, v9, v53
    v_mul_f32_e32 v54, v9, v54
    v_mfma_f32_32x32x16_bf16 v[16:31], v[92:95], v[172:175], v[16:31]
    ds_read_b128 v[88:91], v2 offset:34816
    v_mul_f32_e32 v55, v9, v55
    v_exp_f32_e32 v52, v52
    s_waitcnt lgkmcnt(3)
    v_mfma_f32_32x32x16_bf16 v[16:31], v[96:99], v[176:179], v[16:31]
    ds_read_b128 v[92:95], v2 offset:35840
    v_exp_f32_e32 v53, v53
    v_exp_f32_e32 v54, v54
    v_mfma_f32_32x32x16_bf16 v[16:31], v[100:103], v[180:183], v[16:31]
    ds_read_b128 v[96:99], v2 offset:36864
    buffer_load_dwordx4 v1, s[4:7], s54 offen offset:1024 lds
    v_exp_f32_e32 v55, v55
    v_fma_f32 v52, v52, v10, v10
    v_mfma_f32_32x32x16_bf16 v[16:31], v[104:107], v[184:187], v[16:31]
    ds_read_b128 v[100:103], v2 offset:37888
    v_mov_b32_e32 v14, s36
    s_cmp_lg_u32 s43, 0
    s_mov_b64 exec, 1
    s_waitcnt vmcnt(7)
    s_cbranch_scc1 L_slow_15
    buffer_store_dword v14, off, s[4:7], s75 offset:640
L_back_16:
    s_mov_b64 exec, -1
    v_fma_f32 v53, v53, v10, v10
    v_mfma_f32_32x32x16_bf16 v[16:31], v[108:111], v[188:191], v[16:31]
    ds_read_b128 v[104:107], v2 offset:38912
    v_fma_f32 v54, v54, v10, v10
    v_fma_f32 v55, v55, v10, v10
    v_rcp_f32_e32 v52, v52
    s_waitcnt lgkmcnt(3)
    v_mfma_f32_32x32x16_bf16 v[16:31], v[80:83], v[192:195], v[16:31]
    ds_read_b128 v[108:111], v2 offset:39936
    v_rcp_f32_e32 v53, v53
    buffer_load_dwordx4 a[44:47], v1, s[4:7], s55 offen offset:3072
    v_rcp_f32_e32 v54, v54
    v_mfma_f32_32x32x16_bf16 v[16:31], v[84:87], v[196:199], v[16:31]
    ds_read_b128 v[80:83], v2 offset:40960
    v_rcp_f32_e32 v55, v55
    buffer_load_dwordx4 v1, s[4:7], s54 offen offset:2048 lds
    v_mul_f32_e32 v52, v60, v52
    v_mul_f32_e32 v53, v61, v53
    v_mul_f32_e32 v54, v62, v54
    v_mfma_f32_32x32x16_bf16 v[16:31], v[88:91], v[200:203], v[16:31]
    ds_read_b128 v[84:87], v2 offset:41984
    v_mul_f32_e32 v55, v63, v55
    v_cvt_pk_bf16_f32 v50, v52, v53
    v_cvt_pk_bf16_f32 v51, v54, v55
    buffer_load_dwordx4 v1, s[4:7], s54 offen offset:3072 lds
    v_mfma_f32_32x32x16_bf16 v[16:31], v[92:95], v[204:207], v[16:31]
    ds_read_b128 v[88:91], v2 offset:43008
    s_add_u32 s50, s70, 65536
    buffer_store_dwordx4 v[48:51], v1, s[4:7], s50 offen sc1
    v_mul_f32_e32 v64, v9, v64
    v_mul_f32_e32 v65, v9, v65
    s_waitcnt lgkmcnt(3)
    v_mfma_f32_32x32x16_bf16 v[16:31], v[96:99], v[208:211], v[16:31]
    ds_read_b128 v[92:95], v2 offset:44032
    v_mul_f32_e32 v66, v9, v66
    v_mul_f32_e32 v67, v9, v67
    v_exp_f32_e32 v64, v64
    v_mfma_f32_32x32x16_bf16 v[16:31], v[100:103], v[212:215], v[16:31]
    ds_read_b128 v[96:99], v2 offset:45056
    v_exp_f32_e32 v65, v65
    v_exp_f32_e32 v66, v66
    ds_read_b64 v[120:121], v5 offset:1280
    v_mfma_f32_32x32x16_bf16 v[16:31], v[104:107], v[216:219], v[16:31]
    ds_read_b128 v[100:103], v2 offset:46080
    s_add_u32 s55, s55, 4096
    buffer_load_dwordx4 a[48:51], v1, s[4:7], s55 offen offset:0
    v_exp_f32_e32 v67, v67
    v_fma_f32 v64, v64, v10, v10
    v_fma_f32 v65, v65, v10, v10
    v_fma_f32 v66, v66, v10, v10
    v_mfma_f32_32x32x16_bf16 v[16:31], v[108:111], v[220:223], v[16:31]
    ds_read_b128 v[104:107], v2 offset:47104
    buffer_load_dword v127, v15, s[4:7], s76 offen offset:640 sc1
    v_fma_f32 v67, v67, v10, v10
    v_rcp_f32_e32 v64, v64
    s_waitcnt lgkmcnt(4)
    v_mfma_f32_32x32x16_bf16 v[16:31], v[80:83], v[224:227], v[16:31]
    ds_read_b128 v[108:111], v2 offset:48128
    v_rcp_f32_e32 v65, v65
    v_rcp_f32_e32 v66, v66
    v_rcp_f32_e32 v67, v67
    s_waitcnt vmcnt(11)
    s_barrier
    v_mfma_f32_32x32x16_bf16 v[16:31], v[84:87], v[228:231], v[16:31]
    ds_read_b128 v[80:83], v2 offset:49152
    v_mul_f32_e32 v64, v72, v64
    v_mul_f32_e32 v65, v73, v65
    v_mul_f32_e32 v66, v74, v66
    s_add_u32 m0, s49, 81920
    s_add_u32 s54, s60, 212992
    buffer_load_dwordx4 v1, s[4:7], s54 offen lds
    v_mfma_f32_32x32x16_bf16 v[16:31], v[88:91], v[232:235], v[16:31]
    ds_read_b128 v[84:87], v2 offset:50176
    v_mul_f32_e32 v67, v75, v67
    v_cvt_pk_bf16_f32 v64, v64, v65
    v_cvt_pk_bf16_f32 v65, v66, v67
    v_mul_f32_e32 v68, v9, v68
    v_mul_f32_e32 v69, v9, v69
    v_mfma_f32_32x32x16_bf16 v[16:31], v[92:95], v[236:239], v[16:31]
    ds_read_b128 v[88:91], v2 offset:51200
    v_mul_f32_e32 v70, v9, v70
    v_mul_f32_e32 v71, v9, v71
    buffer_load_dwordx4 a[52:55], v1, s[4:7], s55 offen offset:1024
    v_exp_f32_e32 v68, v68
    s_waitcnt lgkmcnt(3)
    v_mfma_f32_32x32x16_bf16 v[16:31], v[96:99], v[240:243], v[16:31]
    ds_read_b128 v[92:95], v2 offset:52224
    v_exp_f32_e32 v69, v69
    v_exp_f32_e32 v70, v70
    v_mfma_f32_32x32x16_bf16 v[16:31], v[100:103], v[244:247], v[16:31]
    ds_read_b128 v[96:99], v2 offset:53248
    v_exp_f32_e32 v71, v71
    v_fma_f32 v68, v68, v10, v10
    v_fma_f32 v69, v69, v10, v10
    v_fma_f32 v70, v70, v10, v10
    v_mfma_f32_32x32x16_bf16 v[16:31], v[104:107], v[248:251], v[16:31]
    ds_read_b128 v[100:103], v2 offset:54272
    v_fma_f32 v71, v71, v10, v10
    v_rcp_f32_e32 v68, v68
    buffer_load_dwordx4 v1, s[4:7], s54 offen offset:1024 lds
    v_mfma_f32_32x32x16_bf16 v[16:31], v[108:111], v[252:255], v[16:31]
    ds_read_b128 v[104:107], v2 offset:55296
    v_rcp_f32_e32 v69, v69
    v_rcp_f32_e32 v70, v70
    v_rcp_f32_e32 v71, v71
    v_mul_f32_e32 v68, v76, v68
    v_mul_f32_e32 v69, v77, v69
    v_mul_f32_e32 v70, v78, v70
    v_mul_f32_e32 v71, v79, v71
    v_cvt_pk_bf16_f32 v66, v68, v69
    v_cvt_pk_bf16_f32 v67, v70, v71
    s_add_u32 s50, s70, 98304
    buffer_store_dwordx4 v[64:67], v1, s[4:7], s50 offen sc1
    v_mfma_f32_32x32x8_bf16 v[32:47], v[120:121], v[12:13], 0
    buffer_load_dwordx4 a[56:59], v1, s[4:7], s55 offen offset:2048
    buffer_load_dwordx4 v1, s[4:7], s54 offen offset:2048 lds
    s_waitcnt lgkmcnt(3)
    v_mfma_f32_32x32x16_bf16 v[32:47], v[80:83], v[128:131], v[32:47]
    ds_read_b128 v[108:111], v2 offset:56320
    v_mfma_f32_32x32x16_bf16 v[32:47], v[84:87], v[132:135], v[32:47]
    ds_read_b128 v[80:83], v2 offset:57344
    buffer_load_dwordx4 a[60:63], v1, s[4:7], s55 offen offset:3072
    v_mfma_f32_32x32x16_bf16 v[32:47], v[88:91], v[136:139], v[32:47]
    ds_read_b128 v[84:87], v2 offset:58368
    v_mul_f32_e32 v16, v9, v16
    buffer_load_dwordx4 v1, s[4:7], s54 offen offset:3072 lds
    v_mul_f32_e32 v17, v9, v17
    v_mul_f32_e32 v18, v9, v18
    v_mfma_f32_32x32x16_bf16 v[32:47], v[92:95], v[140:143], v[32:47]
    ds_read_b128 v[88:91], v2 offset:59392
    v_mul_f32_e32 v19, v9, v19
    v_exp_f32_e32 v16, v16
    s_waitcnt lgkmcnt(3)
    v_mfma_f32_32x32x16_bf16 v[32:47], v[96:99], v[144:147], v[32:47]
    ds_read_b128 v[92:95], v2 offset:60416
    v_exp_f32_e32 v17, v17
    v_exp_f32_e32 v18, v18
    v_mfma_f32_32x32x16_bf16 v[32:47], v[100:103], v[148:151], v[32:47]
    ds_read_b128 v[96:99], v2 offset:61440
    v_exp_f32_e32 v19, v19
    v_fma_f32 v16, v16, v10, v10
    v_fma_f32 v17, v17, v10, v10
    v_fma_f32 v18, v18, v10, v10
    v_mfma_f32_32x32x16_bf16 v[32:47], v[104:107], v[152:155], v[32:47]
    ds_read_b128 v[100:103], v2 offset:62464
    v_fma_f32 v19, v19, v10, v10
    v_rcp_f32_e32 v16, v16
    v_rcp_f32_e32 v17, v17
    v_mfma_f32_32x32x16_bf16 v[32:47], v[108:111], v[156:159], v[32:47]
    ds_read_b128 v[104:107], v2 offset:63488
    s_waitcnt vmcnt(8)
    v_cmp_ne_u32_e32 vcc, s36, v127
    s_cbranch_vccnz L_spin_17
L_back_18:
    v_rcp_f32_e32 v18, v18
    s_waitcnt lgkmcnt(3)
    v_mfma_f32_32x32x16_bf16 v[32:47], v[80:83], v[160:163], v[32:47]
    ds_read_b128 v[108:111], v2 offset:64512
    s_add_u32 s55, s55, 4096
    buffer_load_dwordx4 a[64:67], v1, s[4:7], s55 offen offset:0
    v_rcp_f32_e32 v19, v19
    v_mfma_f32_32x32x16_bf16 v[32:47], v[84:87], v[164:167], v[32:47]
    ds_read_b128 v[80:83], v3 offset:0
    v_mul_f32_e32 v16, v24, v16
    v_mul_f32_e32 v17, v25, v17
    v_mul_f32_e32 v18, v26, v18
    v_mul_f32_e32 v19, v27, v19
    v_cvt_pk_bf16_f32 v16, v16, v17
    v_mfma_f32_32x32x16_bf16 v[32:47], v[88:91], v[168:171], v[32:47]
    ds_read_b128 v[84:87], v3 offset:1024
    s_add_u32 m0, s49, 16384
    s_add_u32 s54, s61, 0
    buffer_load_dwordx4 v1, s[4:7], s54 offen sc1 lds
    v_cvt_pk_bf16_f32 v17, v18, v19
    v_mfma_f32_32x32x16_bf16 v[32:47], v[92:95], v[172:175], v[32:47]
    ds_read_b128 v[88:91], v3 offset:2048
    v_mul_f32_e32 v20, v9, v20
    v_mul_f32_e32 v21, v9, v21
    v_mul_f32_e32 v22, v9, v22
    v_mul_f32_e32 v23, v9, v23
    s_waitcnt lgkmcnt(3)
    v_mfma_f32_32x32x16_bf16 v[32:47], v[96:99], v[176:179], v[32:47]
    ds_read_b128 v[92:95], v3 offset:3072
    buffer_load_dwordx4 a[68:71], v1, s[4:7], s55 offen offset:1024
    v_exp_f32_e32 v20, v20
    v_mfma_f32_32x32x16_bf16 v[32:47], v[100:103], v[180:183], v[32:47]
    ds_read_b128 v[96:99], v3 offset:4096
    buffer_load_dwordx4 v1, s[4:7], s54 offen offset:1024 sc1 lds
    v_exp_f32_e32 v21, v21
    v_mfma_f32_32x32x16_bf16 v[32:47], v[104:107], v[184:187], v[32:47]
    ds_read_b128 v[100:103], v3 offset:5120
    v_exp_f32_e32 v22, v22
    v_exp_f32_e32 v23, v23
    v_fma_f32 v20, v20, v10, v10
    v_mfma_f32_32x32x16_bf16 v[32:47], v[108:111], v[188:191], v[32:47]
    ds_read_b128 v[104:107], v3 offset:6144
    buffer_load_dwordx4 v1, s[4:7], s54 offen offset:2048 sc1 lds
    v_fma_f32 v21, v21, v10, v10
    v_fma_f32 v22, v22, v10, v10
    s_waitcnt lgkmcnt(3)
    v_mfma_f32_32x32x16_bf16 v[32:47], v[80:83], v[192:195], v[32:47]
    ds_read_b128 v[108:111], v3 offset:7168
    v_fma_f32 v23, v23, v10, v10
    v_rcp_f32_e32 v20, v20
    v_rcp_f32_e32 v21, v21
    v_mfma_f32_32x32x16_bf16 v[32:47], v[84:87], v[196:199], v[32:47]
    ds_read_b128 v[80:83], v3 offset:8192
    buffer_load_dwordx4 a[72:75], v1, s[4:7], s55 offen offset:2048
    buffer_load_dwordx4 v1, s[4:7], s54 offen offset:3072 sc1 lds
    v_mfma_f32_32x32x16_bf16 v[32:47], v[88:91], v[200:203], v[32:47]
    ds_read_b128 v[84:87], v3 offset:9216
    v_rcp_f32_e32 v22, v22
    v_rcp_f32_e32 v23, v23
    v_mul_f32_e32 v20, v28, v20
    v_mfma_f32_32x32x16_bf16 v[32:47], v[92:95], v[204:207], v[32:47]
    ds_read_b128 v[88:91], v3 offset:10240
    v_mul_f32_e32 v21, v29, v21
    v_mul_f32_e32 v22, v30, v22
    v_mul_f32_e32 v23, v31, v23
    v_cvt_pk_bf16_f32 v18, v20, v21
    s_waitcnt lgkmcnt(3)
    v_mfma_f32_32x32x16_bf16 v[32:47], v[96:99], v[208:211], v[32:47]
    ds_read_b128 v[92:95], v3 offset:11264
    v_cvt_pk_bf16_f32 v19, v22, v23
    s_add_u32 s50, s70, 131072
    buffer_store_dwordx4 v[16:19], v1, s[4:7], s50 offen sc1
    v_mfma_f32_32x32x16_bf16 v[32:47], v[100:103], v[212:215], v[32:47]
    ds_read_b128 v[96:99], v3 offset:12288
    s_add_u32 m0, s49, 32768
    s_add_u32 s54, s61, 16384
    buffer_load_dwordx4 v1, s[4:7], s54 offen sc1 lds
    ds_read_b64 v[122:123], v5 offset:1536
    v_mfma_f32_32x32x16_bf16 v[32:47], v[104:107], v[216:219], v[32:47]
    ds_read_b128 v[100:103], v3 offset:13312
    buffer_load_dwordx4 a[76:79], v1, s[4:7], s55 offen offset:3072
    v_mfma_f32_32x32x16_bf16 v[32:47], v[108:111], v[220:223], v[32:47]
    ds_read_b128 v[104:107], v3 offset:14336
    s_waitcnt lgkmcnt(4)
    v_mfma_f32_32x32x16_bf16 v[32:47], v[80:83], v[224:227], v[32:47]
    ds_read_b128 v[108:111], v3 offset:15360
    buffer_load_dwordx4 v1, s[4:7], s54 offen offset:1024 sc1 lds
    s_waitcnt vmcnt(11)
    s_barrier
    v_mfma_f32_32x32x16_bf16 v[32:47], v[84:87], v[228:231], v[32:47]
    ds_read_b128 v[80:83], v2 offset:0
    v_mov_b32_e32 v14, s36
    s_cmp_lg_u32 s43, 0
    s_mov_b64 exec, 1
    s_cbranch_scc1 L_slow_19
    buffer_store_dword v14, off, s[4:7], s75 offset:768
L_back_20:
    s_mov_b64 exec, -1
    v_mfma_f32_32x32x16_bf16 v[32:47], v[88:91], v[232:235], v[32:47]
    ds_read_b128 v[84:87], v2 offset:1024
    buffer_load_dwordx4 v1, s[4:7], s54 offen offset:2048 sc1 lds
    v_mfma_f32_32x32x16_bf16 v[32:47], v[92:95], v[236:239], v[32:47]
    ds_read_b128 v[88:91], v2 offset:2048
    s_add_u32 s55, s55, 4096
    buffer_load_dwordx4 a[80:83], v1, s[4:7], s55 offen offset:0
    s_waitcnt lgkmcnt(3)
    v_mfma_f32_32x32x16_bf16 v[32:47], v[96:99], v[240:243], v[32:47]
    ds_read_b128 v[92:95], v2 offset:3072
    buffer_load_dwordx4 v1, s[4:7], s54 offen offset:3072 sc1 lds
    v_mfma_f32_32x32x16_bf16 v[32:47], v[100:103], v[244:247], v[32:47]
    ds_read_b128 v[96:99], v2 offset:4096
    v_mfma_f32_32x32x16_bf16 v[32:47], v[104:107], v[248:251], v[32:47]
    ds_read_b128 v[100:103], v2 offset:5120
    v_mfma_f32_32x32x16_bf16 v[32:47], v[108:111], v[252:255], v[32:47]
    ds_read_b128 v[104:107], v2 offset:6144
    v_mfma_f32_32x32x8_bf16 v[48:63], v[122:123], v[12:13], 0
    s_add_u32 m0, s49, 49152
    s_add_u32 s54, s61, 32768
    buffer_load_dwordx4 v1, s[4:7], s54 offen sc1 lds
    s_waitcnt lgkmcnt(3)
    v_mfma_f32_32x32x16_bf16 v[48:63], v[80:83], v[128:131], v[48:63]
    ds_read_b128 v[108:111], v2 offset:7168
    buffer_load_dwordx4 a[84:87], v1, s[4:7], s55 offen offset:1024
    v_mfma_f32_32x32x16_bf16 v[48:63], v[84:87], v[132:135], v[48:63]
    ds_read_b128 v[80:83], v2 offset:8192
    buffer_load_dword v127, v15, s[4:7], s76 offen offset:768 sc1
    v_mfma_f32_32x32x16_bf16 v[48:63], v[88:91], v[136:139], v[48:63]
    ds_read_b128 v[84:87], v2 offset:9216
    v_mul_f32_e32 v32, v9, v32
    buffer_load_dwordx4 v1, s[4:7], s54 offen offset:1024 sc1 lds
    v_mul_f32_e32 v33, v9, v33
    v_mul_f32_e32 v34, v9, v34
    v_mfma_f32_32x32x16_bf16 v[48:63], v[92:95], v[140:143], v[48:63]
    ds_read_b128 v[88:91], v2 offset:10240
    v_mul_f32_e32 v35, v9, v35
    v_exp_f32_e32 v32, v32
    s_waitcnt lgkmcnt(3)
    v_mfma_f32_32x32x16_bf16 v[48:63], v[96:99], v[144:147], v[48:63]
    ds_read_b128 v[92:95], v2 offset:11264
    v_exp_f32_e32 v33, v33
    buffer_load_dwordx4 v1, s[4:7], s54 offen offset:2048 sc1 lds
    v_mfma_f32_32x32x16_bf16 v[48:63], v[100:103], v[148:151], v[48:63]
    ds_read_b128 v[96:99], v2 offset:12288
    buffer_load_dwordx4 a[88:91], v1, s[4:7], s55 offen offset:2048
    v_exp_f32_e32 v34, v34
    v_mfma_f32_32x32x16_bf16 v[48:63], v[104:107], v[152:155], v[48:63]
    ds_read_b128 v[100:103], v2 offset:13312
    v_exp_f32_e32 v35, v35
    v_fma_f32 v32, v32, v10, v10
    v_fma_f32 v33, v33, v10, v10
    v_fma_f32 v34, v34, v10, v10
    v_mfma_f32_32x32x16_bf16 v[48:63], v[108:111], v[156:159], v[48:63]
    ds_read_b128 v[104:107], v2 offset:14336
    buffer_load_dwordx4 v1, s[4:7], s54 offen offset:3072 sc1 lds
    v_fma_f32 v35, v35, v10, v10
    s_waitcnt lgkmcnt(3)
    v_mfma_f32_32x32x16_bf16 v[48:63], v[80:83], v[160:163], v[48:63]
    ds_read_b128 v[108:111], v2 offset:15360
    v_rcp_f32_e32 v32, v32
    v_rcp_f32_e32 v33, v33
    v_mfma_f32_32x32x16_bf16 v[48:63], v[84:87], v[164:167], v[48:63]
    ds_read_b128 v[80:83], v2 offset:16384
    buffer_load_dwordx4 a[92:95], v1, s[4:7], s55 offen offset:3072
    v_rcp_f32_e32 v34, v34
    v_mfma_f32_32x32x16_bf16 v[48:63], v[88:91], v[168:171], v[48:63]
    ds_read_b128 v[84:87], v2 offset:17408
    v_and_b32_e32 v116, 15, v0
    v_lshlrev_b32_e32 v116, 6, v116
    s_lshl_b32 s88, s39, 10
    s_add_u32 s88, s88, 49152
    v_mfma_f32_32x32x16_bf16 v[48:63], v[92:95], v[172:175], v[48:63]
    ds_read_b128 v[88:91], v2 offset:18432
    v_rcp_f32_e32 v35, v35
    v_mul_f32_e32 v32, v40, v32
    v_mul_f32_e32 v33, v41, v33
    s_waitcnt lgkmcnt(3)
    v_mfma_f32_32x32x16_bf16 v[48:63], v[96:99], v[176:179], v[48:63]
    ds_read_b128 v[92:95], v2 offset:19456
    s_add_u32 m0, s49, 0
    s_add_u32 s54, s61, 49152
    buffer_load_dwordx4 v1, s[4:7], s54 offen sc1 lds
    v_mul_f32_e32 v34, v42, v34
    v_mfma_f32_32x32x16_bf16 v[48:63], v[100:103], v[180:183], v[48:63]
    ds_read_b128 v[96:99], v2 offset:20480
    v_mul_f32_e32 v35, v43, v35
    v_cvt_pk_bf16_f32 v32, v32, v33
    v_cvt_pk_bf16_f32 v33, v34, v35
    v_mul_f32_e32 v36, v9, v36
    v_mul_f32_e32 v37, v9, v37
    v_mfma_f32_32x32x16_bf16 v[48:63], v[104:107], v[184:187], v[48:63]
    ds_read_b128 v[100:103], v2 offset:21504
    v_mul_f32_e32 v38, v9, v38
    buffer_load_dwordx4 v1, s[4:7], s54 offen offset:1024 sc1 lds
    v_mul_f32_e32 v39, v9, v39
    v_mfma_f32_32x32x16_bf16 v[48:63], v[108:111], v[188:191], v[48:63]
    ds_read_b128 v[104:107], v2 offset:22528
    v_exp_f32_e32 v36, v36
    v_exp_f32_e32 v37, v37
    s_waitcnt lgkmcnt(3)
    v_mfma_f32_32x32x16_bf16 v[48:63], v[80:83], v[192:195], v[48:63]
    ds_read_b128 v[108:111], v2 offset:23552
    s_add_u32 s55, s55, 4096
    buffer_load_dwordx4 a[96:99], v1, s[4:7], s55 offen offset:0
    v_exp_f32_e32 v38, v38
    v_mfma_f32_32x32x16_bf16 v[48:63], v[84:87], v[196:199], v[48:63]
    ds_read_b128 v[80:83], v2 offset:24576
    buffer_load_dwordx4 v1, s[4:7], s54 offen offset:2048 sc1 lds
    v_exp_f32_e32 v39, v39
    v_fma_f32 v36, v36, v10, v10
    v_mfma_f32_32x32x16_bf16 v[48:63], v[88:91], v[200:203], v[48:63]
    ds_read_b128 v[84:87], v2 offset:25600
    s_waitcnt vmcnt(9)
    v_cmp_ne_u32_e32 vcc, s36, v127
    s_cbranch_vccnz L_spin_21
L_back_22:
    buffer_load_dwordx4 v1, s[4:7], s54 offen offset:3072 sc1 lds
    v_fma_f32 v37, v37, v10, v10
    v_mfma_f32_32x32x16_bf16 v[48:63], v[92:95], v[204:207], v[48:63]
    ds_read_b128 v[88:91], v2 offset:26624
    v_fma_f32 v38, v38, v10, v10
    v_fma_f32 v39, v39, v10, v10
    v_rcp_f32_e32 v36, v36
    s_waitcnt lgkmcnt(3)
    v_mfma_f32_32x32x16_bf16 v[48:63], v[96:99], v[208:211], v[48:63]
    ds_read_b128 v[92:95], v2 offset:27648
    v_rcp_f32_e32 v37, v37
    v_rcp_f32_e32 v38, v38
    v_mfma_f32_32x32x16_bf16 v[48:63], v[100:103], v[212:215], v[48:63]
    ds_read_b128 v[96:99], v2 offset:28672
    v_rcp_f32_e32 v39, v39
    buffer_load_dwordx4 a[100:103], v1, s[4:7], s55 offen offset:1024
    v_mul_f32_e32 v36, v44, v36
    v_mfma_f32_32x32x16_bf16 v[48:63], v[104:107], v[216:219], v[48:63]
    ds_read_b128 v[100:103], v2 offset:29696
    s_add_u32 m0, s49, 98304
    s_add_u32 s54, s61, 65536
    buffer_load_dwordx4 v1, s[4:7], s54 offen sc1 lds
    v_mul_f32_e32 v37, v45, v37
    v_mfma_f32_32x32x16_bf16 v[48:63], v[108:111], v[220:223], v[48:63]
    ds_read_b128 v[104:107], v2 offset:30720
    v_mul_f32_e32 v38, v46, v38
    v_mul_f32_e32 v39, v47, v39
    v_cvt_pk_bf16_f32 v34, v36, v37
    v_cvt_pk_bf16_f32 v35, v38, v39
    s_add_u32 s50, s70, 163840
    buffer_store_dwordx4 v[32:35], v1, s[4:7], s50 offen sc1
    s_waitcnt lgkmcnt(3)
    v_mfma_f32_32x32x16_bf16 v[48:63], v[80:83], v[224:227], v[48:63]
    ds_read_b128 v[108:111], v2 offset:31744
    buffer_load_dwordx4 v1, s[4:7], s54 offen offset:1024 sc1 lds
    v_mfma_f32_32x32x16_bf16 v[48:63], v[84:87], v[228:231], v[48:63]
    buffer_load_dwordx4 a[104:107], v1, s[4:7], s55 offen offset:2048
    buffer_load_dwordx4 v1, s[4:7], s54 offen offset:2048 sc1 lds
    v_mfma_f32_32x32x16_bf16 v[48:63], v[88:91], v[232:235], v[48:63]
    v_mfma_f32_32x32x16_bf16 v[48:63], v[92:95], v[236:239], v[48:63]
    buffer_load_dwordx4 v1, s[4:7], s54 offen offset:3072 sc1 lds
    s_waitcnt lgkmcnt(0)
    v_mfma_f32_32x32x16_bf16 v[48:63], v[96:99], v[240:243], v[48:63]
    v_mfma_f32_32x32x16_bf16 v[48:63], v[100:103], v[244:247], v[48:63]
    buffer_load_dwordx4 a[108:111], v1, s[4:7], s55 offen offset:3072
    v_mfma_f32_32x32x16_bf16 v[48:63], v[104:107], v[248:251], v[48:63]
    s_add_u32 m0, s49, 114688
    s_add_u32 s54, s61, 81920
    buffer_load_dwordx4 v1, s[4:7], s54 offen sc1 lds
    v_mfma_f32_32x32x16_bf16 v[48:63], v[108:111], v[252:255], v[48:63]
    buffer_load_dwordx4 v1, s[4:7], s54 offen offset:1024 sc1 lds
    s_nop 10
    v_mul_f32_e32 v48, v9, v48
    v_mul_f32_e32 v49, v9, v49
    v_mul_f32_e32 v50, v9, v50
    v_mul_f32_e32 v51, v9, v51
    v_exp_f32_e32 v48, v48
    v_exp_f32_e32 v49, v49
    v_exp_f32_e32 v50, v50
    v_exp_f32_e32 v51, v51
    v_fma_f32 v48, v48, v10, v10
    v_fma_f32 v49, v49, v10, v10
    v_fma_f32 v50, v50, v10, v10
    v_fma_f32 v51, v51, v10, v10
    v_rcp_f32_e32 v48, v48
    v_rcp_f32_e32 v49, v49
    v_rcp_f32_e32 v50, v50
    v_rcp_f32_e32 v51, v51
    v_mul_f32_e32 v48, v56, v48
    v_mul_f32_e32 v49, v57, v49
    buffer_load_dwordx4 v1, s[4:7], s54 offen offset:2048 sc1 lds
    v_mul_f32_e32 v50, v58, v50
    v_mul_f32_e32 v51, v59, v51
    v_cvt_pk_bf16_f32 v48, v48, v49
    v_cvt_pk_bf16_f32 v49, v50, v51
    v_mul_f32_e32 v52, v9, v52
    v_mul_f32_e32 v53, v9, v53
    v_mul_f32_e32 v54, v9, v54
    v_mul_f32_e32 v55, v9, v55
    v_exp_f32_e32 v52, v52
    v_exp_f32_e32 v53, v53
    v_exp_f32_e32 v54, v54
    v_exp_f32_e32 v55, v55
    v_fma_f32 v52, v52, v10, v10
    v_fma_f32 v53, v53, v10, v10
    v_fma_f32 v54, v54, v10, v10
    v_fma_f32 v55, v55, v10, v10
    v_rcp_f32_e32 v52, v52
    v_rcp_f32_e32 v53, v53
    v_rcp_f32_e32 v54, v54
    buffer_load_dwordx4 v1, s[4:7], s54 offen offset:3072 sc1 lds
    v_rcp_f32_e32 v55, v55
    v_mul_f32_e32 v52, v60, v52
    v_mul_f32_e32 v53, v61, v53
    v_mul_f32_e32 v54, v62, v54
    v_mul_f32_e32 v55, v63, v55
    v_cvt_pk_bf16_f32 v50, v52, v53
    v_cvt_pk_bf16_f32 v51, v54, v55
    s_add_u32 s50, s70, 196608
    buffer_store_dwordx4 v[48:51], v1, s[4:7], s50 offen sc1
    s_mul_i32 s50, s47, 3072
    s_lshl_b32 s51, s47, 10
    s_add_u32 s51, s51, 1024
    v_add_u32_e32 v192, s50, v1
    v_add_u32_e32 v195, s51, v1
    v_add_u32_e32 v193, s50, v2
    v_add_u32_e32 v196, s51, v2
    v_add_u32_e32 v194, s50, v3
    v_add_u32_e32 v197, s51, v3
    s_barrier
    ds_read_b128 v[128:131], v195 offset:16384
    ds_read_b128 v[132:135], v192 offset:16384
    ds_read_b128 v[136:139], v195 offset:20480
    ds_read_b128 v[140:143], v192 offset:20480
    ds_read_b128 v[144:147], v195 offset:24576
    ds_read_b128 v[148:151], v192 offset:24576
    v_mov_b32_e32 v14, s36
    s_cmp_lg_u32 s43, 0
    s_mov_b64 exec, 1
    s_waitcnt vmcnt(10)
    s_cbranch_scc1 L_slow_26
    buffer_store_dword v14, off, s[4:7], s75 offset:896
L_back_27:
    s_mov_b64 exec, -1
    s_xor_b32 s50, s49, 8192
    s_add_u32 s50, s50, 16384
    v_add_u32_e32 v112, s50, v1
    s_add_u32 s50, s49, 16384
    v_add_u32_e32 v113, s50, v1
    v_and_b32_e32 v114, 31, v0
    v_lshrrev_b32_e32 v115, 5, v0
    v_lshlrev_b32_e32 v114, 4, v114
    v_lshl_add_u32 v114, v115, 2, v114
    s_add_u32 s64, s64, s43
    s_add_u32 s65, s65, s43
    s_add_u32 s66, s66, s43
    s_add_u32 s67, s67, s43
    v_accvgpr_read_b32 v16, a224
    v_accvgpr_read_b32 v17, a225
    v_accvgpr_read_b32 v18, a226
    v_accvgpr_read_b32 v19, a227
    v_accvgpr_read_b32 v20, a228
    v_accvgpr_read_b32 v21, a229
    v_accvgpr_read_b32 v22, a230
    v_accvgpr_read_b32 v23, a231
    v_accvgpr_read_b32 v24, a232
    v_accvgpr_read_b32 v25, a233
    v_accvgpr_read_b32 v26, a234
    v_accvgpr_read_b32 v27, a235
    v_accvgpr_read_b32 v28, a236
    v_accvgpr_read_b32 v29, a237
    v_accvgpr_read_b32 v30, a238
    v_accvgpr_read_b32 v31, a239
    s_waitcnt lgkmcnt(4)
    v_mfma_f32_32x32x16_bf16 v[32:47], a[0:3], v[128:131], 0
    ds_read_b128 v[152:155], v195 offset:28672
    v_mfma_f32_32x32x16_bf16 v[16:31], a[0:3], v[132:135], v[16:31]
    ds_read_b128 v[156:159], v192 offset:28672
    s_add_u32 s55, s55, 4096
    buffer_load_dwordx4 a[112:115], v1, s[4:7], s55 offen offset:0
    s_waitcnt lgkmcnt(4)
    v_mfma_f32_32x32x16_bf16 v[32:47], a[4:7], v[136:139], v[32:47]
    ds_read_b128 v[160:163], v195 offset:32768
    s_add_u32 m0, s49, 131072
    s_add_u32 s54, s61, 98304
    buffer_load_dwordx4 v1, s[4:7], s54 offen sc1 lds
    v_mfma_f32_32x32x16_bf16 v[16:31], a[4:7], v[140:143], v[16:31]
    ds_read_b128 v[164:167], v192 offset:32768
    s_waitcnt lgkmcnt(4)
    v_mfma_f32_32x32x16_bf16 v[32:47], a[8:11], v[144:147], v[32:47]
    ds_read_b128 v[168:171], v195 offset:36864
    buffer_load_dword v127, v15, s[4:7], s76 offen offset:896 sc1
    buffer_load_dwordx4 v1, s[4:7], s54 offen offset:1024 sc1 lds
    v_mfma_f32_32x32x16_bf16 v[16:31], a[8:11], v[148:151], v[16:31]
    ds_read_b128 v[172:175], v192 offset:36864
    buffer_load_dwordx4 a[116:119], v1, s[4:7], s55 offen offset:1024
    s_waitcnt lgkmcnt(4)
    v_mfma_f32_32x32x16_bf16 v[32:47], a[12:15], v[152:155], v[32:47]
    ds_read_b128 v[176:179], v195 offset:40960
    buffer_load_dwordx4 v1, s[4:7], s54 offen offset:2048 sc1 lds
    v_mfma_f32_32x32x16_bf16 v[16:31], a[12:15], v[156:159], v[16:31]
    ds_read_b128 v[180:183], v192 offset:40960
    buffer_load_dwordx4 a[120:123], v1, s[4:7], s55 offen offset:2048
    s_waitcnt lgkmcnt(4)
    v_mfma_f32_32x32x16_bf16 v[32:47], a[16:19], v[160:163], v[32:47]
    ds_read_b128 v[184:187], v195 offset:45056
    buffer_load_dwordx4 v1, s[4:7], s54 offen offset:3072 sc1 lds
    v_mfma_f32_32x32x16_bf16 v[16:31], a[16:19], v[164:167], v[16:31]
    ds_read_b128 v[188:191], v192 offset:45056
    s_barrier
    s_waitcnt lgkmcnt(4)
    v_mfma_f32_32x32x16_bf16 v[32:47], a[20:23], v[168:171], v[32:47]
    ds_read_b128 v[128:131], v195 offset:49152
    buffer_load_dwordx4 a[124:127], v1, s[4:7], s55 offen offset:3072
    v_mfma_f32_32x32x16_bf16 v[16:31], a[20:23], v[172:175], v[16:31]
    ds_read_b128 v[132:135], v192 offset:49152
    s_add_u32 m0, s49, 65536
    s_add_u32 s54, s61, 114688
    buffer_load_dwordx4 v1, s[4:7], s54 offen sc1 lds
    s_waitcnt lgkmcnt(4)
    v_mfma_f32_32x32x16_bf16 v[32:47], a[24:27], v[176:179], v[32:47]
    ds_read_b128 v[136:139], v195 offset:53248
    v_mfma_f32_32x32x16_bf16 v[16:31], a[24:27], v[180:183], v[16:31]
    ds_read_b128 v[140:143], v192 offset:53248
    s_add_u32 s55, s55, 4096
    buffer_load_dwordx4 a[128:131], v1, s[4:7], s55 offen offset:0
    s_waitcnt lgkmcnt(4)
    v_mfma_f32_32x32x16_bf16 v[32:47], a[28:31], v[184:187], v[32:47]
    ds_read_b128 v[144:147], v195 offset:57344
    buffer_load_dwordx4 v1, s[4:7], s54 offen offset:1024 sc1 lds
    v_mfma_f32_32x32x16_bf16 v[16:31], a[28:31], v[188:191], v[16:31]
    ds_read_b128 v[148:151], v192 offset:57344
    s_waitcnt lgkmcnt(4)
    v_mfma_f32_32x32x16_bf16 v[32:47], a[32:35], v[128:131], v[32:47]
    ds_read_b128 v[152:155], v195 offset:61440
    buffer_load_dwordx4 a[132:135], v1, s[4:7], s55 offen offset:1024
    buffer_load_dwordx4 v1, s[4:7], s54 offen offset:2048 sc1 lds
    v_mfma_f32_32x32x16_bf16 v[16:31], a[32:35], v[132:135], v[16:31]
    ds_read_b128 v[156:159], v192 offset:61440
    s_waitcnt lgkmcnt(4)
    v_mfma_f32_32x32x16_bf16 v[32:47], a[36:39], v[136:139], v[32:47]
    ds_read_b128 v[160:163], v195 offset:0
    buffer_load_dwordx4 v1, s[4:7], s54 offen offset:3072 sc1 lds
    v_mfma_f32_32x32x16_bf16 v[16:31], a[36:39], v[140:143], v[16:31]
    ds_read_b128 v[164:167], v192 offset:0
    s_waitcnt vmcnt(12)
    v_cmp_ne_u32_e32 vcc, s36, v127
    s_cbranch_vccnz L_spin_28
L_back_29:
    buffer_load_dwordx4 a[136:139], v1, s[4:7], s55 offen offset:2048
    s_waitcnt lgkmcnt(4)
    v_mfma_f32_32x32x16_bf16 v[32:47], a[40:43], v[144:147], v[32:47]
    ds_read_b128 v[168:171], v195 offset:4096
    v_mov_b32_e32 v14, s36
    s_cmp_lg_u32 s43, 0
    s_mov_b64 exec, 1
    s_cbranch_scc1 L_slow_30
    buffer_store_dword v14, off, s[4:7], s75 offset:1024
L_back_31:
    s_mov_b64 exec, -1
    v_mfma_f32_32x32x16_bf16 v[16:31], a[40:43], v[148:151], v[16:31]
    ds_read_b128 v[172:175], v192 offset:4096
    buffer_load_dword v118, v116, s[4:7], s88 offen offset:0 sc1
    buffer_load_dwordx4 a[140:143], v1, s[4:7], s55 offen offset:3072
    s_waitcnt lgkmcnt(4)
    v_mfma_f32_32x32x16_bf16 v[32:47], a[44:47], v[152:155], v[32:47]
    ds_read_b128 v[176:179], v195 offset:8192
    s_add_u32 m0, s49, 81920
    s_add_u32 s54, s61, 131072
    buffer_load_dwordx4 v1, s[4:7], s54 offen sc1 lds
    v_mfma_f32_32x32x16_bf16 v[16:31], a[44:47], v[156:159], v[16:31]
    ds_read_b128 v[180:183], v192 offset:8192
    s_waitcnt lgkmcnt(4)
    v_mfma_f32_32x32x16_bf16 v[32:47], a[48:51], v[160:163], v[32:47]
    ds_read_b128 v[184:187], v195 offset:12288
    buffer_load_dwordx4 v1, s[4:7], s54 offen offset:1024 sc1 lds
    s_add_u32 s55, s55, 4096
    buffer_load_dwordx4 a[144:147], v1, s[4:7], s55 offen offset:0
    v_mfma_f32_32x32x16_bf16 v[16:31], a[48:51], v[164:167], v[16:31]
    ds_read_b128 v[188:191], v192 offset:12288
    s_barrier
    s_waitcnt lgkmcnt(4)
    v_mfma_f32_32x32x16_bf16 v[32:47], a[52:55], v[168:171], v[32:47]
    ds_read_b128 v[128:131], v196 offset:32768
    buffer_load_dwordx4 v1, s[4:7], s54 offen offset:2048 sc1 lds
    v_mfma_f32_32x32x16_bf16 v[16:31], a[52:55], v[172:175], v[16:31]
    ds_read_b128 v[132:135], v193 offset:32768
    buffer_load_dwordx4 a[148:151], v1, s[4:7], s55 offen offset:1024
    s_waitcnt lgkmcnt(4)
    v_mfma_f32_32x32x16_bf16 v[32:47], a[56:59], v[176:179], v[32:47]
    ds_read_b128 v[136:139], v196 offset:36864
    buffer_load_dwordx4 v1, s[4:7], s54 offen offset:3072 sc1 lds
    v_mfma_f32_32x32x16_bf16 v[16:31], a[56:59], v[180:183], v[16:31]
    ds_read_b128 v[140:143], v193 offset:36864
    s_waitcnt lgkmcnt(4)
    v_mfma_f32_32x32x16_bf16 v[32:47], a[60:63], v[184:187], v[32:47]
    ds_read_b128 v[144:147], v196 offset:40960
    buffer_load_dwordx4 a[152:155], v1, s[4:7], s55 offen offset:2048
    v_mfma_f32_32x32x16_bf16 v[16:31], a[60:63], v[188:191], v[16:31]
    ds_read_b128 v[148:151], v193 offset:40960
    s_add_u32 m0, s49, 16384
    s_add_u32 s54, s61, 147456
    buffer_load_dwordx4 v1, s[4:7], s54 offen sc1 lds
    s_waitcnt lgkmcnt(4)
    v_mfma_f32_32x32x16_bf16 v[32:47], a[64:67], v[128:131], v[32:47]
    ds_read_b128 v[152:155], v196 offset:45056
    v_mfma_f32_32x32x16_bf16 v[16:31], a[64:67], v[132:135], v[16:31]
    ds_read_b128 v[156:159], v193 offset:45056
    buffer_load_dwordx4 a[156:159], v1, s[4:7], s55 offen offset:3072
    buffer_load_dwordx4 v1, s[4:7], s54 offen offset:1024 sc1 lds
    s_waitcnt lgkmcnt(4)
    v_mfma_f32_32x32x16_bf16 v[32:47], a[68:71], v[136:139], v[32:47]
    ds_read_b128 v[160:163], v196 offset:49152
    v_mfma_f32_32x32x16_bf16 v[16:31], a[68:71], v[140:143], v[16:31]
    ds_read_b128 v[164:167], v193 offset:49152
    buffer_load_dwordx4 v1, s[4:7], s54 offen offset:2048 sc1 lds
    s_waitcnt lgkmcnt(4)
    v_mfma_f32_32x32x16_bf16 v[32:47], a[72:75], v[144:147], v[32:47]
    ds_read_b128 v[168:171], v196 offset:53248
    buffer_load_dword v127, v15, s[4:7], s76 offen offset:1024 sc1
    s_add_u32 s55, s55, 4096
    buffer_load_dwordx4 a[160:163], v1, s[4:7], s55 offen offset:0
    v_mfma_f32_32x32x16_bf16 v[16:31], a[72:75], v[148:151], v[16:31]
    ds_read_b128 v[172:175], v193 offset:53248
    buffer_load_dwordx4 v1, s[4:7], s54 offen offset:3072 sc1 lds
    s_waitcnt lgkmcnt(4)
    v_mfma_f32_32x32x16_bf16 v[32:47], a[76:79], v[152:155], v[32:47]
    ds_read_b128 v[176:179], v196 offset:57344
    v_mfma_f32_32x32x16_bf16 v[16:31], a[76:79], v[156:159], v[16:31]
    ds_read_b128 v[180:183], v193 offset:57344
    buffer_load_dwordx4 a[164:167], v1, s[4:7], s55 offen offset:1024
    s_waitcnt lgkmcnt(4)
    v_mfma_f32_32x32x16_bf16 v[32:47], a[80:83], v[160:163], v[32:47]
    ds_read_b128 v[184:187], v196 offset:61440
    s_add_u32 m0, s49, 32768
    s_add_u32 s54, s61, 163840
    buffer_load_dwordx4 v1, s[4:7], s54 offen sc1 lds
    v_mfma_f32_32x32x16_bf16 v[16:31], a[80:83], v[164:167], v[16:31]
    ds_read_b128 v[188:191], v193 offset:61440
    buffer_load_dwordx4 a[168:171], v1, s[4:7], s55 offen offset:2048
    s_waitcnt vmcnt(21)
    s_barrier
    s_waitcnt lgkmcnt(4)
    v_mfma_f32_32x32x16_bf16 v[32:47], a[84:87], v[168:171], v[32:47]
    ds_read_b128 v[128:131], v197 offset:0
    buffer_load_dwordx4 v1, s[4:7], s54 offen offset:1024 sc1 lds
    v_mfma_f32_32x32x16_bf16 v[16:31], a[84:87], v[172:175], v[16:31]
    ds_read_b128 v[132:135], v194 offset:0
    s_waitcnt lgkmcnt(4)
    v_mfma_f32_32x32x16_bf16 v[32:47], a[88:91], v[176:179], v[32:47]
    ds_read_b128 v[136:139], v197 offset:4096
    buffer_load_dwordx4 v1, s[4:7], s54 offen offset:2048 sc1 lds
    buffer_load_dwordx4 a[172:175], v1, s[4:7], s55 offen offset:3072
    v_mfma_f32_32x32x16_bf16 v[16:31], a[88:91], v[180:183], v[16:31]
    ds_read_b128 v[140:143], v194 offset:4096
    s_waitcnt lgkmcnt(4)
    v_mfma_f32_32x32x16_bf16 v[32:47], a[92:95], v[184:187], v[32:47]
    ds_read_b128 v[144:147], v197 offset:8192
    buffer_load_dwordx4 v1, s[4:7], s54 offen offset:3072 sc1 lds
    v_mfma_f32_32x32x16_bf16 v[16:31], a[92:95], v[188:191], v[16:31]
    ds_read_b128 v[148:151], v194 offset:8192
    s_add_u32 s55, s55, 4096
    buffer_load_dwordx4 a[176:179], v1, s[4:7], s55 offen offset:0
    s_waitcnt lgkmcnt(4)
    v_mfma_f32_32x32x16_bf16 v[32:47], a[96:99], v[128:131], v[32:47]
    ds_read_b128 v[152:155], v197 offset:12288
    s_add_u32 m0, s49, 49152
    s_add_u32 s54, s61, 180224
    buffer_load_dwordx4 v1, s[4:7], s54 offen sc1 lds
    v_mfma_f32_32x32x16_bf16 v[16:31], a[96:99], v[132:135], v[16:31]
    ds_read_b128 v[156:159], v194 offset:12288
    s_waitcnt lgkmcnt(4)
    v_mfma_f32_32x32x16_bf16 v[32:47], a[100:103], v[136:139], v[32:47]
    ds_read_b128 v[160:163], v196 offset:0
    buffer_load_dwordx4 a[180:183], v1, s[4:7], s55 offen offset:1024
    v_mfma_f32_32x32x16_bf16 v[16:31], a[100:103], v[140:143], v[16:31]
    ds_read_b128 v[164:167], v193 offset:0
    buffer_load_dwordx4 v1, s[4:7], s54 offen offset:1024 sc1 lds
    s_waitcnt lgkmcnt(4)
    v_mfma_f32_32x32x16_bf16 v[32:47], a[104:107], v[144:147], v[32:47]
    ds_read_b128 v[168:171], v196 offset:4096
    s_waitcnt vmcnt(26)
    v_cmp_ne_u32_e32 vcc, s36, v118
    s_cbranch_vccnz L_spin_24
L_back_25:
    v_mfma_f32_32x32x16_bf16 v[16:31], a[104:107], v[148:151], v[16:31]
    ds_read_b128 v[172:175], v193 offset:4096
    buffer_load_dwordx4 v1, s[4:7], s54 offen offset:2048 sc1 lds
    buffer_load_dwordx4 a[184:187], v1, s[4:7], s55 offen offset:2048
    s_waitcnt lgkmcnt(4)
    v_mfma_f32_32x32x16_bf16 v[32:47], a[108:111], v[152:155], v[32:47]
    ds_read_b128 v[176:179], v196 offset:8192
    v_mfma_f32_32x32x16_bf16 v[16:31], a[108:111], v[156:159], v[16:31]
    ds_read_b128 v[180:183], v193 offset:8192
    s_waitcnt vmcnt(15)
    v_cmp_ne_u32_e32 vcc, s36, v127
    s_cbranch_vccnz L_spin_32
L_back_33:
    buffer_load_dwordx4 v1, s[4:7], s54 offen offset:3072 sc1 lds
    s_waitcnt lgkmcnt(4)
    v_mfma_f32_32x32x16_bf16 v[32:47], a[112:115], v[160:163], v[32:47]
    ds_read_b128 v[184:187], v196 offset:12288
    buffer_load_dwordx4 a[188:191], v1, s[4:7], s55 offen offset:3072
    v_mfma_f32_32x32x16_bf16 v[16:31], a[112:115], v[164:167], v[16:31]
    ds_read_b128 v[188:191], v193 offset:12288
    s_waitcnt vmcnt(15)
    s_barrier
    s_waitcnt lgkmcnt(4)
    v_mfma_f32_32x32x16_bf16 v[32:47], a[116:119], v[168:171], v[32:47]
    ds_read_b128 v[128:131], v196 offset:16384
    s_add_u32 m0, s49, 0
    s_add_u32 s54, s61, 196608
    buffer_load_dwordx4 v1, s[4:7], s54 offen sc1 lds
    v_mfma_f32_32x32x16_bf16 v[16:31], a[116:119], v[172:175], v[16:31]
    ds_read_b128 v[132:135], v193 offset:16384
    s_add_u32 s55, s55, 4096
    buffer_load_dwordx4 a[192:195], v1, s[4:7], s55 offen offset:0
    s_waitcnt lgkmcnt(4)
    v_mfma_f32_32x32x16_bf16 v[32:47], a[120:123], v[176:179], v[32:47]
    ds_read_b128 v[136:139], v196 offset:20480
    buffer_load_dwordx4 v1, s[4:7], s54 offen offset:1024 sc1 lds
    v_mfma_f32_32x32x16_bf16 v[16:31], a[120:123], v[180:183], v[16:31]
    ds_read_b128 v[140:143], v193 offset:20480
    s_waitcnt lgkmcnt(4)
    v_mfma_f32_32x32x16_bf16 v[32:47], a[124:127], v[184:187], v[32:47]
    ds_read_b128 v[144:147], v196 offset:24576
    buffer_load_dwordx4 a[196:199], v1, s[4:7], s55 offen offset:1024
    buffer_load_dwordx4 v1, s[4:7], s54 offen offset:2048 sc1 lds
    v_mfma_f32_32x32x16_bf16 v[16:31], a[124:127], v[188:191], v[16:31]
    ds_read_b128 v[148:151], v193 offset:24576
    s_waitcnt lgkmcnt(4)
    v_mfma_f32_32x32x16_bf16 v[32:47], a[128:131], v[128:131], v[32:47]
    ds_read_b128 v[152:155], v196 offset:28672
    buffer_load_dwordx4 v1, s[4:7], s54 offen offset:3072 sc1 lds
    buffer_load_dwordx4 a[200:203], v1, s[4:7], s55 offen offset:2048
    v_mfma_f32_32x32x16_bf16 v[16:31], a[128:131], v[132:135], v[16:31]
    ds_read_b128 v[156:159], v193 offset:28672
    s_waitcnt lgkmcnt(4)
    v_mfma_f32_32x32x16_bf16 v[32:47], a[132:135], v[136:139], v[32:47]
    ds_read_b128 v[160:163], v195 offset:16384
    s_add_u32 m0, s49, 98304
    s_add_u32 s54, s61, 212992
    buffer_load_dwordx4 v1, s[4:7], s54 offen sc1 lds
    v_mfma_f32_32x32x16_bf16 v[16:31], a[132:135], v[140:143], v[16:31]
    ds_read_b128 v[164:167], v192 offset:16384
    buffer_load_dwordx4 a[204:207], v1, s[4:7], s55 offen offset:3072
    s_waitcnt lgkmcnt(4)
    v_mfma_f32_32x32x16_bf16 v[32:47], a[136:139], v[144:147], v[32:47]
    ds_read_b128 v[168:171], v195 offset:20480
    v_mfma_f32_32x32x16_bf16 v[16:31], a[136:139], v[148:151], v[16:31]
    ds_read_b128 v[172:175], v192 offset:20480
    buffer_load_dwordx4 v1, s[4:7], s54 offen offset:1024 sc1 lds
    s_waitcnt lgkmcnt(4)
    v_mfma_f32_32x32x16_bf16 v[32:47], a[140:143], v[152:155], v[32:47]
    ds_read_b128 v[176:179], v195 offset:24576
    s_add_u32 s55, s55, 4096
    buffer_load_dwordx4 a[208:211], v1, s[4:7], s55 offen offset:0
    v_lshlrev_b32_e32 v4, 7, v0
    v_mfma_f32_32x32x16_bf16 v[16:31], a[140:143], v[156:159], v[16:31]
    ds_read_b128 v[180:183], v192 offset:24576
    buffer_load_dwordx4 v1, s[4:7], s54 offen offset:2048 sc1 lds
    s_waitcnt lgkmcnt(4)
    v_mfma_f32_32x32x16_bf16 v[32:47], a[144:147], v[160:163], v[32:47]
    ds_read_b128 v[184:187], v195 offset:28672
    s_mov_b64 exec, 0xffff
    buffer_load_dword a255, v4, s[4:7], s64 offen sc1
    s_mov_b64 exec, -1
    v_mfma_f32_32x32x16_bf16 v[16:31], a[144:147], v[164:167], v[16:31]
    ds_read_b128 v[188:191], v192 offset:28672
    buffer_load_dwordx4 v1, s[4:7], s54 offen offset:3072 sc1 lds
    s_waitcnt vmcnt(15)
    s_barrier
    s_waitcnt lgkmcnt(4)
    v_mfma_f32_32x32x16_bf16 v[32:47], a[148:151], v[168:171], v[32:47]
    ds_read_b128 v[128:131], v195 offset:32768
    buffer_load_dwordx4 a[212:215], v1, s[4:7], s55 offen offset:1024
    v_mfma_f32_32x32x16_bf16 v[16:31], a[148:151], v[172:175], v[16:31]
    ds_read_b128 v[132:135], v192 offset:32768
    s_waitcnt lgkmcnt(4)
    v_mfma_f32_32x32x16_bf16 v[32:47], a[152:155], v[176:179], v[32:47]
    ds_read_b128 v[136:139], v195 offset:36864
    buffer_load_dwordx4 a[216:219], v1, s[4:7], s55 offen offset:2048
    v_mfma_f32_32x32x16_bf16 v[16:31], a[152:155], v[180:183], v[16:31]
    ds_read_b128 v[140:143], v192 offset:36864
    s_add_u32 m0, s49, 114688
    s_add_u32 s54, s82, 0
    buffer_load_dwordx4 v1, s[4:7], s54 offen lds
    s_waitcnt lgkmcnt(4)
    v_mfma_f32_32x32x16_bf16 v[32:47], a[156:159], v[184:187], v[32:47]
    ds_read_b128 v[144:147], v195 offset:40960
    s_and_b32 s50, s66, 0xfffffe00
    s_mov_b64 exec, 0xf
    buffer_load_dword a255, v4, s[4:7], s50 offen sc1
    s_mov_b64 exec, -1
    v_mfma_f32_32x32x16_bf16 v[16:31], a[156:159], v[188:191], v[16:31]
    ds_read_b128 v[148:151], v192 offset:40960
    buffer_load_dwordx4 a[220:223], v1, s[4:7], s55 offen offset:3072
    buffer_load_dwordx4 v1, s[4:7], s54 offen offset:1024 lds
    s_waitcnt lgkmcnt(4)
    v_mfma_f32_32x32x16_bf16 v[32:47], a[160:163], v[128:131], v[32:47]
    ds_read_b128 v[152:155], v195 offset:45056
    v_mfma_f32_32x32x16_bf16 v[16:31], a[160:163], v[132:135], v[16:31]
    ds_read_b128 v[156:159], v192 offset:45056
    buffer_load_dwordx4 v1, s[4:7], s54 offen offset:2048 lds
    s_waitcnt lgkmcnt(4)
    v_mfma_f32_32x32x16_bf16 v[32:47], a[164:167], v[136:139], v[32:47]
    ds_read_b128 v[160:163], v195 offset:49152
    v_mfma_f32_32x32x16_bf16 v[16:31], a[164:167], v[140:143], v[16:31]
    ds_read_b128 v[164:167], v192 offset:49152
    s_waitcnt lgkmcnt(4)
    v_mfma_f32_32x32x16_bf16 v[32:47], a[168:171], v[144:147], v[32:47]
    ds_read_b128 v[168:171], v195 offset:53248
    buffer_load_dwordx4 v1, s[4:7], s54 offen offset:3072 lds
    v_mfma_f32_32x32x16_bf16 v[16:31], a[168:171], v[148:151], v[16:31]
    ds_read_b128 v[172:175], v192 offset:53248
    s_waitcnt lgkmcnt(4)
    v_mfma_f32_32x32x16_bf16 v[32:47], a[172:175], v[152:155], v[32:47]
    ds_read_b128 v[176:179], v195 offset:57344
    v_mfma_f32_32x32x16_bf16 v[16:31], a[172:175], v[156:159], v[16:31]
    ds_read_b128 v[180:183], v192 offset:57344
    s_add_u32 m0, s49, 131072
    s_add_u32 s54, s82, 16384
    buffer_load_dwordx4 v1, s[4:7], s54 offen lds
    s_waitcnt lgkmcnt(4)
    v_mfma_f32_32x32x16_bf16 v[32:47], a[176:179], v[160:163], v[32:47]
    ds_read_b128 v[184:187], v195 offset:61440
    v_mfma_f32_32x32x16_bf16 v[16:31], a[176:179], v[164:167], v[16:31]
    ds_read_b128 v[188:191], v192 offset:61440
    s_waitcnt vmcnt(9)
    s_barrier
    s_waitcnt lgkmcnt(4)
    v_mfma_f32_32x32x16_bf16 v[32:47], a[180:183], v[168:171], v[32:47]
    ds_read_b128 v[128:131], v195 offset:0
    buffer_load_dwordx4 v1, s[4:7], s54 offen offset:1024 lds
    v_mfma_f32_32x32x16_bf16 v[16:31], a[180:183], v[172:175], v[16:31]
    ds_read_b128 v[132:135], v192 offset:0
    s_waitcnt lgkmcnt(4)
    v_mfma_f32_32x32x16_bf16 v[32:47], a[184:187], v[176:179], v[32:47]
    ds_read_b128 v[136:139], v195 offset:4096
    v_mfma_f32_32x32x16_bf16 v[16:31], a[184:187], v[180:183], v[16:31]
    ds_read_b128 v[140:143], v192 offset:4096
    buffer_load_dwordx4 v1, s[4:7], s54 offen offset:2048 lds
    s_waitcnt lgkmcnt(4)
    v_mfma_f32_32x32x16_bf16 v[32:47], a[188:191], v[184:187], v[32:47]
    ds_read_b128 v[144:147], v195 offset:8192
    v_mfma_f32_32x32x16_bf16 v[16:31], a[188:191], v[188:191], v[16:31]
    ds_read_b128 v[148:151], v192 offset:8192
    buffer_load_dwordx4 v1, s[4:7], s54 offen offset:3072 lds
    s_waitcnt lgkmcnt(4)
    v_mfma_f32_32x32x16_bf16 v[32:47], a[192:195], v[128:131], v[32:47]
    ds_read_b128 v[152:155], v195 offset:12288
    v_mfma_f32_32x32x16_bf16 v[16:31], a[192:195], v[132:135], v[16:31]
    ds_read_b128 v[156:159], v192 offset:12288
    s_waitcnt lgkmcnt(4)
    v_mfma_f32_32x32x16_bf16 v[32:47], a[196:199], v[136:139], v[32:47]
    ds_read_b128 v[160:163], v196 offset:32768
    s_add_u32 m0, s49, 65536
    s_add_u32 s54, s82, 32768
    buffer_load_dwordx4 v1, s[4:7], s54 offen lds
    v_mfma_f32_32x32x16_bf16 v[16:31], a[196:199], v[140:143], v[16:31]
    ds_read_b128 v[164:167], v193 offset:32768
    s_waitcnt lgkmcnt(4)
    v_mfma_f32_32x32x16_bf16 v[32:47], a[200:203], v[144:147], v[32:47]
    ds_read_b128 v[168:171], v196 offset:36864
    v_mfma_f32_32x32x16_bf16 v[16:31], a[200:203], v[148:151], v[16:31]
    ds_read_b128 v[172:175], v193 offset:36864
    s_waitcnt lgkmcnt(4)
    v_mfma_f32_32x32x16_bf16 v[32:47], a[204:207], v[152:155], v[32:47]
    ds_read_b128 v[176:179], v196 offset:40960
    buffer_load_dwordx4 v1, s[4:7], s54 offen offset:1024 lds
    v_mfma_f32_32x32x16_bf16 v[16:31], a[204:207], v[156:159], v[16:31]
    ds_read_b128 v[180:183], v193 offset:40960
    s_waitcnt lgkmcnt(4)
    v_mfma_f32_32x32x16_bf16 v[32:47], a[208:211], v[160:163], v[32:47]
    ds_read_b128 v[184:187], v196 offset:45056
    buffer_load_dwordx4 v1, s[4:7], s54 offen offset:2048 lds
    v_mfma_f32_32x32x16_bf16 v[16:31], a[208:211], v[164:167], v[16:31]
    ds_read_b128 v[188:191], v193 offset:45056
    s_waitcnt lgkmcnt(4)
    s_waitcnt vmcnt(14)
    v_mfma_f32_32x32x16_bf16 v[32:47], a[212:215], v[168:171], v[32:47]
    buffer_load_dwordx4 v1, s[4:7], s54 offen offset:3072 lds
    s_waitcnt lgkmcnt(2)
    s_waitcnt vmcnt(14)
    v_mfma_f32_32x32x16_bf16 v[32:47], a[216:219], v[176:179], v[32:47]
    s_waitcnt lgkmcnt(0)
    s_waitcnt vmcnt(11)
    v_mfma_f32_32x32x16_bf16 v[32:47], a[220:223], v[184:187], v[32:47]
    v_mfma_f32_32x32x16_bf16 v[16:31], a[212:215], v[172:175], v[16:31]
    v_mfma_f32_32x32x16_bf16 v[16:31], a[216:219], v[180:183], v[16:31]
    v_mfma_f32_32x32x16_bf16 v[16:31], a[220:223], v[188:191], v[16:31]
    s_nop 8
    ds_write_b128 v112, v[32:35] offset:0
    ds_write_b128 v112, v[36:39] offset:1024
    ds_write_b128 v112, v[40:43] offset:2048
    ds_write_b128 v112, v[44:47] offset:3072
    s_waitcnt vmcnt(4)
    s_waitcnt lgkmcnt(0)
    s_barrier
    ds_read_b128 v[48:51], v113 offset:0
    ds_read_b128 v[52:55], v113 offset:1024
    ds_read_b128 v[56:59], v113 offset:2048
    ds_read_b128 v[60:63], v113 offset:3072
    s_waitcnt lgkmcnt(3)
    v_pk_add_f32 v[16:17], v[16:17], v[48:49]
    v_pk_add_f32 v[18:19], v[18:19], v[50:51]
    s_waitcnt lgkmcnt(2)
    v_pk_add_f32 v[20:21], v[20:21], v[52:53]
    v_pk_add_f32 v[22:23], v[22:23], v[54:55]
    v_cvt_pk_bf16_f32 v32, v16, v17
    v_cvt_pk_bf16_f32 v33, v18, v19
    v_cvt_pk_bf16_f32 v34, v20, v21
    v_cvt_pk_bf16_f32 v35, v22, v23
    buffer_store_dwordx4 v[32:35], v1, s[4:7], s64 offen offset:0
    s_waitcnt lgkmcnt(1)
    v_pk_add_f32 v[24:25], v[24:25], v[56:57]
    v_pk_add_f32 v[26:27], v[26:27], v[58:59]
    s_waitcnt lgkmcnt(0)
    v_pk_add_f32 v[28:29], v[28:29], v[60:61]
    v_pk_add_f32 v[30:31], v[30:31], v[62:63]
    v_cvt_pk_bf16_f32 v36, v24, v25
    v_cvt_pk_bf16_f32 v37, v26, v27
    v_cvt_pk_bf16_f32 v38, v28, v29
    v_cvt_pk_bf16_f32 v39, v30, v31
    buffer_store_dwordx4 v[36:39], v1, s[4:7], s64 offen offset:1024
    v_pk_add_f32 v[48:49], v[16:17], v[18:19]
    v_pk_mul_f32 v[50:51], v[16:17], v[16:17]
    v_pk_fma_f32 v[50:51], v[18:19], v[18:19], v[50:51]
    v_pk_add_f32 v[48:49], v[48:49], v[20:21]
    v_pk_fma_f32 v[50:51], v[20:21], v[20:21], v[50:51]
    v_pk_add_f32 v[48:49], v[48:49], v[22:23]
    v_pk_fma_f32 v[50:51], v[22:23], v[22:23], v[50:51]
    v_pk_add_f32 v[48:49], v[48:49], v[24:25]
    v_pk_fma_f32 v[50:51], v[24:25], v[24:25], v[50:51]
    v_pk_add_f32 v[48:49], v[48:49], v[26:27]
    v_pk_fma_f32 v[50:51], v[26:27], v[26:27], v[50:51]
    v_pk_add_f32 v[48:49], v[48:49], v[28:29]
    v_pk_fma_f32 v[50:51], v[28:29], v[28:29], v[50:51]
    v_pk_add_f32 v[48:49], v[48:49], v[30:31]
    v_pk_fma_f32 v[50:51], v[30:31], v[30:31], v[50:51]
    v_add_f32_e32 v48, v48, v49
    v_add_f32_e32 v50, v50, v51
    s_nop 1
    v_permlane32_swap_b32_e32 v48, v50
    v_add_f32_e32 v48, v48, v50
    buffer_store_dword v48, v114, s[4:7], s66 offen
    s_add_u32 m0, s49, 81920
    s_add_u32 s54, s82, 49152
    buffer_load_dwordx4 v1, s[4:7], s54 offen lds
    buffer_load_dwordx4 v1, s[4:7], s54 offen offset:1024 lds
    buffer_load_dwordx4 v1, s[4:7], s54 offen offset:2048 lds
    buffer_load_dwordx4 v1, s[4:7], s54 offen offset:3072 lds
    v_accvgpr_write_b32 a224, v16
    v_accvgpr_write_b32 a225, v17
    v_accvgpr_write_b32 a226, v18
    v_accvgpr_write_b32 a227, v19
    v_accvgpr_write_b32 a228, v20
    v_accvgpr_write_b32 a229, v21
    v_accvgpr_write_b32 a230, v22
    v_accvgpr_write_b32 a231, v23
    v_accvgpr_write_b32 a232, v24
    v_accvgpr_write_b32 a233, v25
    v_accvgpr_write_b32 a234, v26
    v_accvgpr_write_b32 a235, v27
    v_accvgpr_write_b32 a236, v28
    v_accvgpr_write_b32 a237, v29
    v_accvgpr_write_b32 a238, v30
    v_accvgpr_write_b32 a239, v31
    v_and_b32_e32 v15, 15, v0
    v_lshlrev_b32_e32 v15, 2, v15
    s_mov_b32 s52, s65
    v_and_b32_e32 v4, 31, v0
    v_lshrrev_b32_e32 v116, 5, v0
    v_lshlrev_b32_e32 v4, 4, v4
    v_lshl_add_u32 v4, v116, 11, v4
    ds_read_b128 v[80:83], v2 offset:49152
    ds_read_b128 v[84:87], v2 offset:50176
    ds_read_b128 v[88:91], v2 offset:51200
    ds_read_b128 v[92:95], v2 offset:52224
    ds_read_b128 v[96:99], v2 offset:53248
    ds_read_b128 v[100:103], v2 offset:54272
    ds_read_b128 v[104:107], v2 offset:55296
    v_mov_b32_e32 v14, s36
    s_cmp_lg_u32 s43, 0
    s_mov_b64 exec, 1
    s_waitcnt vmcnt(4)
    s_cbranch_scc1 L_slow_34
    buffer_store_dword v14, off, s[4:7], s71 offset:128
L_back_35:
    s_mov_b64 exec, -1
L_poll_36:
    s_add_u32 s44, s44, 1
    s_cbranch_scc1 L_abort
    buffer_load_dword v14, v15, s[4:7], s72 offen offset:128 sc1
    s_waitcnt vmcnt(0)
    v_cmp_ne_u32_e32 vcc, s36, v14
    s_cbranch_vccnz L_poll_36
    buffer_load_dwordx4 v[128:131], v1, s[4:7], s52 offen offset:0 sc1
    buffer_load_dwordx4 v[132:135], v1, s[4:7], s52 offen offset:1024 sc1
    buffer_load_dwordx4 v[136:139], v1, s[4:7], s52 offen offset:2048 sc1
    buffer_load_dwordx4 v[140:143], v1, s[4:7], s52 offen offset:3072 sc1
    s_add_u32 s52, s52, 4096
    buffer_load_dwordx4 v[144:147], v1, s[4:7], s52 offen offset:0 sc1
    buffer_load_dwordx4 v[148:151], v1, s[4:7], s52 offen offset:1024 sc1
    buffer_load_dwordx4 v[152:155], v1, s[4:7], s52 offen offset:2048 sc1
    s_waitcnt lgkmcnt(3)
    s_waitcnt vmcnt(6)
    v_mfma_f32_32x32x16_bf16 v[16:31], v[80:83], v[128:131], 0
    ds_read_b128 v[108:111], v2 offset:56320
    buffer_load_dwordx4 v[156:159], v1, s[4:7], s52 offen offset:3072 sc1
    v_mfma_f32_32x32x16_bf16 v[32:47], v[84:87], v[128:131], 0
    ds_read_b128 v[80:83], v2 offset:57344
    s_waitcnt vmcnt(6)
    v_mfma_f32_32x32x16_bf16 v[16:31], v[88:91], v[132:135], v[16:31]
    ds_read_b128 v[84:87], v2 offset:58368
    s_add_u32 s52, s52, 4096
    buffer_load_dwordx4 v[160:163], v1, s[4:7], s52 offen offset:0 sc1
    v_mfma_f32_32x32x16_bf16 v[32:47], v[92:95], v[132:135], v[32:47]
    ds_read_b128 v[88:91], v2 offset:59392
    s_waitcnt lgkmcnt(3)
    s_waitcnt vmcnt(6)
    v_mfma_f32_32x32x16_bf16 v[16:31], v[96:99], v[136:139], v[16:31]
    ds_read_b128 v[92:95], v2 offset:60416
    buffer_load_dwordx4 v[164:167], v1, s[4:7], s52 offen offset:1024 sc1
    v_mfma_f32_32x32x16_bf16 v[32:47], v[100:103], v[136:139], v[32:47]
    ds_read_b128 v[96:99], v2 offset:61440
    s_waitcnt vmcnt(6)
    v_mfma_f32_32x32x16_bf16 v[16:31], v[104:107], v[140:143], v[16:31]
    ds_read_b128 v[100:103], v2 offset:62464
    buffer_load_dwordx4 v[168:171], v1, s[4:7], s52 offen offset:2048 sc1
    v_mfma_f32_32x32x16_bf16 v[32:47], v[108:111], v[140:143], v[32:47]
    ds_read_b128 v[104:107], v2 offset:63488
    buffer_load_dwordx4 v[172:175], v1, s[4:7], s52 offen offset:3072 sc1
    s_waitcnt lgkmcnt(3)
    s_waitcnt vmcnt(7)
    v_mfma_f32_32x32x16_bf16 v[16:31], v[80:83], v[144:147], v[16:31]
    ds_read_b128 v[108:111], v2 offset:64512
    v_mfma_f32_32x32x16_bf16 v[32:47], v[84:87], v[144:147], v[32:47]
    ds_read_b128 v[80:83], v3 offset:0
    s_add_u32 s52, s52, 4096
    buffer_load_dwordx4 v[176:179], v1, s[4:7], s52 offen offset:0 sc1
    s_waitcnt vmcnt(7)
    v_mfma_f32_32x32x16_bf16 v[16:31], v[88:91], v[148:151], v[16:31]
    ds_read_b128 v[84:87], v3 offset:1024
    v_mfma_f32_32x32x16_bf16 v[32:47], v[92:95], v[148:151], v[32:47]
    ds_read_b128 v[88:91], v3 offset:2048
    buffer_load_dwordx4 v[180:183], v1, s[4:7], s52 offen offset:1024 sc1
    s_waitcnt lgkmcnt(3)
    s_waitcnt vmcnt(7)
    v_mfma_f32_32x32x16_bf16 v[16:31], v[96:99], v[152:155], v[16:31]
    ds_read_b128 v[92:95], v3 offset:3072
    v_mfma_f32_32x32x16_bf16 v[32:47], v[100:103], v[152:155], v[32:47]
    ds_read_b128 v[96:99], v3 offset:4096
    buffer_load_dwordx4 v[112:115], v4, s[4:7], s67 offen offset:0 sc1
    s_waitcnt vmcnt(7)
    v_mfma_f32_32x32x16_bf16 v[16:31], v[104:107], v[156:159], v[16:31]
    ds_read_b128 v[100:103], v3 offset:5120
    buffer_load_dwordx4 v[116:119], v4, s[4:7], s67 offen offset:512 sc1
    v_mfma_f32_32x32x16_bf16 v[32:47], v[108:111], v[156:159], v[32:47]
    ds_read_b128 v[104:107], v3 offset:6144
    s_waitcnt lgkmcnt(3)
    s_waitcnt vmcnt(7)
    v_mfma_f32_32x32x16_bf16 v[16:31], v[80:83], v[160:163], v[16:31]
    ds_read_b128 v[108:111], v3 offset:7168
    buffer_load_dwordx4 v[120:123], v4, s[4:7], s67 offen offset:1024 sc1
    v_mfma_f32_32x32x16_bf16 v[32:47], v[84:87], v[160:163], v[32:47]
    ds_read_b128 v[80:83], v3 offset:8192
    buffer_load_dwordx4 v[124:127], v4, s[4:7], s67 offen offset:1536 sc1
    s_waitcnt vmcnt(8)
    v_mfma_f32_32x32x16_bf16 v[16:31], v[88:91], v[164:167], v[16:31]
    ds_read_b128 v[84:87], v3 offset:9216
    v_mfma_f32_32x32x16_bf16 v[32:47], v[92:95], v[164:167], v[32:47]
    ds_read_b128 v[88:91], v3 offset:10240
    buffer_load_dwordx4 v[184:187], v1, s[4:7], s52 offen offset:2048 sc1
    s_waitcnt lgkmcnt(3)
    s_waitcnt vmcnt(8)
    v_mfma_f32_32x32x16_bf16 v[16:31], v[96:99], v[168:171], v[16:31]
    ds_read_b128 v[92:95], v3 offset:11264
    v_mfma_f32_32x32x16_bf16 v[32:47], v[100:103], v[168:171], v[32:47]
    ds_read_b128 v[96:99], v3 offset:12288
    buffer_load_dwordx4 v[188:191], v1, s[4:7], s52 offen offset:3072 sc1
    s_waitcnt vmcnt(8)
    v_mfma_f32_32x32x16_bf16 v[16:31], v[104:107], v[172:175], v[16:31]
    ds_read_b128 v[100:103], v3 offset:13312
    v_mfma_f32_32x32x16_bf16 v[32:47], v[108:111], v[172:175], v[32:47]
    ds_read_b128 v[104:107], v3 offset:14336
    s_barrier
    s_waitcnt lgkmcnt(3)
    s_waitcnt vmcnt(7)
    v_mfma_f32_32x32x16_bf16 v[16:31], v[80:83], v[176:179], v[16:31]
    ds_read_b128 v[108:111], v3 offset:15360
    s_add_u32 s52, s52, 4096
    buffer_load_dwordx4 v[192:195], v1, s[4:7], s52 offen offset:0 sc1
    buffer_load_dwordx4 v[196:199], v1, s[4:7], s52 offen offset:1024 sc1
    v_mfma_f32_32x32x16_bf16 v[32:47], v[84:87], v[176:179], v[32:47]
    ds_read_b128 v[80:83], v2 offset:0
    s_waitcnt vmcnt(8)
    v_mfma_f32_32x32x16_bf16 v[16:31], v[88:91], v[180:183], v[16:31]
    ds_read_b128 v[84:87], v2 offset:1024
    buffer_load_dwordx4 v[200:203], v1, s[4:7], s52 offen offset:2048 sc1
    v_mfma_f32_32x32x16_bf16 v[32:47], v[92:95], v[180:183], v[32:47]
    ds_read_b128 v[88:91], v2 offset:2048
    s_waitcnt lgkmcnt(3)
    s_waitcnt vmcnt(4)
    v_mfma_f32_32x32x16_bf16 v[16:31], v[96:99], v[184:187], v[16:31]
    ds_read_b128 v[92:95], v2 offset:3072
    buffer_load_dwordx4 v[204:207], v1, s[4:7], s52 offen offset:3072 sc1
    v_mfma_f32_32x32x16_bf16 v[32:47], v[100:103], v[184:187], v[32:47]
    ds_read_b128 v[96:99], v2 offset:4096
    s_waitcnt vmcnt(4)
    v_mfma_f32_32x32x16_bf16 v[16:31], v[104:107], v[188:191], v[16:31]
    ds_read_b128 v[100:103], v2 offset:5120
    s_add_u32 s52, s52, 4096
    buffer_load_dwordx4 v[208:211], v1, s[4:7], s52 offen offset:0 sc1
    v_mfma_f32_32x32x16_bf16 v[32:47], v[108:111], v[188:191], v[32:47]
    ds_read_b128 v[104:107], v2 offset:6144
    s_waitcnt lgkmcnt(3)
    s_waitcnt vmcnt(4)
    v_mfma_f32_32x32x16_bf16 v[16:31], v[80:83], v[192:195], v[16:31]
    ds_read_b128 v[108:111], v2 offset:7168
    buffer_load_dwordx4 v[212:215], v1, s[4:7], s52 offen offset:1024 sc1
    v_mfma_f32_32x32x16_bf16 v[32:47], v[84:87], v[192:195], v[32:47]
    ds_read_b128 v[80:83], v2 offset:8192
    buffer_load_dwordx4 v[216:219], v1, s[4:7], s52 offen offset:2048 sc1
    s_waitcnt vmcnt(5)
    v_mfma_f32_32x32x16_bf16 v[16:31], v[88:91], v[196:199], v[16:31]
    ds_read_b128 v[84:87], v2 offset:9216
    v_mfma_f32_32x32x16_bf16 v[32:47], v[92:95], v[196:199], v[32:47]
    ds_read_b128 v[88:91], v2 offset:10240
    buffer_load_dwordx4 v[220:223], v1, s[4:7], s52 offen offset:3072 sc1
    s_waitcnt lgkmcnt(3)
    s_waitcnt vmcnt(5)
    v_mfma_f32_32x32x16_bf16 v[16:31], v[96:99], v[200:203], v[16:31]
    ds_read_b128 v[92:95], v2 offset:11264
    v_add_f32_e32 v112, v112, v120
    v_add_f32_e32 v113, v113, v121
    v_add_f32_e32 v114, v114, v122
    v_add_f32_e32 v115, v115, v123
    v_add_f32_e32 v116, v116, v124
    v_mfma_f32_32x32x16_bf16 v[32:47], v[100:103], v[200:203], v[32:47]
    ds_read_b128 v[96:99], v2 offset:12288
    s_add_u32 s52, s52, 4096
    buffer_load_dwordx4 v[224:227], v1, s[4:7], s52 offen offset:0 sc1
    v_add_f32_e32 v117, v117, v125
    v_add_f32_e32 v118, v118, v126
    s_waitcnt vmcnt(5)
    v_mfma_f32_32x32x16_bf16 v[16:31], v[104:107], v[204:207], v[16:31]
    ds_read_b128 v[100:103], v2 offset:13312
    v_add_f32_e32 v119, v119, v127
    v_add_f32_e32 v112, v112, v116
    v_add_f32_e32 v113, v113, v117
    v_add_f32_e32 v114, v114, v118
    v_add_f32_e32 v115, v115, v119
    v_mfma_f32_32x32x16_bf16 v[32:47], v[108:111], v[204:207], v[32:47]
    ds_read_b128 v[104:107], v2 offset:14336
    buffer_load_dwordx4 v[228:231], v1, s[4:7], s52 offen offset:1024 sc1
    v_add_f32_e32 v112, v112, v114
    v_add_f32_e32 v113, v113, v115
    s_waitcnt lgkmcnt(3)
    s_waitcnt vmcnt(5)
    v_mfma_f32_32x32x16_bf16 v[16:31], v[80:83], v[208:211], v[16:31]
    ds_read_b128 v[108:111], v2 offset:15360
    buffer_load_dwordx4 v[232:235], v1, s[4:7], s52 offen offset:2048 sc1
    v_permlane32_swap_b32_e32 v112, v113
    v_add_f32_e32 v112, v112, v113
    v_mfma_f32_32x32x16_bf16 v[32:47], v[84:87], v[208:211], v[32:47]
    ds_read_b128 v[80:83], v2 offset:16384
    v_mov_b32_e32 v113, v112
    s_nop 1
    v_permlane32_swap_b32_e32 v112, v113
    v_mul_f32_e32 v114, 0x3b000000, v112
    v_mul_f32_e32 v115, v114, v114
    s_waitcnt vmcnt(5)
    v_mfma_f32_32x32x16_bf16 v[16:31], v[88:91], v[212:215], v[16:31]
    ds_read_b128 v[84:87], v2 offset:17408
    buffer_load_dwordx4 v[236:239], v1, s[4:7], s52 offen offset:3072 sc1
    v_mul_f32_e32 v113, 0x3b000000, v113
    v_sub_f32_e32 v113, v113, v115
    v_max_f32_e32 v113, 0, v113
    v_mfma_f32_32x32x16_bf16 v[32:47], v[92:95], v[212:215], v[32:47]
    ds_read_b128 v[88:91], v2 offset:18432
    v_add_f32_e32 v113, 0x3727c5ac, v113
    v_rsq_f32_e32 v8, v113
    v_mul_f32_e32 v114, v11, v112
    s_waitcnt lgkmcnt(3)
    s_waitcnt vmcnt(5)
    v_mfma_f32_32x32x16_bf16 v[16:31], v[96:99], v[216:219], v[16:31]
    ds_read_b128 v[92:95], v2 offset:19456
    s_add_u32 s52, s52, 4096
    buffer_load_dwordx4 v[240:243], v1, s[4:7], s52 offen offset:0 sc1
    v_cvt_pk_bf16_f32 v13, v114, 0
    v_mul_f32_e32 v10, v113, v8
    v_mfma_f32_32x32x16_bf16 v[32:47], v[100:103], v[216:219], v[32:47]
    ds_read_b128 v[96:99], v2 offset:20480
    v_mul_f32_e32 v9, 0x3fb8aa3b, v8
    v_lshlrev_b32_e32 v115, 16, v13
    v_sub_f32_e32 v115, v114, v115
    v_cvt_pk_bf16_f32 v12, v114, v115
    s_waitcnt vmcnt(5)
    v_mfma_f32_32x32x16_bf16 v[16:31], v[104:107], v[220:223], v[16:31]
    ds_read_b128 v[100:103], v2 offset:21504
    buffer_load_dwordx4 v[244:247], v1, s[4:7], s52 offen offset:1024 sc1
    v_mfma_f32_32x32x16_bf16 v[32:47], v[108:111], v[220:223], v[32:47]
    ds_read_b128 v[104:107], v2 offset:22528
    buffer_load_dwordx4 v[248:251], v1, s[4:7], s52 offen offset:2048 sc1
    s_waitcnt lgkmcnt(3)
    s_waitcnt vmcnt(6)
    v_mfma_f32_32x32x16_bf16 v[16:31], v[80:83], v[224:227], v[16:31]
    ds_read_b128 v[108:111], v2 offset:23552
    v_mfma_f32_32x32x16_bf16 v[32:47], v[84:87], v[224:227], v[32:47]
    ds_read_b128 v[80:83], v2 offset:24576
    buffer_load_dwordx4 v[252:255], v1, s[4:7], s52 offen offset:3072 sc1
    s_waitcnt vmcnt(6)
    v_mfma_f32_32x32x16_bf16 v[16:31], v[88:91], v[228:231], v[16:31]
    ds_read_b128 v[84:87], v2 offset:25600
    v_mfma_f32_32x32x16_bf16 v[32:47], v[92:95], v[228:231], v[32:47]
    ds_read_b128 v[88:91], v2 offset:26624
    s_waitcnt lgkmcnt(3)
    s_waitcnt vmcnt(5)
    v_mfma_f32_32x32x16_bf16 v[16:31], v[96:99], v[232:235], v[16:31]
    ds_read_b128 v[92:95], v2 offset:27648
    v_mfma_f32_32x32x16_bf16 v[32:47], v[100:103], v[232:235], v[32:47]
    ds_read_b128 v[96:99], v2 offset:28672
    s_waitcnt vmcnt(4)
    v_mfma_f32_32x32x16_bf16 v[16:31], v[104:107], v[236:239], v[16:31]
    ds_read_b128 v[100:103], v2 offset:29696
    v_lshlrev_b32_e32 v48, 10, v0
    s_and_b32 s50, s81, 127
    s_mul_i32 s50, s50, 4096
    s_mov_b64 exec, 0xf
    buffer_load_dword a255, v48, s[16:19], s50 offen offset:384
    s_mov_b64 exec, -1
    v_mfma_f32_32x32x16_bf16 v[32:47], v[108:111], v[236:239], v[32:47]
    ds_read_b128 v[104:107], v2 offset:30720
    v_mfma_f32_32x32x8_bf16 v[16:31], a[248:249], v[12:13], v[16:31]
    v_mfma_f32_32x32x8_bf16 v[32:47], a[250:251], v[12:13], v[32:47]
    s_waitcnt lgkmcnt(3)
    s_waitcnt vmcnt(4)
    v_mfma_f32_32x32x16_bf16 v[16:31], v[80:83], v[240:243], v[16:31]
    ds_read_b128 v[108:111], v2 offset:31744
    s_add_u32 m0, s49, 32768
    s_add_u32 s54, s82, 65536
    buffer_load_dwordx4 v1, s[4:7], s54 offen lds
    v_mfma_f32_32x32x16_bf16 v[32:47], v[84:87], v[240:243], v[32:47]
    s_waitcnt vmcnt(4)
    v_mfma_f32_32x32x16_bf16 v[16:31], v[88:91], v[244:247], v[16:31]
    v_mfma_f32_32x32x16_bf16 v[32:47], v[92:95], v[244:247], v[32:47]
    buffer_load_dwordx4 v1, s[4:7], s54 offen offset:1024 lds
    s_waitcnt lgkmcnt(0)
    s_waitcnt vmcnt(4)
    v_mfma_f32_32x32x16_bf16 v[16:31], v[96:99], v[248:251], v[16:31]
    v_mfma_f32_32x32x16_bf16 v[32:47], v[100:103], v[248:251], v[32:47]
    buffer_load_dwordx4 v1, s[4:7], s54 offen offset:2048 lds
    s_waitcnt vmcnt(4)
    v_mfma_f32_32x32x16_bf16 v[16:31], v[104:107], v[252:255], v[16:31]
    v_mfma_f32_32x32x16_bf16 v[32:47], v[108:111], v[252:255], v[32:47]
    buffer_load_dwordx4 v1, s[4:7], s54 offen offset:3072 lds
    s_barrier
    v_lshrrev_b32_e32 v121, 5, v0
    v_lshlrev_b32_e32 v121, 7, v121
    v_xor_b32_e32 v120, v121, v1
    s_add_u32 s50, s48, 0
    v_add_u32_e32 v120, s50, v120
    v_bfe_u32 v122, v0, 2, 3
    v_lshlrev_b32_e32 v5, 10, v122
    v_lshrrev_b32_e32 v122, 5, v0
    v_lshl_add_u32 v5, v122, 6, v5
    v_and_b32_e32 v122, 3, v0
    v_lshl_add_u32 v5, v122, 4, v5
    v_lshlrev_b32_e32 v4, 7, v0
    v_cvt_pk_bf16_f32 v64, v16, v17
    v_cvt_pk_bf16_f32 v65, v18, v19
    v_cvt_pk_bf16_f32 v66, v20, v21
    v_cvt_pk_bf16_f32 v67, v22, v23
    v_cvt_pk_bf16_f32 v68, v24, v25
    v_cvt_pk_bf16_f32 v69, v26, v27
    v_cvt_pk_bf16_f32 v70, v28, v29
    v_cvt_pk_bf16_f32 v71, v30, v31
    v_mfma_f32_32x32x16_bf16 v[48:63], a[240:243], v[64:67], 0
    s_nop 0
    v_mfma_f32_32x32x16_bf16 v[48:63], a[244:247], v[68:71], v[48:63]
    s_add_u32 m0, s49, 98304
    s_add_u32 s54, s82, 81920
    buffer_load_dwordx4 v1, s[4:7], s54 offen lds
    v_mul_f32_e32 v32, v8, v32
    v_mul_f32_e32 v33, v8, v33
    v_mul_f32_e32 v34, v8, v34
    v_mul_f32_e32 v35, v8, v35
    v_mul_f32_e32 v36, v8, v36
    v_mul_f32_e32 v37, v8, v37
    v_mul_f32_e32 v38, v8, v38
    v_mul_f32_e32 v39, v8, v39
    v_cvt_pk_bf16_f32 v72, v32, v33
    v_cvt_pk_bf16_f32 v73, v34, v35
    v_cvt_pk_bf16_f32 v74, v36, v37
    v_cvt_pk_bf16_f32 v75, v38, v39
    ds_write_b128 v120, v[72:75] offset:49152
    v_mul_f32_e32 v40, v8, v40
    v_mul_f32_e32 v41, v8, v41
    v_mul_f32_e32 v42, v8, v42
    v_mul_f32_e32 v43, v8, v43
    v_mul_f32_e32 v44, v8, v44
    v_mul_f32_e32 v45, v8, v45
    v_mul_f32_e32 v46, v8, v46
    v_mul_f32_e32 v47, v8, v47
    v_cvt_pk_bf16_f32 v76, v40, v41
    v_cvt_pk_bf16_f32 v77, v42, v43
    buffer_load_dwordx4 v1, s[4:7], s54 offen offset:1024 lds
    v_cvt_pk_bf16_f32 v78, v44, v45
    v_cvt_pk_bf16_f32 v79, v46, v47
    ds_write_b128 v120, v[76:79] offset:53248
    v_max3_f32 v112, v48, v49, v50
    v_min3_f32 v114, v48, v49, v50
    v_max3_f32 v113, v56, v57, v58
    v_min3_f32 v115, v56, v57, v58
    v_max3_f32 v112, v112, v51, v52
    v_min3_f32 v114, v114, v51, v52
    v_max3_f32 v113, v113, v59, v60
    v_min3_f32 v115, v115, v59, v60
    v_max3_f32 v112, v112, v53, v54
    v_min3_f32 v114, v114, v53, v54
    v_max3_f32 v113, v113, v61, v62
    v_min3_f32 v115, v115, v61, v62
    v_max_f32_e32 v112, v112, v55
    v_min_f32_e32 v114, v114, v55
    v_max_f32_e32 v113, v113, v63
    v_min_f32_e32 v115, v115, v63
    s_nop 0
    v_permlane32_swap_b32_e32 v112, v113
    buffer_load_dwordx4 v1, s[4:7], s54 offen offset:2048 lds
    v_permlane32_swap_b32_e32 v114, v115
    v_max_f32_e32 v112, v112, v113
    v_min_f32_e32 v114, v114, v115
    v_mul_f32_e64 v112, -v112, v9
    v_mul_f32_e32 v114, v114, v9
    v_mov_b32_e32 v116, v112
    v_mov_b32_e32 v118, v114
    s_nop 0
    v_permlane32_swap_b32_e32 v112, v116
    v_permlane32_swap_b32_e32 v114, v118
    v_pk_fma_f32 v[80:81], v[48:49], v[8:9], v[112:113] op_sel:[0,1,0] op_sel_hi:[1,1,0]
    v_pk_fma_f32 v[82:83], v[50:51], v[8:9], v[112:113] op_sel:[0,1,0] op_sel_hi:[1,1,0]
    v_pk_fma_f32 v[84:85], v[52:53], v[8:9], v[112:113] op_sel:[0,1,0] op_sel_hi:[1,1,0]
    v_pk_fma_f32 v[86:87], v[54:55], v[8:9], v[112:113] op_sel:[0,1,0] op_sel_hi:[1,1,0]
    v_pk_fma_f32 v[88:89], v[48:49], v[8:9], v[114:115] op_sel:[0,1,0] op_sel_hi:[1,1,0] neg_lo:[1,0,0] neg_hi:[1,0,0]
    v_pk_fma_f32 v[90:91], v[50:51], v[8:9], v[114:115] op_sel:[0,1,0] op_sel_hi:[1,1,0] neg_lo:[1,0,0] neg_hi:[1,0,0]
    v_pk_fma_f32 v[92:93], v[52:53], v[8:9], v[114:115] op_sel:[0,1,0] op_sel_hi:[1,1,0] neg_lo:[1,0,0] neg_hi:[1,0,0]
    v_pk_fma_f32 v[94:95], v[54:55], v[8:9], v[114:115] op_sel:[0,1,0] op_sel_hi:[1,1,0] neg_lo:[1,0,0] neg_hi:[1,0,0]
    v_pk_fma_f32 v[96:97], v[56:57], v[8:9], v[116:117] op_sel:[0,1,0] op_sel_hi:[1,1,0]
    buffer_load_dwordx4 v1, s[4:7], s54 offen offset:3072 lds
    v_pk_fma_f32 v[98:99], v[58:59], v[8:9], v[116:117] op_sel:[0,1,0] op_sel_hi:[1,1,0]
    v_pk_fma_f32 v[100:101], v[60:61], v[8:9], v[116:117] op_sel:[0,1,0] op_sel_hi:[1,1,0]
    v_pk_fma_f32 v[102:103], v[62:63], v[8:9], v[116:117] op_sel:[0,1,0] op_sel_hi:[1,1,0]
    v_pk_fma_f32 v[104:105], v[56:57], v[8:9], v[118:119] op_sel:[0,1,0] op_sel_hi:[1,1,0] neg_lo:[1,0,0] neg_hi:[1,0,0]
    v_pk_fma_f32 v[106:107], v[58:59], v[8:9], v[118:119] op_sel:[0,1,0] op_sel_hi:[1,1,0] neg_lo:[1,0,0] neg_hi:[1,0,0]
    v_pk_fma_f32 v[108:109], v[60:61], v[8:9], v[118:119] op_sel:[0,1,0] op_sel_hi:[1,1,0] neg_lo:[1,0,0] neg_hi:[1,0,0]
    v_pk_fma_f32 v[110:111], v[62:63], v[8:9], v[118:119] op_sel:[0,1,0] op_sel_hi:[1,1,0] neg_lo:[1,0,0] neg_hi:[1,0,0]
    v_exp_f32_e32 v80, v80
    v_exp_f32_e32 v81, v81
    v_exp_f32_e32 v82, v82
    v_exp_f32_e32 v83, v83
    v_exp_f32_e32 v84, v84
    v_exp_f32_e32 v85, v85
    v_exp_f32_e32 v86, v86
    v_exp_f32_e32 v87, v87
    s_add_u32 m0, s48, 65536
    s_add_u32 s54, s80, 0
    buffer_load_dwordx4 v5, s[16:19], s54 offen lds
    v_exp_f32_e32 v88, v88
    v_exp_f32_e32 v89, v89
    v_exp_f32_e32 v90, v90
    v_exp_f32_e32 v91, v91
    v_exp_f32_e32 v92, v92
    v_exp_f32_e32 v93, v93
    v_exp_f32_e32 v94, v94
    v_exp_f32_e32 v95, v95
    v_exp_f32_e32 v96, v96
    v_exp_f32_e32 v97, v97
    v_exp_f32_e32 v98, v98
    v_exp_f32_e32 v99, v99
    s_add_u32 m0, s48, 114688
    s_add_u32 s54, s80, 262144
    buffer_load_dwordx4 v5, s[16:19], s54 offen lds
    v_exp_f32_e32 v100, v100
    v_exp_f32_e32 v101, v101
    v_exp_f32_e32 v102, v102
    v_exp_f32_e32 v103, v103
    v_exp_f32_e32 v104, v104
    v_exp_f32_e32 v105, v105
    v_exp_f32_e32 v106, v106
    v_exp_f32_e32 v107, v107
    v_exp_f32_e32 v108, v108
    v_exp_f32_e32 v109, v109
    v_exp_f32_e32 v110, v110
    v_exp_f32_e32 v111, v111
    s_add_u32 m0, s48, 69632
    s_add_u32 s54, s80, 32768
    buffer_load_dwordx4 v5, s[16:19], s54 offen lds
    v_pk_add_f32 v[48:49], v[80:81], v[82:83]
    v_pk_add_f32 v[50:51], v[84:85], v[86:87]
    v_pk_add_f32 v[52:53], v[88:89], v[90:91]
    v_pk_add_f32 v[54:55], v[92:93], v[94:95]
    v_pk_add_f32 v[56:57], v[96:97], v[98:99]
    v_pk_add_f32 v[58:59], v[100:101], v[102:103]
    v_pk_add_f32 v[60:61], v[104:105], v[106:107]
    v_pk_add_f32 v[62:63], v[108:109], v[110:111]
    v_pk_add_f32 v[48:49], v[48:49], v[50:51]
    v_pk_add_f32 v[52:53], v[52:53], v[54:55]
    v_pk_add_f32 v[56:57], v[56:57], v[58:59]
    v_pk_add_f32 v[60:61], v[60:61], v[62:63]
    v_add_f32_e32 v112, v48, v49
    v_add_f32_e32 v114, v52, v53
    v_add_f32_e32 v116, v56, v57
    v_add_f32_e32 v118, v60, v61
    v_permlane32_swap_b32_e32 v112, v114
    s_nop 0
    v_permlane32_swap_b32_e32 v116, v118
    s_add_u32 m0, s48, 118784
    s_add_u32 s54, s80, 294912
    buffer_load_dwordx4 v5, s[16:19], s54 offen lds
    v_add_f32_e32 v112, v112, v114
    v_add_f32_e32 v116, v116, v118
    v_rcp_f32_e32 v112, v112
    v_rcp_f32_e32 v116, v116
    v_mov_b32_e32 v114, v112
    v_mov_b32_e32 v118, v116
    s_nop 0
    v_permlane32_swap_b32_e32 v112, v114
    v_permlane32_swap_b32_e32 v116, v118
    v_pk_mul_f32 v[80:81], v[80:81], v[112:113] op_sel_hi:[1,0]
    v_pk_mul_f32 v[82:83], v[82:83], v[112:113] op_sel_hi:[1,0]
    v_pk_mul_f32 v[84:85], v[84:85], v[112:113] op_sel_hi:[1,0]
    v_pk_mul_f32 v[86:87], v[86:87], v[112:113] op_sel_hi:[1,0]
    v_cvt_pk_bf16_f32 v16, v80, v81
    v_cvt_pk_bf16_f32 v17, v82, v83
    v_cvt_pk_bf16_f32 v18, v84, v85
    v_cvt_pk_bf16_f32 v19, v86, v87
    ds_write_b128 v120, v[16:19] offset:0
    s_add_u32 m0, s48, 73728
    s_add_u32 s54, s80, 65536
    buffer_load_dwordx4 v5, s[16:19], s54 offen lds
    v_pk_mul_f32 v[88:89], v[88:89], v[114:115] op_sel_hi:[1,0]
    v_pk_mul_f32 v[90:91], v[90:91], v[114:115] op_sel_hi:[1,0]
    v_pk_mul_f32 v[92:93], v[92:93], v[114:115] op_sel_hi:[1,0]
    v_pk_mul_f32 v[94:95], v[94:95], v[114:115] op_sel_hi:[1,0]
    v_cvt_pk_bf16_f32 v20, v88, v89
    v_cvt_pk_bf16_f32 v21, v90, v91
    v_cvt_pk_bf16_f32 v22, v92, v93
    v_cvt_pk_bf16_f32 v23, v94, v95
    ds_write_b128 v120, v[20:23] offset:4096
    v_pk_mul_f32 v[96:97], v[96:97], v[116:117] op_sel_hi:[1,0]
    v_pk_mul_f32 v[98:99], v[98:99], v[116:117] op_sel_hi:[1,0]
    v_pk_mul_f32 v[100:101], v[100:101], v[116:117] op_sel_hi:[1,0]
    v_pk_mul_f32 v[102:103], v[102:103], v[116:117] op_sel_hi:[1,0]
    v_cvt_pk_bf16_f32 v24, v96, v97
    v_cvt_pk_bf16_f32 v25, v98, v99
    v_cvt_pk_bf16_f32 v26, v100, v101
    v_cvt_pk_bf16_f32 v27, v102, v103
    ds_write_b128 v120, v[24:27] offset:8192
    v_pk_mul_f32 v[104:105], v[104:105], v[118:119] op_sel_hi:[1,0]
    v_pk_mul_f32 v[106:107], v[106:107], v[118:119] op_sel_hi:[1,0]
    v_pk_mul_f32 v[108:109], v[108:109], v[118:119] op_sel_hi:[1,0]
    v_pk_mul_f32 v[110:111], v[110:111], v[118:119] op_sel_hi:[1,0]
    v_cvt_pk_bf16_f32 v28, v104, v105
    v_cvt_pk_bf16_f32 v29, v106, v107
    v_cvt_pk_bf16_f32 v30, v108, v109
    v_cvt_pk_bf16_f32 v31, v110, v111
    ds_write_b128 v120, v[28:31] offset:12288
    v_bfe_u32 v123, v0, 1, 1
    v_lshrrev_b32_e32 v121, 2, v0
    v_lshlrev_b32_e32 v121, 4, v121
    v_mul_u32_u24_e32 v123, 0x280, v123
    v_xor_b32_e32 v121, v121, v123
    v_and_b32_e32 v123, 1, v0
    v_lshl_add_u32 v123, v123, 3, v121
    s_add_u32 s50, s49, 0
    v_add_u32_e32 v121, s50, v123
    s_lshl_b32 s50, s47, 12
    s_add_u32 s50, s50, 49152
    v_add_u32_e32 v122, s50, v123
    s_waitcnt lgkmcnt(0)
    s_barrier
    ds_read_b64_tr_b16 v[80:81], v121 offset:0
    ds_read_b64_tr_b16 v[82:83], v121 offset:256
    ds_read_b64_tr_b16 v[84:85], v122 offset:0
    ds_read_b64_tr_b16 v[86:87], v122 offset:256
    v_mov_b32_e32 v124, s45
    v_mov_b32_e32 v125, s45
    v_mov_b32_e32 v126, s45
    v_mov_b32_e32 v127, s45
    ds_read_b64_tr_b16 v[88:89], v121 offset:1024
    ds_read_b64_tr_b16 v[90:91], v121 offset:1280
    ds_read_b64_tr_b16 v[92:93], v122 offset:1024
    ds_read_b64_tr_b16 v[94:95], v122 offset:1280
    ds_read_b64_tr_b16 v[96:97], v121 offset:2048
    ds_read_b64_tr_b16 v[98:99], v121 offset:2304
    ds_read_b64_tr_b16 v[100:101], v122 offset:2048
    ds_read_b64_tr_b16 v[102:103], v122 offset:2304
    ds_read_b64_tr_b16 v[104:105], v121 offset:3072
    ds_read_b64_tr_b16 v[106:107], v121 offset:3328
    ds_read_b64_tr_b16 v[108:109], v122 offset:3072
    ds_read_b64_tr_b16 v[110:111], v122 offset:3328
    s_waitcnt lgkmcnt(12)
    v_mfma_f32_16x16x32_bf16 v[112:115], v[80:83], v[84:87], 0
    v_mfma_f32_16x16x32_bf16 v[116:119], v[80:83], v[124:127], 0
    s_waitcnt lgkmcnt(8)
    v_mfma_f32_16x16x32_bf16 v[112:115], v[88:91], v[92:95], v[112:115]
    v_mfma_f32_16x16x32_bf16 v[116:119], v[88:91], v[124:127], v[116:119]
    s_waitcnt lgkmcnt(4)
    v_mfma_f32_16x16x32_bf16 v[112:115], v[96:99], v[100:103], v[112:115]
    v_mfma_f32_16x16x32_bf16 v[116:119], v[96:99], v[124:127], v[116:119]
    s_waitcnt lgkmcnt(0)
    v_mfma_f32_16x16x32_bf16 v[112:115], v[104:107], v[108:111], v[112:115]
    v_mfma_f32_16x16x32_bf16 v[116:119], v[104:107], v[124:127], v[116:119]
    s_add_u32 s51, s77, s38
    s_lshl_b32 s58, s51, 10
    s_add_u32 s58, s58, 3145728
    s_lshl_b32 s59, s51, 6
    s_add_u32 s59, s59, 196608
    v_mov_b32_e32 v123, 0xfff
    s_nop 0
    v_bfi_b32 v112, v123, s36, v112
    buffer_store_dwordx4 v[112:115], v1, s[4:7], s58 offen sc1
    v_bfi_b32 v116, v123, s36, v116
    s_mov_b32 exec_lo, 0x10001
    s_mov_b32 exec_hi, 0x10001
    buffer_store_dwordx4 v[116:119], v0, s[4:7], s59 offen sc1
    s_mov_b64 exec, -1
    s_add_u32 m0, s48, 122880
    s_add_u32 s54, s80, 327680
    buffer_load_dwordx4 v5, s[16:19], s54 offen lds
    s_add_u32 m0, s48, 77824
    s_add_u32 s54, s80, 98304
    buffer_load_dwordx4 v5, s[16:19], s54 offen lds
    s_waitcnt vmcnt(9)
    s_barrier
    ds_read_b128 v[80:83], v1 offset:32768
    ds_read_b128 v[84:87], v1 offset:33792
    ds_read_b128 v[88:91], v1 offset:34816
    ds_read_b128 v[92:95], v1 offset:35840
    ds_read_b128 v[96:99], v1 offset:36864
    s_waitcnt lgkmcnt(4)
    v_mfma_f32_32x32x16_bf16 v[32:47], v[80:83], v[128:131], 0
    ds_read_b128 v[100:103], v1 offset:37888
    v_lshrrev_b32_e32 v25, 2, v0
    v_and_b32_e32 v26, 3, v0
    v_lshlrev_b32_e32 v25, 10, v25
    v_lshl_add_u32 v25, v26, 4, v25
    s_waitcnt lgkmcnt(4)
    v_mfma_f32_32x32x16_bf16 v[32:47], v[84:87], v[132:135], v[32:47]
    ds_read_b128 v[104:107], v1 offset:38912
    s_add_u32 m0, s48, 126976
    s_add_u32 s54, s80, 360448
    buffer_load_dwordx4 v5, s[16:19], s54 offen lds
    s_waitcnt lgkmcnt(4)
    v_mfma_f32_32x32x16_bf16 v[32:47], v[88:91], v[136:139], v[32:47]
    ds_read_b128 v[108:111], v1 offset:39936
    v_lshrrev_b32_e32 v27, 4, v0
    v_lshlrev_b32_e32 v28, 5, v27
    v_lshl_add_u32 v28, v26, 3, v28
    s_waitcnt lgkmcnt(4)
    v_mfma_f32_32x32x16_bf16 v[32:47], v[92:95], v[140:143], v[32:47]
    ds_read_b128 v[80:83], v1 offset:40960
    s_add_u32 m0, s48, 81920
    s_add_u32 s54, s80, 131072
    buffer_load_dwordx4 v5, s[16:19], s54 offen lds
    s_waitcnt lgkmcnt(4)
    v_mfma_f32_32x32x16_bf16 v[32:47], v[96:99], v[144:147], v[32:47]
    ds_read_b128 v[84:87], v1 offset:41984
    s_add_u32 s50, s48, 160256
    v_add_u32_e32 v28, s50, v28
    s_waitcnt lgkmcnt(4)
    v_mfma_f32_32x32x16_bf16 v[32:47], v[100:103], v[148:151], v[32:47]
    ds_read_b128 v[88:91], v1 offset:43008
    s_add_u32 m0, s48, 131072
    s_add_u32 s54, s80, 393216
    buffer_load_dwordx4 v5, s[16:19], s54 offen lds
    s_waitcnt lgkmcnt(4)
    v_mfma_f32_32x32x16_bf16 v[32:47], v[104:107], v[152:155], v[32:47]
    ds_read_b128 v[92:95], v1 offset:44032
    v_cmp_gt_u32_e32 vcc, 16, v0
    v_mov_b32_e32 v29, 0xfff
    s_nop 0
    v_cndmask_b32_e32 v27, 0, v29, vcc
    s_waitcnt lgkmcnt(4)
    v_mfma_f32_32x32x16_bf16 v[32:47], v[108:111], v[156:159], v[32:47]
    ds_read_b128 v[96:99], v1 offset:45056
    s_lshl_b32 s56, s77, 10
    s_lshl_b32 s50, s38, 6
    s_add_u32 s56, s56, s50
    s_add_u32 s56, s56, 3145728
    s_waitcnt lgkmcnt(4)
    v_mfma_f32_32x32x16_bf16 v[32:47], v[80:83], v[160:163], v[32:47]
    ds_read_b128 v[100:103], v1 offset:46080
    s_add_u32 m0, s48, 86016
    s_add_u32 s54, s80, 163840
    buffer_load_dwordx4 v5, s[16:19], s54 offen lds
    s_waitcnt lgkmcnt(4)
    v_mfma_f32_32x32x16_bf16 v[32:47], v[84:87], v[164:167], v[32:47]
    ds_read_b128 v[104:107], v1 offset:47104
    s_lshl_b32 s57, s77, 6
    s_add_u32 s58, s57, 262144
    s_add_u32 s57, s57, 196608
    s_waitcnt lgkmcnt(4)
    v_mfma_f32_32x32x16_bf16 v[32:47], v[88:91], v[168:171], v[32:47]
    ds_read_b128 v[108:111], v1 offset:48128
    s_add_u32 m0, s48, 135168
    s_add_u32 s54, s80, 425984
    buffer_load_dwordx4 v5, s[16:19], s54 offen lds
    s_waitcnt lgkmcnt(4)
    v_mfma_f32_32x32x16_bf16 v[32:47], v[92:95], v[172:175], v[32:47]
    ds_read_b128 v[80:83], v2 offset:32768
    s_waitcnt lgkmcnt(4)
    v_mfma_f32_32x32x16_bf16 v[32:47], v[96:99], v[176:179], v[32:47]
    ds_read_b128 v[84:87], v2 offset:33792
    s_waitcnt lgkmcnt(4)
    v_mfma_f32_32x32x16_bf16 v[32:47], v[100:103], v[180:183], v[32:47]
    ds_read_b128 v[88:91], v2 offset:34816
    s_add_u32 m0, s48, 90112
    s_add_u32 s54, s80, 196608
    buffer_load_dwordx4 v5, s[16:19], s54 offen lds
    s_waitcnt lgkmcnt(4)
    v_mfma_f32_32x32x16_bf16 v[32:47], v[104:107], v[184:187], v[32:47]
    ds_read_b128 v[92:95], v2 offset:35840
    s_waitcnt lgkmcnt(4)
    v_mfma_f32_32x32x16_bf16 v[32:47], v[108:111], v[188:191], v[32:47]
    ds_read_b128 v[96:99], v2 offset:36864
    s_add_u32 m0, s48, 139264
    s_add_u32 s54, s80, 458752
    buffer_load_dwordx4 v5, s[16:19], s54 offen lds
    s_waitcnt lgkmcnt(4)
    v_mfma_f32_32x32x16_bf16 v[32:47], v[80:83], v[192:195], v[32:47]
    ds_read_b128 v[100:103], v2 offset:37888
    s_waitcnt lgkmcnt(4)
    v_mfma_f32_32x32x16_bf16 v[32:47], v[84:87], v[196:199], v[32:47]
    ds_read_b128 v[104:107], v2 offset:38912
    s_add_u32 m0, s48, 94208
    s_add_u32 s54, s80, 229376
    buffer_load_dwordx4 v5, s[16:19], s54 offen lds
    s_waitcnt lgkmcnt(4)
    v_mfma_f32_32x32x16_bf16 v[32:47], v[88:91], v[200:203], v[32:47]
    ds_read_b128 v[108:111], v2 offset:39936
    s_waitcnt lgkmcnt(4)
    v_mfma_f32_32x32x16_bf16 v[32:47], v[92:95], v[204:207], v[32:47]
    ds_read_b128 v[80:83], v2 offset:40960
    s_waitcnt lgkmcnt(4)
    v_mfma_f32_32x32x16_bf16 v[32:47], v[96:99], v[208:211], v[32:47]
    ds_read_b128 v[84:87], v2 offset:41984
    s_add_u32 m0, s48, 143360
    s_add_u32 s54, s80, 491520
    buffer_load_dwordx4 v5, s[16:19], s54 offen lds
    s_waitcnt lgkmcnt(4)
    v_mfma_f32_32x32x16_bf16 v[32:47], v[100:103], v[212:215], v[32:47]
    ds_read_b128 v[88:91], v2 offset:43008
    s_waitcnt lgkmcnt(4)
    v_mfma_f32_32x32x16_bf16 v[32:47], v[104:107], v[216:219], v[32:47]
    ds_read_b128 v[92:95], v2 offset:44032
    s_mov_b64 exec, 0xffff
    buffer_load_dword a255, v4, s[4:7], s68 offen sc1
    s_mov_b64 exec, -1
    s_waitcnt lgkmcnt(4)
    v_mfma_f32_32x32x16_bf16 v[32:47], v[108:111], v[220:223], v[32:47]
    ds_read_b128 v[96:99], v2 offset:45056
    s_waitcnt lgkmcnt(4)
    v_mfma_f32_32x32x16_bf16 v[32:47], v[80:83], v[224:227], v[32:47]
    ds_read_b128 v[100:103], v2 offset:46080
    s_waitcnt lgkmcnt(4)
    v_mfma_f32_32x32x16_bf16 v[32:47], v[84:87], v[228:231], v[32:47]
    ds_read_b128 v[104:107], v2 offset:47104
    s_waitcnt lgkmcnt(4)
    v_mfma_f32_32x32x16_bf16 v[32:47], v[88:91], v[232:235], v[32:47]
    ds_read_b128 v[108:111], v2 offset:48128
    s_waitcnt lgkmcnt(4)
    v_mfma_f32_32x32x16_bf16 v[32:47], v[92:95], v[236:239], v[32:47]
    buffer_load_dwordx4 v[16:19], v25, s[4:7], s56 offen sc1
    s_waitcnt lgkmcnt(3)
    v_mfma_f32_32x32x16_bf16 v[32:47], v[96:99], v[240:243], v[32:47]
    s_waitcnt lgkmcnt(2)
    v_mfma_f32_32x32x16_bf16 v[32:47], v[100:103], v[244:247], v[32:47]
    buffer_load_dwordx4 v[20:23], v1, s[4:7], s57 offen sc1
    s_waitcnt lgkmcnt(1)
    v_mfma_f32_32x32x16_bf16 v[32:47], v[104:107], v[248:251], v[32:47]
    s_waitcnt lgkmcnt(0)
    v_mfma_f32_32x32x16_bf16 v[32:47], v[108:111], v[252:255], v[32:47]
    v_mfma_f32_32x32x8_bf16 v[32:47], a[252:253], v[12:13], v[32:47]
    s_barrier
    s_mov_b64 exec, 0xffff
    buffer_load_dword a255, v4, s[4:7], s64 offen sc1
    s_mov_b64 exec, -1
    s_and_b32 s50, s66, 0xfffffe00
    s_mov_b64 exec, 0xf
    buffer_load_dword a255, v4, s[4:7], s50 offen sc1
    s_mov_b64 exec, -1
    v_and_b32_e32 v120, 15, v0
    v_lshrrev_b32_e32 v121, 4, v0
    v_lshlrev_b32_e32 v120, 5, v120
    v_lshl_add_u32 v120, v121, 3, v120
    s_add_u32 s50, s48, 159744
    v_add_u32_e32 v120, s50, v120
    v_and_b32_e32 v123, 31, v0
    v_and_b32_e32 v122, 19, v0
    v_cmp_gt_u32_e32 vcc, 16, v123
    v_lshrrev_b32_e32 v124, 5, v0
    s_nop 0
    v_cndmask_b32_e32 v122, v122, v123, vcc
    v_lshlrev_b32_e32 v122, 5, v122
    v_lshl_add_u32 v122, v124, 4, v122
    v_add_u32_e32 v122, 159744, v122
    v_cvt_pk_bf16_f32 v64, v32, v33
    v_cvt_pk_bf16_f32 v65, v34, v35
    v_cvt_pk_bf16_f32 v66, v36, v37
    v_cvt_pk_bf16_f32 v67, v38, v39
    v_cvt_pk_bf16_f32 v68, v40, v41
    v_cvt_pk_bf16_f32 v69, v42, v43
    v_cvt_pk_bf16_f32 v70, v44, v45
    v_cvt_pk_bf16_f32 v71, v46, v47
    v_mfma_f32_32x32x16_bf16 v[48:63], a[240:243], v[64:67], 0
    s_nop 0
    v_mfma_f32_32x32x16_bf16 v[48:63], a[244:247], v[68:71], v[48:63]
L_chk_37:
    s_waitcnt vmcnt(3)
    v_xor_b32_e32 v16, s78, v16
    s_waitcnt vmcnt(2)
    v_xor_b32_e32 v20, s78, v20
    v_or_b32_e32 v29, v16, v20
    v_and_b32_e32 v29, 0xfff, v29
    v_cmp_ne_u32_e32 vcc, 0, v29
    s_cbranch_vccnz L_retry_38
    v_add_f32_dpp v16, v16, v16 row_ror:4 row_mask:0xf bank_mask:0xf
    v_add_f32_dpp v17, v17, v17 row_ror:4 row_mask:0xf bank_mask:0xf
    v_add_f32_dpp v18, v18, v18 row_ror:4 row_mask:0xf bank_mask:0xf
    v_add_f32_dpp v19, v19, v19 row_ror:4 row_mask:0xf bank_mask:0xf
    v_add_f32_dpp v16, v16, v16 row_ror:8 row_mask:0xf bank_mask:0xf
    v_add_f32_dpp v17, v17, v17 row_ror:8 row_mask:0xf bank_mask:0xf
    v_add_f32_dpp v18, v18, v18 row_ror:8 row_mask:0xf bank_mask:0xf
    v_add_f32_dpp v19, v19, v19 row_ror:8 row_mask:0xf bank_mask:0xf
    v_add_f32_dpp v20, v20, v20 row_ror:4 row_mask:0xf bank_mask:0xf
    v_add_f32_dpp v21, v21, v21 row_ror:4 row_mask:0xf bank_mask:0xf
    v_add_f32_dpp v22, v22, v22 row_ror:4 row_mask:0xf bank_mask:0xf
    v_add_f32_dpp v23, v23, v23 row_ror:4 row_mask:0xf bank_mask:0xf
    v_permlane16_swap_b32_e32 v16, v17
    v_permlane16_swap_b32_e32 v18, v19
    v_add_f32_e32 v16, v16, v17
    v_add_f32_e32 v18, v18, v19
    s_lshl_b32 s50, s38, 6
    s_add_u32 s50, s50, s58
    v_permlane32_swap_b32_e32 v16, v18
    v_add_f32_e32 v16, v16, v18
    v_bfi_b32 v16, v27, s36, v16
    v_mov_b32_e32 v18, v16
    s_nop 1
    v_permlane32_swap_b32_e32 v16, v18
    v_mov_b32_e32 v17, v16
    v_mov_b32_e32 v19, v18
    s_nop 0
    v_permlane16_swap_b32_e32 v16, v17
    v_permlane16_swap_b32_e32 v18, v19
    s_mov_b64 exec, 15
    buffer_store_dwordx4 v[16:19], v1, s[4:7], s50 offen sc1
    s_mov_b64 exec, -1
    v_add_f32_dpp v20, v20, v20 row_ror:8 row_mask:0xf bank_mask:0xf
    v_add_f32_dpp v21, v21, v21 row_ror:8 row_mask:0xf bank_mask:0xf
    v_add_f32_dpp v22, v22, v22 row_ror:8 row_mask:0xf bank_mask:0xf
    v_add_f32_dpp v23, v23, v23 row_ror:8 row_mask:0xf bank_mask:0xf
    v_cvt_pk_bf16_f32 v18, v20, v21
    v_cvt_pk_bf16_f32 v19, v22, v23
    ds_write_b64 v28, v[18:19]
    s_add_u32 s68, s68, s43
    s_add_u32 s69, s69, s43
    s_add_u32 m0, s49, 16384
    s_add_u32 s54, s60, 0
    buffer_load_dwordx4 v1, s[4:7], s54 offen lds
    v_max3_f32 v112, v48, v49, v50
    v_min3_f32 v114, v48, v49, v50
    v_max3_f32 v113, v56, v57, v58
    v_min3_f32 v115, v56, v57, v58
    v_max3_f32 v112, v112, v51, v52
    v_min3_f32 v114, v114, v51, v52
    v_max3_f32 v113, v113, v59, v60
    v_min3_f32 v115, v115, v59, v60
    v_max3_f32 v112, v112, v53, v54
    v_min3_f32 v114, v114, v53, v54
    v_max3_f32 v113, v113, v61, v62
    v_min3_f32 v115, v115, v61, v62
    v_max_f32_e32 v112, v112, v55
    v_min_f32_e32 v114, v114, v55
    v_max_f32_e32 v113, v113, v63
    v_min_f32_e32 v115, v115, v63
    s_nop 0
    v_permlane32_swap_b32_e32 v112, v113
    v_permlane32_swap_b32_e32 v114, v115
    v_max_f32_e32 v112, v112, v113
    v_min_f32_e32 v114, v114, v115
    v_mul_f32_e64 v112, -v112, v9
    v_mul_f32_e32 v114, v114, v9
    v_mov_b32_e32 v116, v112
    v_mov_b32_e32 v118, v114
    s_nop 0
    v_permlane32_swap_b32_e32 v112, v116
    v_permlane32_swap_b32_e32 v114, v118
    v_pk_fma_f32 v[80:81], v[48:49], v[8:9], v[112:113] op_sel:[0,1,0] op_sel_hi:[1,1,0]
    v_pk_fma_f32 v[82:83], v[50:51], v[8:9], v[112:113] op_sel:[0,1,0] op_sel_hi:[1,1,0]
    buffer_load_dwordx4 v1, s[4:7], s54 offen offset:1024 lds
    v_pk_fma_f32 v[84:85], v[52:53], v[8:9], v[112:113] op_sel:[0,1,0] op_sel_hi:[1,1,0]
    v_pk_fma_f32 v[86:87], v[54:55], v[8:9], v[112:113] op_sel:[0,1,0] op_sel_hi:[1,1,0]
    v_pk_fma_f32 v[88:89], v[48:49], v[8:9], v[114:115] op_sel:[0,1,0] op_sel_hi:[1,1,0] neg_lo:[1,0,0] neg_hi:[1,0,0]
    v_pk_fma_f32 v[90:91], v[50:51], v[8:9], v[114:115] op_sel:[0,1,0] op_sel_hi:[1,1,0] neg_lo:[1,0,0] neg_hi:[1,0,0]
    v_pk_fma_f32 v[92:93], v[52:53], v[8:9], v[114:115] op_sel:[0,1,0] op_sel_hi:[1,1,0] neg_lo:[1,0,0] neg_hi:[1,0,0]
    v_pk_fma_f32 v[94:95], v[54:55], v[8:9], v[114:115] op_sel:[0,1,0] op_sel_hi:[1,1,0] neg_lo:[1,0,0] neg_hi:[1,0,0]
    v_pk_fma_f32 v[96:97], v[56:57], v[8:9], v[116:117] op_sel:[0,1,0] op_sel_hi:[1,1,0]
    v_pk_fma_f32 v[98:99], v[58:59], v[8:9], v[116:117] op_sel:[0,1,0] op_sel_hi:[1,1,0]
    v_pk_fma_f32 v[100:101], v[60:61], v[8:9], v[116:117] op_sel:[0,1,0] op_sel_hi:[1,1,0]
    v_pk_fma_f32 v[102:103], v[62:63], v[8:9], v[116:117] op_sel:[0,1,0] op_sel_hi:[1,1,0]
    v_pk_fma_f32 v[104:105], v[56:57], v[8:9], v[118:119] op_sel:[0,1,0] op_sel_hi:[1,1,0] neg_lo:[1,0,0] neg_hi:[1,0,0]
    v_pk_fma_f32 v[106:107], v[58:59], v[8:9], v[118:119] op_sel:[0,1,0] op_sel_hi:[1,1,0] neg_lo:[1,0,0] neg_hi:[1,0,0]
    v_pk_fma_f32 v[108:109], v[60:61], v[8:9], v[118:119] op_sel:[0,1,0] op_sel_hi:[1,1,0] neg_lo:[1,0,0] neg_hi:[1,0,0]
    v_pk_fma_f32 v[110:111], v[62:63], v[8:9], v[118:119] op_sel:[0,1,0] op_sel_hi:[1,1,0] neg_lo:[1,0,0] neg_hi:[1,0,0]
    v_exp_f32_e32 v80, v80
    v_exp_f32_e32 v81, v81
    v_exp_f32_e32 v82, v82
    v_exp_f32_e32 v83, v83
    v_exp_f32_e32 v84, v84
    v_exp_f32_e32 v85, v85
    v_exp_f32_e32 v86, v86
    v_exp_f32_e32 v87, v87
    v_exp_f32_e32 v88, v88
    buffer_load_dwordx4 v1, s[4:7], s54 offen offset:2048 lds
    v_exp_f32_e32 v89, v89
    v_exp_f32_e32 v90, v90
    v_exp_f32_e32 v91, v91
    v_exp_f32_e32 v92, v92
    v_exp_f32_e32 v93, v93
    v_exp_f32_e32 v94, v94
    v_exp_f32_e32 v95, v95
    v_exp_f32_e32 v96, v96
    v_exp_f32_e32 v97, v97
    v_exp_f32_e32 v98, v98
    v_exp_f32_e32 v99, v99
    v_exp_f32_e32 v100, v100
    v_exp_f32_e32 v101, v101
    v_exp_f32_e32 v102, v102
    v_exp_f32_e32 v103, v103
    v_exp_f32_e32 v104, v104
    v_exp_f32_e32 v105, v105
    v_exp_f32_e32 v106, v106
    buffer_load_dwordx4 v1, s[4:7], s54 offen offset:3072 lds
    v_exp_f32_e32 v107, v107
    v_exp_f32_e32 v108, v108
    v_exp_f32_e32 v109, v109
    v_exp_f32_e32 v110, v110
    v_exp_f32_e32 v111, v111
    v_pk_add_f32 v[48:49], v[80:81], v[82:83]
    v_pk_add_f32 v[50:51], v[84:85], v[86:87]
    v_pk_add_f32 v[52:53], v[88:89], v[90:91]
    v_pk_add_f32 v[54:55], v[92:93], v[94:95]
    v_pk_add_f32 v[56:57], v[96:97], v[98:99]
    v_pk_add_f32 v[58:59], v[100:101], v[102:103]
    v_pk_add_f32 v[60:61], v[104:105], v[106:107]
    v_pk_add_f32 v[62:63], v[108:109], v[110:111]
    v_pk_add_f32 v[48:49], v[48:49], v[50:51]
    v_pk_add_f32 v[52:53], v[52:53], v[54:55]
    v_pk_add_f32 v[56:57], v[56:57], v[58:59]
    v_pk_add_f32 v[60:61], v[60:61], v[62:63]
    v_add_f32_e32 v112, v48, v49
    v_add_f32_e32 v114, v52, v53
    v_add_f32_e32 v116, v56, v57
    v_add_f32_e32 v118, v60, v61
    v_permlane32_swap_b32_e32 v112, v114
    s_nop 0
    v_permlane32_swap_b32_e32 v116, v118
    v_add_f32_e32 v112, v112, v114
    s_add_u32 m0, s49, 0
    s_add_u32 s54, s60, 16384
    buffer_load_dwordx4 v1, s[4:7], s54 offen lds
    v_add_f32_e32 v116, v116, v118
    v_rcp_f32_e32 v112, v112
    v_rcp_f32_e32 v116, v116
    v_mov_b32_e32 v114, v112
    v_mov_b32_e32 v118, v116
    s_nop 0
    v_permlane32_swap_b32_e32 v112, v114
    v_permlane32_swap_b32_e32 v116, v118
    v_pk_mul_f32 v[80:81], v[80:81], v[112:113] op_sel_hi:[1,0]
    v_pk_mul_f32 v[82:83], v[82:83], v[112:113] op_sel_hi:[1,0]
    v_pk_mul_f32 v[84:85], v[84:85], v[112:113] op_sel_hi:[1,0]
    v_pk_mul_f32 v[86:87], v[86:87], v[112:113] op_sel_hi:[1,0]
    v_cvt_pk_bf16_f32 v16, v80, v81
    v_cvt_pk_bf16_f32 v17, v82, v83
    v_cvt_pk_bf16_f32 v18, v84, v85
    v_cvt_pk_bf16_f32 v19, v86, v87
    v_pk_mul_f32 v[88:89], v[88:89], v[114:115] op_sel_hi:[1,0]
    v_pk_mul_f32 v[90:91], v[90:91], v[114:115] op_sel_hi:[1,0]
    v_pk_mul_f32 v[92:93], v[92:93], v[114:115] op_sel_hi:[1,0]
    v_pk_mul_f32 v[94:95], v[94:95], v[114:115] op_sel_hi:[1,0]
    v_cvt_pk_bf16_f32 v20, v88, v89
    v_cvt_pk_bf16_f32 v21, v90, v91
    v_cvt_pk_bf16_f32 v22, v92, v93
    v_cvt_pk_bf16_f32 v23, v94, v95
    v_pk_mul_f32 v[96:97], v[96:97], v[116:117] op_sel_hi:[1,0]
    v_pk_mul_f32 v[98:99], v[98:99], v[116:117] op_sel_hi:[1,0]
    v_pk_mul_f32 v[100:101], v[100:101], v[116:117] op_sel_hi:[1,0]
    v_pk_mul_f32 v[102:103], v[102:103], v[116:117] op_sel_hi:[1,0]
    buffer_load_dwordx4 v1, s[4:7], s54 offen offset:1024 lds
    v_cvt_pk_bf16_f32 v24, v96, v97
    v_cvt_pk_bf16_f32 v25, v98, v99
    v_cvt_pk_bf16_f32 v26, v100, v101
    v_cvt_pk_bf16_f32 v27, v102, v103
    v_pk_mul_f32 v[104:105], v[104:105], v[118:119] op_sel_hi:[1,0]
    v_pk_mul_f32 v[106:107], v[106:107], v[118:119] op_sel_hi:[1,0]
    v_pk_mul_f32 v[108:109], v[108:109], v[118:119] op_sel_hi:[1,0]
    v_pk_mul_f32 v[110:111], v[110:111], v[118:119] op_sel_hi:[1,0]
    v_cvt_pk_bf16_f32 v28, v104, v105
    v_cvt_pk_bf16_f32 v29, v106, v107
    v_cvt_pk_bf16_f32 v30, v108, v109
    v_cvt_pk_bf16_f32 v31, v110, v111
    buffer_load_dwordx4 v[32:35], v1, s[4:7], s58 offen sc1
    s_barrier
    s_add_u32 m0, s49, 0
    s_add_u32 s54, s60, 16384
    buffer_load_dwordx4 v1, s[4:7], s54 offen offset:2048 lds
    v_bfe_u32 v76, v0, 2, 2
    v_lshlrev_b32_e32 v74, 6, v76
    v_lshrrev_b32_e32 v76, 5, v0
    v_lshl_add_u32 v74, v76, 10, v74
    v_bfe_u32 v76, v0, 4, 1
    v_lshl_add_u32 v74, v76, 5, v74
    v_and_b32_e32 v76, 3, v0
    v_lshl_add_u32 v74, v76, 3, v74
    s_mul_i32 s50, s46, 49664
    s_add_u32 s50, s50, 65536
    v_add_u32_e32 v74, s50, v74
    v_xor_b32_e32 v75, 0x200, v74
    ds_read_b64_tr_b16 v[128:129], v75 offset:0
    ds_read_b64_tr_b16 v[130:131], v75 offset:256
    ds_read_b64_tr_b16 v[132:133], v74 offset:0
    ds_read_b64_tr_b16 v[134:135], v74 offset:256
    ds_read_b64_tr_b16 v[136:137], v75 offset:2048
    ds_read_b64_tr_b16 v[138:139], v75 offset:2304
    ds_read_b64_tr_b16 v[140:141], v74 offset:2048
    ds_read_b64_tr_b16 v[142:143], v74 offset:2304
    ds_read_b64_tr_b16 v[144:145], v75 offset:4096
    ds_read_b64_tr_b16 v[146:147], v75 offset:4352
    ds_read_b64_tr_b16 v[148:149], v74 offset:4096
    ds_read_b64_tr_b16 v[150:151], v74 offset:4352
    ds_read_b64_tr_b16 v[152:153], v75 offset:6144
    ds_read_b64_tr_b16 v[154:155], v75 offset:6400
    ds_read_b64_tr_b16 v[156:157], v74 offset:6144
    ds_read_b64_tr_b16 v[158:159], v74 offset:6400
    ds_read_b64_tr_b16 v[160:161], v75 offset:8192
    ds_read_b64_tr_b16 v[162:163], v75 offset:8448
    ds_read_b64_tr_b16 v[164:165], v74 offset:8192
    ds_read_b64_tr_b16 v[166:167], v74 offset:8448
    buffer_load_dwordx4 v1, s[4:7], s54 offen offset:3072 lds
    ds_read_b64_tr_b16 v[168:169], v75 offset:10240
    ds_read_b64_tr_b16 v[170:171], v75 offset:10496
    ds_read_b64_tr_b16 v[172:173], v74 offset:10240
    ds_read_b64_tr_b16 v[174:175], v74 offset:10496
    ds_read_b64_tr_b16 v[176:177], v75 offset:12288
    ds_read_b64_tr_b16 v[178:179], v75 offset:12544
    ds_read_b64_tr_b16 v[180:181], v74 offset:12288
    ds_read_b64_tr_b16 v[182:183], v74 offset:12544
    ds_read_b64_tr_b16 v[184:185], v75 offset:14336
    ds_read_b64_tr_b16 v[186:187], v75 offset:14592
    ds_read_b64_tr_b16 v[188:189], v74 offset:14336
    ds_read_b64_tr_b16 v[190:191], v74 offset:14592
    ds_read_b64_tr_b16 v[192:193], v75 offset:16384
    ds_read_b64_tr_b16 v[194:195], v75 offset:16640
    ds_read_b64_tr_b16 v[196:197], v74 offset:16384
    ds_read_b64_tr_b16 v[198:199], v74 offset:16640
    ds_read_b64_tr_b16 v[200:201], v75 offset:18432
    ds_read_b64_tr_b16 v[202:203], v75 offset:18688
    ds_read_b64_tr_b16 v[204:205], v74 offset:18432
    ds_read_b64_tr_b16 v[206:207], v74 offset:18688
    ds_read_b64_tr_b16 v[208:209], v75 offset:20480
    ds_read_b64_tr_b16 v[210:211], v75 offset:20736
    ds_read_b64_tr_b16 v[212:213], v74 offset:20480
    ds_read_b64_tr_b16 v[214:215], v74 offset:20736
    ds_read_b64_tr_b16 v[216:217], v75 offset:22528
    ds_read_b64_tr_b16 v[218:219], v75 offset:22784
    ds_read_b64_tr_b16 v[220:221], v74 offset:22528
    ds_read_b64_tr_b16 v[222:223], v74 offset:22784
    ds_read_b64_tr_b16 v[224:225], v75 offset:24576
    ds_read_b64_tr_b16 v[226:227], v75 offset:24832
    s_add_u32 m0, s49, 49152
    s_add_u32 s54, s60, 32768
    buffer_load_dwordx4 v1, s[4:7], s54 offen lds
    ds_read_b64_tr_b16 v[228:229], v74 offset:24576
    ds_read_b64_tr_b16 v[230:231], v74 offset:24832
    ds_read_b64_tr_b16 v[232:233], v75 offset:26624
    ds_read_b64_tr_b16 v[234:235], v75 offset:26880
    ds_read_b64_tr_b16 v[236:237], v74 offset:26624
    ds_read_b64_tr_b16 v[238:239], v74 offset:26880
    ds_read_b64_tr_b16 v[240:241], v75 offset:28672
    ds_read_b64_tr_b16 v[242:243], v75 offset:28928
    ds_read_b64_tr_b16 v[244:245], v74 offset:28672
    ds_read_b64_tr_b16 v[246:247], v74 offset:28928
    ds_read_b64_tr_b16 v[248:249], v75 offset:30720
    ds_read_b64_tr_b16 v[250:251], v75 offset:30976
    ds_read_b64_tr_b16 v[252:253], v74 offset:30720
    ds_read_b64_tr_b16 v[254:255], v74 offset:30976
L_chk_39:
    s_waitcnt vmcnt(3)
    v_xor_b32_e32 v32, s78, v32
    v_and_b32_e32 v36, 0xfff, v32
    v_cmp_ne_u32_e32 vcc, 0, v36
    v_cvt_pk_bf16_f32 v38, v32, v33
    v_cvt_pk_bf16_f32 v39, v34, v35
    s_cbranch_vccnz L_retry_40
    ds_write_b64 v120, v[38:39]
    s_waitcnt lgkmcnt(0)
    s_barrier
    ds_read_b128 v[80:83], v122 offset:0
    ds_read_b128 v[84:87], v122 offset:1024
    ds_read_b128 v[88:91], v122 offset:2048
    ds_read_b128 v[92:95], v122 offset:3072
    s_add_u32 m0, s49, 49152
    s_add_u32 s54, s60, 32768
    buffer_load_dwordx4 v1, s[4:7], s54 offen offset:1024 lds
    buffer_load_dwordx4 v1, s[4:7], s54 offen offset:2048 lds
    s_waitcnt lgkmcnt(3)
    v_mfma_f32_32x32x16_bf16 v[32:47], v[80:83], v[16:19], 0
    s_waitcnt lgkmcnt(2)
    v_mfma_f32_32x32x16_bf16 v[32:47], v[84:87], v[20:23], v[32:47]
    s_waitcnt lgkmcnt(1)
    v_mfma_f32_32x32x16_bf16 v[48:63], v[88:91], v[24:27], 0
    s_waitcnt lgkmcnt(0)
    v_mfma_f32_32x32x16_bf16 v[48:63], v[92:95], v[28:31], v[48:63]
    s_nop 7
    v_add_f32_e32 v40, v40, v41
    v_add_f32_e32 v42, v42, v43
    v_add_f32_e32 v40, 0x358637bd, v40
    v_add_f32_e32 v40, v40, v42
    v_rcp_f32_e32 v40, v40
    s_nop 0
    v_mul_f32_e32 v32, v40, v32
    v_mul_f32_e32 v33, v40, v33
    v_mul_f32_e32 v34, v40, v34
    v_mul_f32_e32 v35, v40, v35
    v_mul_f32_e32 v36, v40, v36
    v_mul_f32_e32 v37, v40, v37
    v_mul_f32_e32 v38, v40, v38
    v_mul_f32_e32 v39, v40, v39
    v_cvt_pk_bf16_f32 v44, v32, v33
    v_cvt_pk_bf16_f32 v45, v34, v35
    v_cvt_pk_bf16_f32 v46, v36, v37
    v_cvt_pk_bf16_f32 v47, v38, v39
    buffer_store_dwordx4 v[44:47], v1, s[4:7], s68 offen offset:0
    v_add_f32_e32 v56, v56, v57
    v_add_f32_e32 v58, v58, v59
    v_add_f32_e32 v56, 0x358637bd, v56
    v_add_f32_e32 v56, v56, v58
    v_rcp_f32_e32 v56, v56
    s_nop 0
    v_pk_mul_f32 v[48:49], v[48:49], v[56:57] op_sel_hi:[1,0]
    v_pk_mul_f32 v[50:51], v[50:51], v[56:57] op_sel_hi:[1,0]
    v_pk_mul_f32 v[52:53], v[52:53], v[56:57] op_sel_hi:[1,0]
    v_pk_mul_f32 v[54:55], v[54:55], v[56:57] op_sel_hi:[1,0]
    v_cvt_pk_bf16_f32 v60, v48, v49
    v_cvt_pk_bf16_f32 v61, v50, v51
    v_cvt_pk_bf16_f32 v62, v52, v53
    v_cvt_pk_bf16_f32 v63, v54, v55
    buffer_store_dwordx4 v[60:63], v1, s[4:7], s68 offen offset:1024
    s_add_u32 m0, s49, 49152
    s_add_u32 s54, s60, 32768
    buffer_load_dwordx4 v1, s[4:7], s54 offen offset:3072 lds
    s_add_u32 m0, s49, 32768
    s_add_u32 s54, s60, 49152
    buffer_load_dwordx4 v1, s[4:7], s54 offen lds
    buffer_load_dwordx4 v1, s[4:7], s54 offen offset:1024 lds
    buffer_load_dwordx4 v1, s[4:7], s54 offen offset:2048 lds
    s_xor_b32 s50, s49, 4096
    s_add_u32 s50, s50, 65536
    v_add_u32_e32 v112, s50, v1
    s_add_u32 s50, s49, 65536
    v_add_u32_e32 v113, s50, v1
    v_and_b32_e32 v114, 31, v0
    v_lshrrev_b32_e32 v115, 5, v0
    v_lshlrev_b32_e32 v114, 4, v114
    v_lshl_add_u32 v114, v115, 2, v114
    s_add_u32 s64, s64, s43
    s_add_u32 s65, s65, s43
    s_add_u32 s66, s66, s43
    s_add_u32 s67, s67, s43
    v_accvgpr_read_b32 v16, a224
    v_accvgpr_read_b32 v17, a225
    v_accvgpr_read_b32 v18, a226
    v_accvgpr_read_b32 v19, a227
    v_accvgpr_read_b32 v20, a228
    v_accvgpr_read_b32 v21, a229
    v_accvgpr_read_b32 v22, a230
    v_accvgpr_read_b32 v23, a231
    v_accvgpr_read_b32 v24, a232
    v_accvgpr_read_b32 v25, a233
    v_accvgpr_read_b32 v26, a234
    v_accvgpr_read_b32 v27, a235
    v_accvgpr_read_b32 v28, a236
    v_accvgpr_read_b32 v29, a237
    v_accvgpr_read_b32 v30, a238
    v_accvgpr_read_b32 v31, a239
    v_and_b32_e32 v15, 7, v0
    v_lshlrev_b32_e32 v15, 2, v15
    s_mov_b32 s52, s69
    v_mov_b32_e32 v14, s36
    s_cmp_lg_u32 s43, 0
    s_mov_b64 exec, 1
    s_waitcnt vmcnt(4)
    s_cbranch_scc1 L_slow_41
    buffer_store_dword v14, off, s[4:7], s73 offset:512
L_back_42:
    s_mov_b64 exec, -1
L_poll_43:
    s_add_u32 s44, s44, 1
    s_cbranch_scc1 L_abort
    buffer_load_dword v14, v15, s[4:7], s74 offen offset:512 sc1
    s_waitcnt vmcnt(0)
    v_cmp_ne_u32_e32 vcc, s36, v14
    s_cbranch_vccnz L_poll_43
    buffer_load_dwordx4 v[80:83], v1, s[4:7], s52 offen offset:0 sc1
    buffer_load_dwordx4 v[84:87], v1, s[4:7], s52 offen offset:1024 sc1
    buffer_load_dwordx4 v[88:91], v1, s[4:7], s52 offen offset:2048 sc1
    buffer_load_dwordx4 v[92:95], v1, s[4:7], s52 offen offset:3072 sc1
    s_add_u32 s52, s52, 4096
    buffer_load_dwordx4 v[96:99], v1, s[4:7], s52 offen offset:0 sc1
    buffer_load_dwordx4 v[100:103], v1, s[4:7], s52 offen offset:1024 sc1
    buffer_load_dwordx4 v[104:107], v1, s[4:7], s52 offen offset:2048 sc1
    buffer_load_dwordx4 v[108:111], v1, s[4:7], s52 offen offset:3072 sc1
    s_waitcnt vmcnt(7)
    v_mfma_f32_32x32x16_bf16 v[32:47], v[128:131], v[80:83], 0
    v_mfma_f32_32x32x16_bf16 v[16:31], v[132:135], v[80:83], v[16:31]
    s_add_u32 s52, s52, 4096
    buffer_load_dwordx4 v[48:51], v1, s[4:7], s52 offen offset:0 sc1
    s_waitcnt vmcnt(7)
    v_mfma_f32_32x32x16_bf16 v[32:47], v[136:139], v[84:87], v[32:47]
    v_mfma_f32_32x32x16_bf16 v[16:31], v[140:143], v[84:87], v[16:31]
    buffer_load_dwordx4 v[52:55], v1, s[4:7], s52 offen offset:1024 sc1
    s_waitcnt vmcnt(7)
    v_mfma_f32_32x32x16_bf16 v[32:47], v[144:147], v[88:91], v[32:47]
    v_mfma_f32_32x32x16_bf16 v[16:31], v[148:151], v[88:91], v[16:31]
    buffer_load_dwordx4 v[56:59], v1, s[4:7], s52 offen offset:2048 sc1
    s_waitcnt vmcnt(7)
    v_mfma_f32_32x32x16_bf16 v[32:47], v[152:155], v[92:95], v[32:47]
    v_mfma_f32_32x32x16_bf16 v[16:31], v[156:159], v[92:95], v[16:31]
    buffer_load_dwordx4 v[60:63], v1, s[4:7], s52 offen offset:3072 sc1
    s_waitcnt vmcnt(7)
    v_mfma_f32_32x32x16_bf16 v[32:47], v[160:163], v[96:99], v[32:47]
    v_mfma_f32_32x32x16_bf16 v[16:31], v[164:167], v[96:99], v[16:31]
    s_add_u32 s52, s52, 4096
    buffer_load_dwordx4 v[64:67], v1, s[4:7], s52 offen offset:0 sc1
    s_waitcnt vmcnt(7)
    v_mfma_f32_32x32x16_bf16 v[32:47], v[168:171], v[100:103], v[32:47]
    v_mfma_f32_32x32x16_bf16 v[16:31], v[172:175], v[100:103], v[16:31]
    buffer_load_dwordx4 v[68:71], v1, s[4:7], s52 offen offset:1024 sc1
    s_waitcnt vmcnt(7)
    v_mfma_f32_32x32x16_bf16 v[32:47], v[176:179], v[104:107], v[32:47]
    v_mfma_f32_32x32x16_bf16 v[16:31], v[180:183], v[104:107], v[16:31]
    buffer_load_dwordx4 v[72:75], v1, s[4:7], s52 offen offset:2048 sc1
    s_waitcnt vmcnt(7)
    v_mfma_f32_32x32x16_bf16 v[32:47], v[184:187], v[108:111], v[32:47]
    v_mfma_f32_32x32x16_bf16 v[16:31], v[188:191], v[108:111], v[16:31]
    buffer_load_dwordx4 v[76:79], v1, s[4:7], s52 offen offset:3072 sc1
    s_waitcnt vmcnt(7)
    v_mfma_f32_32x32x16_bf16 v[32:47], v[192:195], v[48:51], v[32:47]
    v_mfma_f32_32x32x16_bf16 v[16:31], v[196:199], v[48:51], v[16:31]
    s_add_u32 m0, s49, 32768
    s_add_u32 s54, s60, 49152
    buffer_load_dwordx4 v1, s[4:7], s54 offen offset:3072 lds
    s_waitcnt vmcnt(7)
    v_mfma_f32_32x32x16_bf16 v[32:47], v[200:203], v[52:55], v[32:47]
    v_mfma_f32_32x32x16_bf16 v[16:31], v[204:207], v[52:55], v[16:31]
    s_waitcnt vmcnt(6)
    v_mfma_f32_32x32x16_bf16 v[32:47], v[208:211], v[56:59], v[32:47]
    v_mfma_f32_32x32x16_bf16 v[16:31], v[212:215], v[56:59], v[16:31]
    s_add_u32 m0, s49, 98304
    s_add_u32 s54, s60, 65536
    buffer_load_dwordx4 v1, s[4:7], s54 offen lds
    s_waitcnt vmcnt(6)
    v_mfma_f32_32x32x16_bf16 v[32:47], v[216:219], v[60:63], v[32:47]
    v_mfma_f32_32x32x16_bf16 v[16:31], v[220:223], v[60:63], v[16:31]
    buffer_load_dwordx4 v1, s[4:7], s54 offen offset:1024 lds
    s_waitcnt vmcnt(6)
    v_mfma_f32_32x32x16_bf16 v[32:47], v[224:227], v[64:67], v[32:47]
    v_mfma_f32_32x32x16_bf16 v[16:31], v[228:231], v[64:67], v[16:31]
    buffer_load_dwordx4 v1, s[4:7], s54 offen offset:2048 lds
    s_waitcnt vmcnt(6)
    v_mfma_f32_32x32x16_bf16 v[32:47], v[232:235], v[68:71], v[32:47]
    s_waitcnt vmcnt(5)
    v_mfma_f32_32x32x16_bf16 v[32:47], v[240:243], v[72:75], v[32:47]
    buffer_load_dwordx4 v1, s[4:7], s54 offen offset:3072 lds
    s_waitcnt vmcnt(5)
    v_mfma_f32_32x32x16_bf16 v[32:47], v[248:251], v[76:79], v[32:47]
    v_mfma_f32_32x32x16_bf16 v[16:31], v[236:239], v[68:71], v[16:31]
    v_mfma_f32_32x32x16_bf16 v[16:31], v[244:247], v[72:75], v[16:31]
    s_add_u32 m0, s49, 81920
    s_add_u32 s54, s60, 81920
    buffer_load_dwordx4 v1, s[4:7], s54 offen lds
    v_mfma_f32_32x32x16_bf16 v[16:31], v[252:255], v[76:79], v[16:31]
    s_nop 5
    ds_write_b128 v112, v[32:35] offset:0
    ds_write_b128 v112, v[36:39] offset:1024
    ds_write_b128 v112, v[40:43] offset:2048
    ds_write_b128 v112, v[44:47] offset:3072
    s_waitcnt lgkmcnt(0)
    s_barrier
    ds_read_b128 v[48:51], v113 offset:0
    ds_read_b128 v[52:55], v113 offset:1024
    ds_read_b128 v[56:59], v113 offset:2048
    ds_read_b128 v[60:63], v113 offset:3072
    s_waitcnt lgkmcnt(3)
    v_pk_add_f32 v[16:17], v[16:17], v[48:49]
    v_pk_add_f32 v[18:19], v[18:19], v[50:51]
    s_waitcnt lgkmcnt(2)
    v_pk_add_f32 v[20:21], v[20:21], v[52:53]
    v_pk_add_f32 v[22:23], v[22:23], v[54:55]
    v_cvt_pk_bf16_f32 v32, v16, v17
    v_cvt_pk_bf16_f32 v33, v18, v19
    v_cvt_pk_bf16_f32 v34, v20, v21
    v_cvt_pk_bf16_f32 v35, v22, v23
    buffer_store_dwordx4 v[32:35], v1, s[4:7], s64 offen offset:0
    s_waitcnt lgkmcnt(1)
    v_pk_add_f32 v[24:25], v[24:25], v[56:57]
    v_pk_add_f32 v[26:27], v[26:27], v[58:59]
    s_waitcnt lgkmcnt(0)
    v_pk_add_f32 v[28:29], v[28:29], v[60:61]
    v_pk_add_f32 v[30:31], v[30:31], v[62:63]
    v_cvt_pk_bf16_f32 v36, v24, v25
    v_cvt_pk_bf16_f32 v37, v26, v27
    v_cvt_pk_bf16_f32 v38, v28, v29
    v_cvt_pk_bf16_f32 v39, v30, v31
    buffer_store_dwordx4 v[36:39], v1, s[4:7], s64 offen offset:1024
    v_pk_add_f32 v[48:49], v[16:17], v[18:19]
    v_pk_mul_f32 v[50:51], v[16:17], v[16:17]
    v_pk_fma_f32 v[50:51], v[18:19], v[18:19], v[50:51]
    v_pk_add_f32 v[48:49], v[48:49], v[20:21]
    v_pk_fma_f32 v[50:51], v[20:21], v[20:21], v[50:51]
    v_pk_add_f32 v[48:49], v[48:49], v[22:23]
    v_pk_fma_f32 v[50:51], v[22:23], v[22:23], v[50:51]
    v_pk_add_f32 v[48:49], v[48:49], v[24:25]
    v_pk_fma_f32 v[50:51], v[24:25], v[24:25], v[50:51]
    v_pk_add_f32 v[48:49], v[48:49], v[26:27]
    v_pk_fma_f32 v[50:51], v[26:27], v[26:27], v[50:51]
    v_pk_add_f32 v[48:49], v[48:49], v[28:29]
    v_pk_fma_f32 v[50:51], v[28:29], v[28:29], v[50:51]
    v_pk_add_f32 v[48:49], v[48:49], v[30:31]
    v_pk_fma_f32 v[50:51], v[30:31], v[30:31], v[50:51]
    v_add_f32_e32 v48, v48, v49
    v_add_f32_e32 v50, v50, v51
    s_nop 1
    v_permlane32_swap_b32_e32 v48, v50
    v_add_f32_e32 v48, v48, v50
    buffer_store_dword v48, v114, s[4:7], s66 offen
    s_add_u32 m0, s49, 81920
    s_add_u32 s54, s60, 81920
    buffer_load_dwordx4 v1, s[4:7], s54 offen offset:1024 lds
    buffer_load_dwordx4 v1, s[4:7], s54 offen offset:2048 lds
    buffer_load_dwordx4 v1, s[4:7], s54 offen offset:3072 lds
    s_add_u32 m0, s49, 114688
    s_add_u32 s54, s60, 98304
    buffer_load_dwordx4 v1, s[4:7], s54 offen lds
    v_accvgpr_write_b32 a224, v16
    v_accvgpr_write_b32 a225, v17
    v_accvgpr_write_b32 a226, v18
    v_accvgpr_write_b32 a227, v19
    v_accvgpr_write_b32 a228, v20
    v_accvgpr_write_b32 a229, v21
    v_accvgpr_write_b32 a230, v22
    v_accvgpr_write_b32 a231, v23
    v_accvgpr_write_b32 a232, v24
    v_accvgpr_write_b32 a233, v25
    v_accvgpr_write_b32 a234, v26
    v_accvgpr_write_b32 a235, v27
    v_accvgpr_write_b32 a236, v28
    v_accvgpr_write_b32 a237, v29
    v_accvgpr_write_b32 a238, v30
    v_accvgpr_write_b32 a239, v31
    v_and_b32_e32 v15, 15, v0
    v_lshlrev_b32_e32 v15, 2, v15
    s_mov_b32 s52, s65
    v_and_b32_e32 v4, 31, v0
    v_lshrrev_b32_e32 v116, 5, v0
    v_lshlrev_b32_e32 v4, 4, v4
    v_lshl_add_u32 v4, v116, 11, v4
    s_add_u32 s70, s70, s43
    s_add_u32 s61, s61, s43
    v_and_b32_e32 v5, 31, v0
    v_lshlrev_b32_e32 v5, 3, v5
    v_add_u32_e32 v5, 155648, v5
    ds_read_b128 v[80:83], v1 offset:16384
    ds_read_b128 v[84:87], v1 offset:17408
    ds_read_b128 v[88:91], v1 offset:18432
    ds_read_b128 v[92:95], v1 offset:19456
    ds_read_b128 v[96:99], v1 offset:20480
    ds_read_b128 v[100:103], v1 offset:21504
    ds_read_b128 v[104:107], v1 offset:22528
    v_mov_b32_e32 v14, s36
    s_cmp_lg_u32 s43, 0
    s_mov_b64 exec, 1
    s_waitcnt vmcnt(4)
    s_cbranch_scc1 L_slow_44
    buffer_store_dword v14, off, s[4:7], s71 offset:256
L_back_45:
    s_mov_b64 exec, -1
L_poll_46:
    s_add_u32 s44, s44, 1
    s_cbranch_scc1 L_abort
    buffer_load_dword v14, v15, s[4:7], s72 offen offset:256 sc1
    s_waitcnt vmcnt(0)
    v_cmp_ne_u32_e32 vcc, s36, v14
    s_cbranch_vccnz L_poll_46
    buffer_load_dwordx4 v[128:131], v1, s[4:7], s52 offen offset:0 sc1
    buffer_load_dwordx4 v[132:135], v1, s[4:7], s52 offen offset:1024 sc1
    buffer_load_dwordx4 v[136:139], v1, s[4:7], s52 offen offset:2048 sc1
    buffer_load_dwordx4 v[140:143], v1, s[4:7], s52 offen offset:3072 sc1
    s_add_u32 s52, s52, 4096
    buffer_load_dwordx4 v[144:147], v1, s[4:7], s52 offen offset:0 sc1
    buffer_load_dwordx4 v[148:151], v1, s[4:7], s52 offen offset:1024 sc1
    buffer_load_dwordx4 v[152:155], v1, s[4:7], s52 offen offset:2048 sc1
    v_and_b32_e32 v15, 31, v0
    v_lshlrev_b32_e32 v15, 2, v15
    s_waitcnt lgkmcnt(3)
    s_waitcnt vmcnt(6)
    v_mfma_f32_32x32x16_bf16 v[16:31], v[80:83], v[128:131], 0
    ds_read_b128 v[108:111], v1 offset:23552
    v_mfma_f32_32x32x16_bf16 v[32:47], v[84:87], v[128:131], 0
    ds_read_b128 v[80:83], v1 offset:24576
    buffer_load_dwordx4 v[156:159], v1, s[4:7], s52 offen offset:3072 sc1
    v_mfma_f32_32x32x16_bf16 v[48:63], v[88:91], v[128:131], 0
    ds_read_b128 v[84:87], v1 offset:25600
    s_waitcnt vmcnt(6)
    v_mfma_f32_32x32x16_bf16 v[16:31], v[92:95], v[132:135], v[16:31]
    ds_read_b128 v[88:91], v1 offset:26624
    s_waitcnt lgkmcnt(3)
    v_mfma_f32_32x32x16_bf16 v[32:47], v[96:99], v[132:135], v[32:47]
    ds_read_b128 v[92:95], v1 offset:27648
    s_add_u32 s52, s52, 4096
    buffer_load_dwordx4 v[160:163], v1, s[4:7], s52 offen offset:0 sc1
    v_mfma_f32_32x32x16_bf16 v[48:63], v[100:103], v[132:135], v[48:63]
    ds_read_b128 v[96:99], v1 offset:28672
    s_waitcnt vmcnt(6)
    v_mfma_f32_32x32x16_bf16 v[16:31], v[104:107], v[136:139], v[16:31]
    ds_read_b128 v[100:103], v1 offset:29696
    buffer_load_dwordx4 v[164:167], v1, s[4:7], s52 offen offset:1024 sc1
    v_mfma_f32_32x32x16_bf16 v[32:47], v[108:111], v[136:139], v[32:47]
    ds_read_b128 v[104:107], v1 offset:30720
    s_waitcnt lgkmcnt(3)
    v_mfma_f32_32x32x16_bf16 v[48:63], v[80:83], v[136:139], v[48:63]
    ds_read_b128 v[108:111], v1 offset:31744
    s_waitcnt vmcnt(6)
    v_mfma_f32_32x32x16_bf16 v[16:31], v[84:87], v[140:143], v[16:31]
    ds_read_b128 v[80:83], v1 offset:0
    buffer_load_dwordx4 v[168:171], v1, s[4:7], s52 offen offset:2048 sc1
    v_mfma_f32_32x32x16_bf16 v[32:47], v[88:91], v[140:143], v[32:47]
    ds_read_b128 v[84:87], v1 offset:1024
    v_mfma_f32_32x32x16_bf16 v[48:63], v[92:95], v[140:143], v[48:63]
    ds_read_b128 v[88:91], v1 offset:2048
    buffer_load_dwordx4 v[172:175], v1, s[4:7], s52 offen offset:3072 sc1
    s_waitcnt lgkmcnt(3)
    s_waitcnt vmcnt(7)
    v_mfma_f32_32x32x16_bf16 v[16:31], v[96:99], v[144:147], v[16:31]
    ds_read_b128 v[92:95], v1 offset:3072
    v_mfma_f32_32x32x16_bf16 v[32:47], v[100:103], v[144:147], v[32:47]
    ds_read_b128 v[96:99], v1 offset:4096
    v_mfma_f32_32x32x16_bf16 v[48:63], v[104:107], v[144:147], v[48:63]
    ds_read_b128 v[100:103], v1 offset:5120
    s_add_u32 s52, s52, 4096
    buffer_load_dwordx4 v[176:179], v1, s[4:7], s52 offen offset:0 sc1
    s_waitcnt vmcnt(7)
    v_mfma_f32_32x32x16_bf16 v[16:31], v[108:111], v[148:151], v[16:31]
    ds_read_b128 v[104:107], v1 offset:6144
    s_waitcnt lgkmcnt(3)
    v_mfma_f32_32x32x16_bf16 v[32:47], v[80:83], v[148:151], v[32:47]
    ds_read_b128 v[108:111], v1 offset:7168
    v_mfma_f32_32x32x16_bf16 v[48:63], v[84:87], v[148:151], v[48:63]
    ds_read_b128 v[80:83], v1 offset:8192
    buffer_load_dwordx4 v[180:183], v1, s[4:7], s52 offen offset:1024 sc1
    s_waitcnt vmcnt(7)
    v_mfma_f32_32x32x16_bf16 v[16:31], v[88:91], v[152:155], v[16:31]
    ds_read_b128 v[84:87], v1 offset:9216
    v_mfma_f32_32x32x16_bf16 v[32:47], v[92:95], v[152:155], v[32:47]
    ds_read_b128 v[88:91], v1 offset:10240
    buffer_load_dwordx4 v[184:187], v1, s[4:7], s52 offen offset:2048 sc1
    s_waitcnt lgkmcnt(3)
    v_mfma_f32_32x32x16_bf16 v[48:63], v[96:99], v[152:155], v[48:63]
    ds_read_b128 v[92:95], v1 offset:11264
    s_waitcnt vmcnt(7)
    v_mfma_f32_32x32x16_bf16 v[16:31], v[100:103], v[156:159], v[16:31]
    ds_read_b128 v[96:99], v1 offset:12288
    buffer_load_dwordx4 v[188:191], v1, s[4:7], s52 offen offset:3072 sc1
    v_mfma_f32_32x32x16_bf16 v[32:47], v[104:107], v[156:159], v[32:47]
    ds_read_b128 v[100:103], v1 offset:13312
    v_mfma_f32_32x32x16_bf16 v[48:63], v[108:111], v[156:159], v[48:63]
    ds_read_b128 v[104:107], v1 offset:14336
    s_waitcnt lgkmcnt(3)
    s_waitcnt vmcnt(7)
    v_mfma_f32_32x32x16_bf16 v[16:31], v[80:83], v[160:163], v[16:31]
    ds_read_b128 v[108:111], v1 offset:15360
    s_add_u32 s52, s52, 4096
    buffer_load_dwordx4 v[192:195], v1, s[4:7], s52 offen offset:0 sc1
    s_barrier
    v_mfma_f32_32x32x16_bf16 v[32:47], v[84:87], v[160:163], v[32:47]
    ds_read_b128 v[80:83], v1 offset:49152
    v_mfma_f32_32x32x16_bf16 v[48:63], v[88:91], v[160:163], v[48:63]
    ds_read_b128 v[84:87], v1 offset:50176
    s_waitcnt vmcnt(7)
    v_mfma_f32_32x32x16_bf16 v[16:31], v[92:95], v[164:167], v[16:31]
    ds_read_b128 v[88:91], v1 offset:51200
    buffer_load_dwordx4 v[196:199], v1, s[4:7], s52 offen offset:1024 sc1
    s_waitcnt lgkmcnt(3)
    v_mfma_f32_32x32x16_bf16 v[32:47], v[96:99], v[164:167], v[32:47]
    ds_read_b128 v[92:95], v1 offset:52224
    v_mfma_f32_32x32x16_bf16 v[48:63], v[100:103], v[164:167], v[48:63]
    ds_read_b128 v[96:99], v1 offset:53248
    s_waitcnt vmcnt(7)
    v_mfma_f32_32x32x16_bf16 v[16:31], v[104:107], v[168:171], v[16:31]
    ds_read_b128 v[100:103], v1 offset:54272
    buffer_load_dwordx4 v[200:203], v1, s[4:7], s52 offen offset:2048 sc1
    v_mfma_f32_32x32x16_bf16 v[32:47], v[108:111], v[168:171], v[32:47]
    ds_read_b128 v[104:107], v1 offset:55296
    s_add_u32 m0, s49, 114688
    s_add_u32 s54, s60, 98304
    buffer_load_dwordx4 v1, s[4:7], s54 offen offset:1024 lds
    s_waitcnt lgkmcnt(3)
    v_mfma_f32_32x32x16_bf16 v[48:63], v[80:83], v[168:171], v[48:63]
    ds_read_b128 v[108:111], v1 offset:56320
    buffer_load_dwordx4 v[204:207], v1, s[4:7], s52 offen offset:3072 sc1
    s_waitcnt vmcnt(9)
    v_mfma_f32_32x32x16_bf16 v[16:31], v[84:87], v[172:175], v[16:31]
    ds_read_b128 v[80:83], v1 offset:57344
    v_mfma_f32_32x32x16_bf16 v[32:47], v[88:91], v[172:175], v[32:47]
    ds_read_b128 v[84:87], v1 offset:58368
    buffer_load_dwordx4 v[112:115], v4, s[4:7], s67 offen offset:0 sc1
    v_mfma_f32_32x32x16_bf16 v[48:63], v[92:95], v[172:175], v[48:63]
    ds_read_b128 v[88:91], v1 offset:59392
    s_waitcnt lgkmcnt(3)
    s_waitcnt vmcnt(9)
    v_mfma_f32_32x32x16_bf16 v[16:31], v[96:99], v[176:179], v[16:31]
    ds_read_b128 v[92:95], v1 offset:60416
    buffer_load_dwordx4 v[116:119], v4, s[4:7], s67 offen offset:512 sc1
    v_mfma_f32_32x32x16_bf16 v[32:47], v[100:103], v[176:179], v[32:47]
    ds_read_b128 v[96:99], v1 offset:61440
    buffer_load_dwordx4 v1, s[4:7], s54 offen offset:2048 lds
    v_mfma_f32_32x32x16_bf16 v[48:63], v[104:107], v[176:179], v[48:63]
    ds_read_b128 v[100:103], v1 offset:62464
    s_waitcnt vmcnt(10)
    v_mfma_f32_32x32x16_bf16 v[16:31], v[108:111], v[180:183], v[16:31]
    ds_read_b128 v[104:107], v1 offset:63488
    buffer_load_dwordx4 v[120:123], v4, s[4:7], s67 offen offset:1024 sc1
    s_waitcnt lgkmcnt(3)
    v_mfma_f32_32x32x16_bf16 v[32:47], v[80:83], v[180:183], v[32:47]
    ds_read_b128 v[108:111], v1 offset:64512
    v_mfma_f32_32x32x16_bf16 v[48:63], v[84:87], v[180:183], v[48:63]
    ds_read_b128 v[80:83], v1 offset:32768
    buffer_load_dwordx4 v[124:127], v4, s[4:7], s67 offen offset:1536 sc1
    s_waitcnt vmcnt(11)
    v_mfma_f32_32x32x16_bf16 v[16:31], v[88:91], v[184:187], v[16:31]
    ds_read_b128 v[84:87], v1 offset:33792
    buffer_load_dwordx4 v1, s[4:7], s54 offen offset:3072 lds
    v_mfma_f32_32x32x16_bf16 v[32:47], v[92:95], v[184:187], v[32:47]
    ds_read_b128 v[88:91], v1 offset:34816
    s_waitcnt lgkmcnt(3)
    v_mfma_f32_32x32x16_bf16 v[48:63], v[96:99], v[184:187], v[48:63]
    ds_read_b128 v[92:95], v1 offset:35840
    s_add_u32 s52, s52, 4096
    buffer_load_dwordx4 v[208:211], v1, s[4:7], s52 offen offset:0 sc1
    s_waitcnt vmcnt(12)
    v_mfma_f32_32x32x16_bf16 v[16:31], v[100:103], v[188:191], v[16:31]
    ds_read_b128 v[96:99], v1 offset:36864
    v_mfma_f32_32x32x16_bf16 v[32:47], v[104:107], v[188:191], v[32:47]
    ds_read_b128 v[100:103], v1 offset:37888
    v_mfma_f32_32x32x16_bf16 v[48:63], v[108:111], v[188:191], v[48:63]
    ds_read_b128 v[104:107], v1 offset:38912
    buffer_load_dwordx4 v[212:215], v1, s[4:7], s52 offen offset:1024 sc1
    s_waitcnt lgkmcnt(3)
    s_waitcnt vmcnt(12)
    v_mfma_f32_32x32x16_bf16 v[16:31], v[80:83], v[192:195], v[16:31]
    ds_read_b128 v[108:111], v1 offset:39936
    v_mfma_f32_32x32x16_bf16 v[32:47], v[84:87], v[192:195], v[32:47]
    ds_read_b128 v[80:83], v1 offset:40960
    s_add_u32 m0, s49, 131072
    s_add_u32 s54, s60, 114688
    buffer_load_dwordx4 v1, s[4:7], s54 offen lds
    v_mfma_f32_32x32x16_bf16 v[48:63], v[88:91], v[192:195], v[48:63]
    ds_read_b128 v[84:87], v1 offset:41984
    buffer_load_dwordx4 v[216:219], v1, s[4:7], s52 offen offset:2048 sc1
    s_waitcnt vmcnt(13)
    v_mfma_f32_32x32x16_bf16 v[16:31], v[92:95], v[196:199], v[16:31]
    ds_read_b128 v[88:91], v1 offset:43008
    s_waitcnt lgkmcnt(3)
    v_mfma_f32_32x32x16_bf16 v[32:47], v[96:99], v[196:199], v[32:47]
    ds_read_b128 v[92:95], v1 offset:44032
    buffer_load_dwordx4 v[220:223], v1, s[4:7], s52 offen offset:3072 sc1
    v_mfma_f32_32x32x16_bf16 v[48:63], v[100:103], v[196:199], v[48:63]
    ds_read_b128 v[96:99], v1 offset:45056
    s_waitcnt vmcnt(13)
    v_mfma_f32_32x32x16_bf16 v[16:31], v[104:107], v[200:203], v[16:31]
    ds_read_b128 v[100:103], v1 offset:46080
    s_add_u32 s52, s52, 4096
    buffer_load_dwordx4 v[224:227], v1, s[4:7], s52 offen offset:0 sc1
    v_mfma_f32_32x32x16_bf16 v[32:47], v[108:111], v[200:203], v[32:47]
    ds_read_b128 v[104:107], v1 offset:47104
    s_waitcnt lgkmcnt(3)
    v_mfma_f32_32x32x16_bf16 v[48:63], v[80:83], v[200:203], v[48:63]
    ds_read_b128 v[108:111], v1 offset:48128
    buffer_load_dwordx4 v1, s[4:7], s54 offen offset:1024 lds
    s_barrier
    s_waitcnt vmcnt(13)
    v_mfma_f32_32x32x16_bf16 v[16:31], v[84:87], v[204:207], v[16:31]
    ds_read_b128 v[80:83], v2 offset:32768
    buffer_load_dwordx4 v[228:231], v1, s[4:7], s52 offen offset:1024 sc1
    v_mfma_f32_32x32x16_bf16 v[32:47], v[88:91], v[204:207], v[32:47]
    ds_read_b128 v[84:87], v2 offset:33792
    v_mfma_f32_32x32x16_bf16 v[48:63], v[92:95], v[204:207], v[48:63]
    ds_read_b128 v[88:91], v2 offset:34816
    s_waitcnt lgkmcnt(3)
    s_waitcnt vmcnt(7)
    v_mfma_f32_32x32x16_bf16 v[16:31], v[96:99], v[208:211], v[16:31]
    ds_read_b128 v[92:95], v2 offset:35840
    buffer_load_dwordx4 v[232:235], v1, s[4:7], s52 offen offset:2048 sc1
    buffer_load_dwordx4 v1, s[4:7], s54 offen offset:2048 lds
    v_mfma_f32_32x32x16_bf16 v[32:47], v[100:103], v[208:211], v[32:47]
    ds_read_b128 v[96:99], v2 offset:36864
    v_mfma_f32_32x32x16_bf16 v[48:63], v[104:107], v[208:211], v[48:63]
    ds_read_b128 v[100:103], v2 offset:37888
    buffer_load_dwordx4 v[236:239], v1, s[4:7], s52 offen offset:3072 sc1
    s_waitcnt vmcnt(9)
    v_mfma_f32_32x32x16_bf16 v[16:31], v[108:111], v[212:215], v[16:31]
    ds_read_b128 v[104:107], v2 offset:38912
    s_waitcnt lgkmcnt(3)
    v_mfma_f32_32x32x16_bf16 v[32:47], v[80:83], v[212:215], v[32:47]
    ds_read_b128 v[108:111], v2 offset:39936
    v_mfma_f32_32x32x16_bf16 v[48:63], v[84:87], v[212:215], v[48:63]
    ds_read_b128 v[80:83], v2 offset:40960
    s_add_u32 s52, s52, 4096
    buffer_load_dwordx4 v[240:243], v1, s[4:7], s52 offen offset:0 sc1
    s_waitcnt vmcnt(8)
    v_mfma_f32_32x32x16_bf16 v[16:31], v[88:91], v[216:219], v[16:31]
    ds_read_b128 v[84:87], v2 offset:41984
    buffer_load_dwordx4 v1, s[4:7], s54 offen offset:3072 lds
    v_mfma_f32_32x32x16_bf16 v[32:47], v[92:95], v[216:219], v[32:47]
    ds_read_b128 v[88:91], v2 offset:43008
    s_waitcnt lgkmcnt(3)
    v_mfma_f32_32x32x16_bf16 v[48:63], v[96:99], v[216:219], v[48:63]
    ds_read_b128 v[92:95], v2 offset:44032
    buffer_load_dwordx4 v[244:247], v1, s[4:7], s52 offen offset:1024 sc1
    s_waitcnt vmcnt(9)
    v_mfma_f32_32x32x16_bf16 v[16:31], v[100:103], v[220:223], v[16:31]
    ds_read_b128 v[96:99], v2 offset:45056
    v_mfma_f32_32x32x16_bf16 v[32:47], v[104:107], v[220:223], v[32:47]
    ds_read_b128 v[100:103], v2 offset:46080
    buffer_load_dwordx4 v[248:251], v1, s[4:7], s52 offen offset:2048 sc1
    v_mfma_f32_32x32x16_bf16 v[48:63], v[108:111], v[220:223], v[48:63]
    ds_read_b128 v[104:107], v2 offset:47104
    s_waitcnt lgkmcnt(3)
    s_waitcnt vmcnt(9)
    v_mfma_f32_32x32x16_bf16 v[16:31], v[80:83], v[224:227], v[16:31]
    ds_read_b128 v[108:111], v2 offset:48128
    s_add_u32 m0, s49, 65536
    s_add_u32 s54, s60, 131072
    buffer_load_dwordx4 v1, s[4:7], s54 offen lds
    v_mfma_f32_32x32x16_bf16 v[32:47], v[84:87], v[224:227], v[32:47]
    ds_read_b128 v[80:83], v2 offset:16384
    buffer_load_dwordx4 v[252:255], v1, s[4:7], s52 offen offset:3072 sc1
    v_mfma_f32_32x32x16_bf16 v[48:63], v[88:91], v[224:227], v[48:63]
    ds_read_b128 v[84:87], v2 offset:17408
    s_waitcnt vmcnt(9)
    v_mfma_f32_32x32x16_bf16 v[16:31], v[92:95], v[228:231], v[16:31]
    ds_read_b128 v[88:91], v2 offset:18432
    s_waitcnt lgkmcnt(3)
    v_mfma_f32_32x32x16_bf16 v[32:47], v[96:99], v[228:231], v[32:47]
    ds_read_b128 v[92:95], v2 offset:19456
    v_add_f32_e32 v112, v112, v120
    buffer_load_dwordx4 v1, s[4:7], s54 offen offset:1024 lds
    v_add_f32_e32 v113, v113, v121
    v_add_f32_e32 v114, v114, v122
    v_mfma_f32_32x32x16_bf16 v[48:63], v[100:103], v[228:231], v[48:63]
    ds_read_b128 v[96:99], v2 offset:20480
    v_add_f32_e32 v115, v115, v123
    v_add_f32_e32 v116, v116, v124
    v_add_f32_e32 v117, v117, v125
    v_add_f32_e32 v118, v118, v126
    s_waitcnt vmcnt(9)
    v_mfma_f32_32x32x16_bf16 v[16:31], v[104:107], v[232:235], v[16:31]
    ds_read_b128 v[100:103], v2 offset:21504
    v_add_f32_e32 v119, v119, v127
    v_add_f32_e32 v112, v112, v116
    v_add_f32_e32 v113, v113, v117
    v_add_f32_e32 v114, v114, v118
    v_add_f32_e32 v115, v115, v119
    v_mfma_f32_32x32x16_bf16 v[32:47], v[108:111], v[232:235], v[32:47]
    ds_read_b128 v[104:107], v2 offset:22528
    buffer_load_dwordx4 v1, s[4:7], s54 offen offset:2048 lds
    v_add_f32_e32 v112, v112, v114
    v_add_f32_e32 v113, v113, v115
    s_waitcnt lgkmcnt(3)
    v_mfma_f32_32x32x16_bf16 v[48:63], v[80:83], v[232:235], v[48:63]
    ds_read_b128 v[108:111], v2 offset:23552
    v_permlane32_swap_b32_e32 v112, v113
    v_add_f32_e32 v112, v112, v113
    v_mov_b32_e32 v113, v112
    s_waitcnt vmcnt(8)
    v_mfma_f32_32x32x16_bf16 v[16:31], v[84:87], v[236:239], v[16:31]
    ds_read_b128 v[80:83], v2 offset:24576
    v_permlane32_swap_b32_e32 v112, v113
    v_mul_f32_e32 v114, 0x3b000000, v112
    v_mul_f32_e32 v115, v114, v114
    v_mul_f32_e32 v113, 0x3b000000, v113
    v_mfma_f32_32x32x16_bf16 v[32:47], v[88:91], v[236:239], v[32:47]
    ds_read_b128 v[84:87], v2 offset:25600
    v_sub_f32_e32 v113, v113, v115
    v_max_f32_e32 v113, 0, v113
    v_add_f32_e32 v113, 0x3727c5ac, v113
    v_rsq_f32_e32 v8, v113
    v_mfma_f32_32x32x16_bf16 v[48:63], v[92:95], v[236:239], v[48:63]
    ds_read_b128 v[88:91], v2 offset:26624
    buffer_load_dwordx4 v1, s[4:7], s54 offen offset:3072 lds
    v_mul_f32_e32 v114, v11, v112
    s_waitcnt lgkmcnt(3)
    s_waitcnt vmcnt(8)
    v_mfma_f32_32x32x16_bf16 v[16:31], v[96:99], v[240:243], v[16:31]
    ds_read_b128 v[92:95], v2 offset:27648
    v_cvt_pk_bf16_f32 v13, v114, 0
    v_mul_f32_e32 v10, v113, v8
    v_mul_f32_e32 v9, 0xbfb8aa3b, v8
    v_lshlrev_b32_e32 v115, 16, v13
    v_sub_f32_e32 v115, v114, v115
    v_mfma_f32_32x32x16_bf16 v[32:47], v[100:103], v[240:243], v[32:47]
    ds_read_b128 v[96:99], v2 offset:28672
    v_cvt_pk_bf16_f32 v12, v114, v115
    v_mfma_f32_32x32x16_bf16 v[48:63], v[104:107], v[240:243], v[48:63]
    ds_read_b128 v[100:103], v2 offset:29696
    s_waitcnt vmcnt(6)
    v_mfma_f32_32x32x16_bf16 v[16:31], v[108:111], v[244:247], v[16:31]
    ds_read_b128 v[104:107], v2 offset:30720
    s_waitcnt lgkmcnt(3)
    v_mfma_f32_32x32x16_bf16 v[32:47], v[80:83], v[244:247], v[32:47]
    ds_read_b128 v[108:111], v2 offset:31744
    s_barrier
    v_mfma_f32_32x32x16_bf16 v[48:63], v[84:87], v[244:247], v[48:63]
    ds_read_b128 v[80:83], v2 offset:49152
    s_add_u32 m0, s49, 16384
    s_add_u32 s54, s60, 147456
    buffer_load_dwordx4 v1, s[4:7], s54 offen lds
    s_waitcnt vmcnt(6)
    v_mfma_f32_32x32x16_bf16 v[16:31], v[88:91], v[248:251], v[16:31]
    ds_read_b128 v[84:87], v2 offset:50176
    ds_read_b64 v[118:119], v5 offset:0
    v_mfma_f32_32x32x16_bf16 v[32:47], v[92:95], v[248:251], v[32:47]
    ds_read_b128 v[88:91], v2 offset:51200
    ds_read_b64 v[120:121], v5 offset:256
    s_waitcnt lgkmcnt(5)
    v_mfma_f32_32x32x16_bf16 v[48:63], v[96:99], v[248:251], v[48:63]
    ds_read_b128 v[92:95], v2 offset:52224
    s_waitcnt vmcnt(4)
    v_mfma_f32_32x32x16_bf16 v[16:31], v[100:103], v[252:255], v[16:31]
    ds_read_b128 v[96:99], v2 offset:53248
    ds_read_b64 v[122:123], v5 offset:512
    buffer_load_dwordx4 v1, s[4:7], s54 offen offset:1024 lds
    v_mfma_f32_32x32x16_bf16 v[32:47], v[104:107], v[252:255], v[32:47]
    ds_read_b128 v[100:103], v2 offset:54272
    ds_read_b64 v[124:125], v5 offset:768
    v_mfma_f32_32x32x16_bf16 v[48:63], v[108:111], v[252:255], v[48:63]
    ds_read_b128 v[104:107], v2 offset:55296
    s_waitcnt lgkmcnt(8)
    v_mfma_f32_32x32x8_bf16 v[16:31], v[118:119], v[12:13], v[16:31]
    buffer_load_dwordx4 v1, s[4:7], s54 offen offset:2048 lds
    s_waitcnt lgkmcnt(6)
    v_mfma_f32_32x32x8_bf16 v[32:47], v[120:121], v[12:13], v[32:47]
    s_waitcnt lgkmcnt(3)
    v_mfma_f32_32x32x8_bf16 v[48:63], v[122:123], v[12:13], v[48:63]
    s_waitcnt lgkmcnt(1)
    v_mfma_f32_32x32x8_bf16 v[64:79], v[124:125], v[12:13], 0
    v_mfma_f32_32x32x16_bf16 v[64:79], v[80:83], v[128:131], v[64:79]
    ds_read_b128 v[108:111], v2 offset:56320
    buffer_load_dwordx4 v1, s[4:7], s54 offen offset:3072 lds
    v_mfma_f32_32x32x16_bf16 v[64:79], v[84:87], v[132:135], v[64:79]
    ds_read_b128 v[80:83], v2 offset:57344
    v_mul_f32_e32 v16, v9, v16
    v_mul_f32_e32 v17, v9, v17
    v_mul_f32_e32 v18, v9, v18
    v_mul_f32_e32 v19, v9, v19
    v_mfma_f32_32x32x16_bf16 v[64:79], v[88:91], v[136:139], v[64:79]
    ds_read_b128 v[84:87], v2 offset:58368
    v_exp_f32_e32 v16, v16
    v_exp_f32_e32 v17, v17
    v_mfma_f32_32x32x16_bf16 v[64:79], v[92:95], v[140:143], v[64:79]
    ds_read_b128 v[88:91], v2 offset:59392
    v_exp_f32_e32 v18, v18
    v_exp_f32_e32 v19, v19
    s_waitcnt lgkmcnt(3)
    v_mfma_f32_32x32x16_bf16 v[64:79], v[96:99], v[144:147], v[64:79]
    ds_read_b128 v[92:95], v2 offset:60416
    v_fma_f32 v16, v16, v10, v10
    v_fma_f32 v17, v17, v10, v10
    v_fma_f32 v18, v18, v10, v10
    v_fma_f32 v19, v19, v10, v10
    v_mfma_f32_32x32x16_bf16 v[64:79], v[100:103], v[148:151], v[64:79]
    ds_read_b128 v[96:99], v2 offset:61440
    v_rcp_f32_e32 v16, v16
    v_rcp_f32_e32 v17, v17
    v_mfma_f32_32x32x16_bf16 v[64:79], v[104:107], v[152:155], v[64:79]
    ds_read_b128 v[100:103], v2 offset:62464
    s_add_u32 m0, s49, 0
    s_add_u32 s54, s60, 163840
    buffer_load_dwordx4 v1, s[4:7], s54 offen lds
    v_mfma_f32_32x32x16_bf16 v[64:79], v[108:111], v[156:159], v[64:79]
    ds_read_b128 v[104:107], v2 offset:63488
    v_rcp_f32_e32 v18, v18
    v_rcp_f32_e32 v19, v19
    s_waitcnt lgkmcnt(3)
    v_mfma_f32_32x32x16_bf16 v[64:79], v[80:83], v[160:163], v[64:79]
    ds_read_b128 v[108:111], v2 offset:64512
    v_mul_f32_e32 v16, v24, v16
    v_mul_f32_e32 v17, v25, v17
    v_mul_f32_e32 v18, v26, v18
    v_mul_f32_e32 v19, v27, v19
    v_cvt_pk_bf16_f32 v16, v16, v17
    v_mfma_f32_32x32x16_bf16 v[64:79], v[84:87], v[164:167], v[64:79]
    ds_read_b128 v[80:83], v3 offset:0
    v_cvt_pk_bf16_f32 v17, v18, v19
    v_mul_f32_e32 v20, v9, v20
    v_mul_f32_e32 v21, v9, v21
    v_mul_f32_e32 v22, v9, v22
    v_mul_f32_e32 v23, v9, v23
    v_mfma_f32_32x32x16_bf16 v[64:79], v[88:91], v[168:171], v[64:79]
    ds_read_b128 v[84:87], v3 offset:1024
    v_exp_f32_e32 v20, v20
    v_exp_f32_e32 v21, v21
    v_mfma_f32_32x32x16_bf16 v[64:79], v[92:95], v[172:175], v[64:79]
    ds_read_b128 v[88:91], v3 offset:2048
    buffer_load_dwordx4 v1, s[4:7], s54 offen offset:1024 lds
    v_exp_f32_e32 v22, v22
    s_waitcnt lgkmcnt(3)
    v_mfma_f32_32x32x16_bf16 v[64:79], v[96:99], v[176:179], v[64:79]
    ds_read_b128 v[92:95], v3 offset:3072
    v_exp_f32_e32 v23, v23
    v_fma_f32 v20, v20, v10, v10
    v_fma_f32 v21, v21, v10, v10
    v_fma_f32 v22, v22, v10, v10
    v_mfma_f32_32x32x16_bf16 v[64:79], v[100:103], v[180:183], v[64:79]
    ds_read_b128 v[96:99], v3 offset:4096
    v_fma_f32 v23, v23, v10, v10
    v_rcp_f32_e32 v20, v20
    v_rcp_f32_e32 v21, v21
    v_mfma_f32_32x32x16_bf16 v[64:79], v[104:107], v[184:187], v[64:79]
    ds_read_b128 v[100:103], v3 offset:5120
    v_rcp_f32_e32 v22, v22
    buffer_load_dwordx4 v1, s[4:7], s54 offen offset:2048 lds
    v_mfma_f32_32x32x16_bf16 v[64:79], v[108:111], v[188:191], v[64:79]
    ds_read_b128 v[104:107], v3 offset:6144
    v_rcp_f32_e32 v23, v23
    v_mul_f32_e32 v20, v28, v20
    v_mul_f32_e32 v21, v29, v21
    s_waitcnt lgkmcnt(3)
    v_mfma_f32_32x32x16_bf16 v[64:79], v[80:83], v[192:195], v[64:79]
    ds_read_b128 v[108:111], v3 offset:7168
    v_mul_f32_e32 v22, v30, v22
    v_mul_f32_e32 v23, v31, v23
    v_cvt_pk_bf16_f32 v18, v20, v21
    v_cvt_pk_bf16_f32 v19, v22, v23
    v_mfma_f32_32x32x16_bf16 v[64:79], v[84:87], v[196:199], v[64:79]
    ds_read_b128 v[80:83], v3 offset:8192
    s_add_u32 s50, s70, 0
    buffer_store_dwordx4 v[16:19], v1, s[4:7], s50 offen
    v_mul_f32_e32 v32, v9, v32
    v_mul_f32_e32 v33, v9, v33
    v_mfma_f32_32x32x16_bf16 v[64:79], v[88:91], v[200:203], v[64:79]
    ds_read_b128 v[84:87], v3 offset:9216
    v_mul_f32_e32 v34, v9, v34
    buffer_load_dwordx4 v1, s[4:7], s54 offen offset:3072 lds
    v_mul_f32_e32 v35, v9, v35
    v_mfma_f32_32x32x16_bf16 v[64:79], v[92:95], v[204:207], v[64:79]
    ds_read_b128 v[88:91], v3 offset:10240
    v_exp_f32_e32 v32, v32
    v_exp_f32_e32 v33, v33
    s_waitcnt lgkmcnt(3)
    v_mfma_f32_32x32x16_bf16 v[64:79], v[96:99], v[208:211], v[64:79]
    ds_read_b128 v[92:95], v3 offset:11264
    v_exp_f32_e32 v34, v34
    v_exp_f32_e32 v35, v35
    v_fma_f32 v32, v32, v10, v10
    v_mfma_f32_32x32x16_bf16 v[64:79], v[100:103], v[212:215], v[64:79]
    ds_read_b128 v[96:99], v3 offset:12288
    v_fma_f32 v33, v33, v10, v10
    v_fma_f32 v34, v34, v10, v10
    v_fma_f32 v35, v35, v10, v10
    v_rcp_f32_e32 v32, v32
    v_mfma_f32_32x32x16_bf16 v[64:79], v[104:107], v[216:219], v[64:79]
    ds_read_b128 v[100:103], v3 offset:13312
    v_rcp_f32_e32 v33, v33
    v_rcp_f32_e32 v34, v34
    ds_read_b64 v[118:119], v5 offset:1024
    v_mfma_f32_32x32x16_bf16 v[64:79], v[108:111], v[220:223], v[64:79]
    ds_read_b128 v[104:107], v3 offset:14336
    v_rcp_f32_e32 v35, v35
    v_mul_f32_e32 v32, v40, v32
    v_mul_f32_e32 v33, v41, v33
    s_waitcnt lgkmcnt(4)
    v_mfma_f32_32x32x16_bf16 v[64:79], v[80:83], v[224:227], v[64:79]
    ds_read_b128 v[108:111], v3 offset:15360
    s_add_u32 m0, s49, 49152
    s_add_u32 s54, s60, 180224
    buffer_load_dwordx4 v1, s[4:7], s54 offen lds
    s_waitcnt vmcnt(6)
    s_barrier
    v_mfma_f32_32x32x16_bf16 v[64:79], v[84:87], v[228:231], v[64:79]
    ds_read_b128 v[80:83], v2 offset:0
    v_mul_f32_e32 v34, v42, v34
    v_mul_f32_e32 v35, v43, v35
    v_cvt_pk_bf16_f32 v32, v32, v33
    v_cvt_pk_bf16_f32 v33, v34, v35
    v_mul_f32_e32 v36, v9, v36
    v_mfma_f32_32x32x16_bf16 v[64:79], v[88:91], v[232:235], v[64:79]
    ds_read_b128 v[84:87], v2 offset:1024
    v_mul_f32_e32 v37, v9, v37
    v_mul_f32_e32 v38, v9, v38
    v_mul_f32_e32 v39, v9, v39
    v_exp_f32_e32 v36, v36
    v_mfma_f32_32x32x16_bf16 v[64:79], v[92:95], v[236:239], v[64:79]
    ds_read_b128 v[88:91], v2 offset:2048
    v_exp_f32_e32 v37, v37
    v_exp_f32_e32 v38, v38
    s_waitcnt lgkmcnt(3)
    v_mfma_f32_32x32x16_bf16 v[64:79], v[96:99], v[240:243], v[64:79]
    ds_read_b128 v[92:95], v2 offset:3072
    v_exp_f32_e32 v39, v39
    v_fma_f32 v36, v36, v10, v10
    v_fma_f32 v37, v37, v10, v10
    v_fma_f32 v38, v38, v10, v10
    v_mfma_f32_32x32x16_bf16 v[64:79], v[100:103], v[244:247], v[64:79]
    ds_read_b128 v[96:99], v2 offset:4096
    buffer_load_dwordx4 v1, s[4:7], s54 offen offset:1024 lds
    v_fma_f32 v39, v39, v10, v10
    v_rcp_f32_e32 v36, v36
    v_mfma_f32_32x32x16_bf16 v[64:79], v[104:107], v[248:251], v[64:79]
    ds_read_b128 v[100:103], v2 offset:5120
    v_rcp_f32_e32 v37, v37
    v_rcp_f32_e32 v38, v38
    v_mfma_f32_32x32x16_bf16 v[64:79], v[108:111], v[252:255], v[64:79]
    ds_read_b128 v[104:107], v2 offset:6144
    v_rcp_f32_e32 v39, v39
    v_mul_f32_e32 v36, v44, v36
    v_mul_f32_e32 v37, v45, v37
    v_mul_f32_e32 v38, v46, v38
    v_mul_f32_e32 v39, v47, v39
    v_cvt_pk_bf16_f32 v34, v36, v37
    v_cvt_pk_bf16_f32 v35, v38, v39
    s_add_u32 s50, s70, 32768
    buffer_store_dwordx4 v[32:35], v1, s[4:7], s50 offen
    v_mfma_f32_32x32x8_bf16 v[16:31], v[118:119], v[12:13], 0
    buffer_load_dwordx4 v1, s[4:7], s54 offen offset:2048 lds
    s_waitcnt lgkmcnt(3)
    v_mfma_f32_32x32x16_bf16 v[16:31], v[80:83], v[128:131], v[16:31]
    ds_read_b128 v[108:111], v2 offset:7168
    v_mfma_f32_32x32x16_bf16 v[16:31], v[84:87], v[132:135], v[16:31]
    ds_read_b128 v[80:83], v2 offset:8192
    buffer_load_dwordx4 v1, s[4:7], s54 offen offset:3072 lds
    v_mfma_f32_32x32x16_bf16 v[16:31], v[88:91], v[136:139], v[16:31]
    ds_read_b128 v[84:87], v2 offset:9216
    v_mul_f32_e32 v48, v9, v48
    v_mul_f32_e32 v49, v9, v49
    v_mul_f32_e32 v50, v9, v50
    v_mul_f32_e32 v51, v9, v51
    v_mfma_f32_32x32x16_bf16 v[16:31], v[92:95], v[140:143], v[16:31]
    ds_read_b128 v[88:91], v2 offset:10240
    v_exp_f32_e32 v48, v48
    v_exp_f32_e32 v49, v49
    s_waitcnt lgkmcnt(3)
    v_mfma_f32_32x32x16_bf16 v[16:31], v[96:99], v[144:147], v[16:31]
    ds_read_b128 v[92:95], v2 offset:11264
    v_exp_f32_e32 v50, v50
    v_exp_f32_e32 v51, v51
    v_fma_f32 v48, v48, v10, v10
    v_mfma_f32_32x32x16_bf16 v[16:31], v[100:103], v[148:151], v[16:31]
    ds_read_b128 v[96:99], v2 offset:12288
    v_fma_f32 v49, v49, v10, v10
    v_fma_f32 v50, v50, v10, v10
    v_fma_f32 v51, v51, v10, v10
    v_rcp_f32_e32 v48, v48
    v_mfma_f32_32x32x16_bf16 v[16:31], v[104:107], v[152:155], v[16:31]
    ds_read_b128 v[100:103], v2 offset:13312
    s_add_u32 m0, s49, 32768
    s_add_u32 s54, s60, 196608
    buffer_load_dwordx4 v1, s[4:7], s54 offen lds
    v_mfma_f32_32x32x16_bf16 v[16:31], v[108:111], v[156:159], v[16:31]
    ds_read_b128 v[104:107], v2 offset:14336
    v_rcp_f32_e32 v49, v49
    v_rcp_f32_e32 v50, v50
    s_waitcnt lgkmcnt(3)
    v_mfma_f32_32x32x16_bf16 v[16:31], v[80:83], v[160:163], v[16:31]
    ds_read_b128 v[108:111], v2 offset:15360
    v_rcp_f32_e32 v51, v51
    v_mul_f32_e32 v48, v56, v48
    v_mul_f32_e32 v49, v57, v49
    v_mul_f32_e32 v50, v58, v50
    v_mfma_f32_32x32x16_bf16 v[16:31], v[84:87], v[164:167], v[16:31]
    ds_read_b128 v[80:83], v1 offset:16384
    v_mul_f32_e32 v51, v59, v51
    v_cvt_pk_bf16_f32 v48, v48, v49
    v_cvt_pk_bf16_f32 v49, v50, v51
    v_mul_f32_e32 v52, v9, v52
    v_mul_f32_e32 v53, v9, v53
    v_mfma_f32_32x32x16_bf16 v[16:31], v[88:91], v[168:171], v[16:31]
    ds_read_b128 v[84:87], v1 offset:17408
    v_mul_f32_e32 v54, v9, v54
    v_mul_f32_e32 v55, v9, v55
    v_exp_f32_e32 v52, v52
    v_mfma_f32_32x32x16_bf16 v[16:31], v[92:95], v[172:175], v[16:31]
    ds_read_b128 v[88:91], v1 offset:18432
    v_exp_f32_e32 v53, v53
    v_exp_f32_e32 v54, v54
    s_waitcnt lgkmcnt(3)
    v_mfma_f32_32x32x16_bf16 v[16:31], v[96:99], v[176:179], v[16:31]
    ds_read_b128 v[92:95], v1 offset:19456
    buffer_load_dwordx4 v1, s[4:7], s54 offen offset:1024 lds
    v_exp_f32_e32 v55, v55
    v_fma_f32 v52, v52, v10, v10
    v_mfma_f32_32x32x16_bf16 v[16:31], v[100:103], v[180:183], v[16:31]
    ds_read_b128 v[96:99], v1 offset:20480
    v_fma_f32 v53, v53, v10, v10
    v_fma_f32 v54, v54, v10, v10
    v_fma_f32 v55, v55, v10, v10
    v_rcp_f32_e32 v52, v52
    v_mfma_f32_32x32x16_bf16 v[16:31], v[104:107], v[184:187], v[16:31]
    ds_read_b128 v[100:103], v1 offset:21504
    v_mov_b32_e32 v14, s36
    s_cmp_lg_u32 s43, 0
    s_mov_b64 exec, 1
    s_waitcnt vmcnt(4)
    s_cbranch_scc1 L_slow_47
    buffer_store_dword v14, off, s[4:7], s75 offset:1152
L_back_48:
    s_mov_b64 exec, -1
    v_mfma_f32_32x32x16_bf16 v[16:31], v[108:111], v[188:191], v[16:31]
    ds_read_b128 v[104:107], v1 offset:22528
    v_rcp_f32_e32 v53, v53
    v_rcp_f32_e32 v54, v54
    s_waitcnt lgkmcnt(3)
    v_mfma_f32_32x32x16_bf16 v[16:31], v[80:83], v[192:195], v[16:31]
    ds_read_b128 v[108:111], v1 offset:23552
    v_rcp_f32_e32 v55, v55
    buffer_load_dwordx4 v1, s[4:7], s54 offen offset:2048 lds
    v_mul_f32_e32 v52, v60, v52
    v_mfma_f32_32x32x16_bf16 v[16:31], v[84:87], v[196:199], v[16:31]
    ds_read_b128 v[80:83], v1 offset:24576
    v_mul_f32_e32 v53, v61, v53
    v_mul_f32_e32 v54, v62, v54
    v_mul_f32_e32 v55, v63, v55
    v_cvt_pk_bf16_f32 v50, v52, v53
    v_cvt_pk_bf16_f32 v51, v54, v55
    v_mfma_f32_32x32x16_bf16 v[16:31], v[88:91], v[200:203], v[16:31]
    ds_read_b128 v[84:87], v1 offset:25600
    s_add_u32 s50, s70, 65536
    buffer_store_dwordx4 v[48:51], v1, s[4:7], s50 offen
    v_mul_f32_e32 v64, v9, v64
    v_mul_f32_e32 v65, v9, v65
    v_mfma_f32_32x32x16_bf16 v[16:31], v[92:95], v[204:207], v[16:31]
    ds_read_b128 v[88:91], v1 offset:26624
    v_mul_f32_e32 v66, v9, v66
    v_mul_f32_e32 v67, v9, v67
    v_exp_f32_e32 v64, v64
    s_waitcnt lgkmcnt(3)
    v_mfma_f32_32x32x16_bf16 v[16:31], v[96:99], v[208:211], v[16:31]
    ds_read_b128 v[92:95], v1 offset:27648
    buffer_load_dwordx4 v1, s[4:7], s54 offen offset:3072 lds
    v_exp_f32_e32 v65, v65
    v_mfma_f32_32x32x16_bf16 v[16:31], v[100:103], v[212:215], v[16:31]
    ds_read_b128 v[96:99], v1 offset:28672
    v_exp_f32_e32 v66, v66
    v_exp_f32_e32 v67, v67
    v_fma_f32 v64, v64, v10, v10
    v_mfma_f32_32x32x16_bf16 v[16:31], v[104:107], v[216:219], v[16:31]
    ds_read_b128 v[100:103], v1 offset:29696
    v_fma_f32 v65, v65, v10, v10
    v_fma_f32 v66, v66, v10, v10
    v_fma_f32 v67, v67, v10, v10
    v_rcp_f32_e32 v64, v64
    v_mfma_f32_32x32x16_bf16 v[16:31], v[108:111], v[220:223], v[16:31]
    ds_read_b128 v[104:107], v1 offset:30720
    ds_read_b64 v[120:121], v5 offset:1280
    buffer_load_dword v127, v15, s[4:7], s76 offen offset:1152 sc1
    s_waitcnt lgkmcnt(4)
    v_mfma_f32_32x32x16_bf16 v[16:31], v[80:83], v[224:227], v[16:31]
    ds_read_b128 v[108:111], v1 offset:31744
    v_rcp_f32_e32 v65, v65
    v_rcp_f32_e32 v66, v66
    v_rcp_f32_e32 v67, v67
    s_waitcnt vmcnt(7)
    s_barrier
    v_mfma_f32_32x32x16_bf16 v[16:31], v[84:87], v[228:231], v[16:31]
    ds_read_b128 v[80:83], v1 offset:0
    v_mul_f32_e32 v64, v72, v64
    v_mul_f32_e32 v65, v73, v65
    v_mul_f32_e32 v66, v74, v66
    s_add_u32 m0, s49, 98304
    s_add_u32 s54, s60, 212992
    buffer_load_dwordx4 v1, s[4:7], s54 offen lds
    v_mfma_f32_32x32x16_bf16 v[16:31], v[88:91], v[232:235], v[16:31]
    ds_read_b128 v[84:87], v1 offset:1024
    v_mul_f32_e32 v67, v75, v67
    v_cvt_pk_bf16_f32 v64, v64, v65
    v_cvt_pk_bf16_f32 v65, v66, v67
    v_mul_f32_e32 v68, v9, v68
    v_mul_f32_e32 v69, v9, v69
    v_mfma_f32_32x32x16_bf16 v[16:31], v[92:95], v[236:239], v[16:31]
    ds_read_b128 v[88:91], v1 offset:2048
    v_mul_f32_e32 v70, v9, v70
    v_mul_f32_e32 v71, v9, v71
    v_exp_f32_e32 v68, v68
    s_waitcnt lgkmcnt(3)
    v_mfma_f32_32x32x16_bf16 v[16:31], v[96:99], v[240:243], v[16:31]
    ds_read_b128 v[92:95], v1 offset:3072
    v_exp_f32_e32 v69, v69
    v_exp_f32_e32 v70, v70
    v_mfma_f32_32x32x16_bf16 v[16:31], v[100:103], v[244:247], v[16:31]
    ds_read_b128 v[96:99], v1 offset:4096
    v_exp_f32_e32 v71, v71
    v_fma_f32 v68, v68, v10, v10
    v_fma_f32 v69, v69, v10, v10
    v_fma_f32 v70, v70, v10, v10
    v_mfma_f32_32x32x16_bf16 v[16:31], v[104:107], v[248:251], v[16:31]
    ds_read_b128 v[100:103], v1 offset:5120
    v_fma_f32 v71, v71, v10, v10
    v_rcp_f32_e32 v68, v68
    buffer_load_dwordx4 v1, s[4:7], s54 offen offset:1024 lds
    v_mfma_f32_32x32x16_bf16 v[16:31], v[108:111], v[252:255], v[16:31]
    ds_read_b128 v[104:107], v1 offset:6144
    v_rcp_f32_e32 v69, v69
    v_rcp_f32_e32 v70, v70
    v_rcp_f32_e32 v71, v71
    v_mul_f32_e32 v68, v76, v68
    v_mul_f32_e32 v69, v77, v69
    v_mul_f32_e32 v70, v78, v70
    v_mul_f32_e32 v71, v79, v71
    v_cvt_pk_bf16_f32 v66, v68, v69
    v_cvt_pk_bf16_f32 v67, v70, v71
    s_add_u32 s50, s70, 98304
    buffer_store_dwordx4 v[64:67], v1, s[4:7], s50 offen
    v_mfma_f32_32x32x8_bf16 v[32:47], v[120:121], v[12:13], 0
    buffer_load_dwordx4 v1, s[4:7], s54 offen offset:2048 lds
    s_waitcnt lgkmcnt(3)
    v_mfma_f32_32x32x16_bf16 v[32:47], v[80:83], v[128:131], v[32:47]
    ds_read_b128 v[108:111], v1 offset:7168
    v_mfma_f32_32x32x16_bf16 v[32:47], v[84:87], v[132:135], v[32:47]
    ds_read_b128 v[80:83], v1 offset:8192
    v_mfma_f32_32x32x16_bf16 v[32:47], v[88:91], v[136:139], v[32:47]
    ds_read_b128 v[84:87], v1 offset:9216
    v_mul_f32_e32 v16, v9, v16
    buffer_load_dwordx4 v1, s[4:7], s54 offen offset:3072 lds
    v_mul_f32_e32 v17, v9, v17
    v_mul_f32_e32 v18, v9, v18
    v_mfma_f32_32x32x16_bf16 v[32:47], v[92:95], v[140:143], v[32:47]
    ds_read_b128 v[88:91], v1 offset:10240
    v_mul_f32_e32 v19, v9, v19
    v_exp_f32_e32 v16, v16
    s_waitcnt lgkmcnt(3)
    v_mfma_f32_32x32x16_bf16 v[32:47], v[96:99], v[144:147], v[32:47]
    ds_read_b128 v[92:95], v1 offset:11264
    v_exp_f32_e32 v17, v17
    v_exp_f32_e32 v18, v18
    v_mfma_f32_32x32x16_bf16 v[32:47], v[100:103], v[148:151], v[32:47]
    ds_read_b128 v[96:99], v1 offset:12288
    v_exp_f32_e32 v19, v19
    v_fma_f32 v16, v16, v10, v10
    v_fma_f32 v17, v17, v10, v10
    v_fma_f32 v18, v18, v10, v10
    v_mfma_f32_32x32x16_bf16 v[32:47], v[104:107], v[152:155], v[32:47]
    ds_read_b128 v[100:103], v1 offset:13312
    v_fma_f32 v19, v19, v10, v10
    v_rcp_f32_e32 v16, v16
    v_rcp_f32_e32 v17, v17
    v_mfma_f32_32x32x16_bf16 v[32:47], v[108:111], v[156:159], v[32:47]
    ds_read_b128 v[104:107], v1 offset:14336
    s_waitcnt vmcnt(5)
    v_cmp_ne_u32_e32 vcc, s36, v127
    s_cbranch_vccnz L_spin_49
L_back_50:
    v_rcp_f32_e32 v18, v18
    s_waitcnt lgkmcnt(3)
    v_mfma_f32_32x32x16_bf16 v[32:47], v[80:83], v[160:163], v[32:47]
    ds_read_b128 v[108:111], v1 offset:15360
    v_rcp_f32_e32 v19, v19
    v_mul_f32_e32 v16, v24, v16
    v_mul_f32_e32 v17, v25, v17
    v_mul_f32_e32 v18, v26, v18
    v_mfma_f32_32x32x16_bf16 v[32:47], v[84:87], v[164:167], v[32:47]
    ds_read_b128 v[80:83], v1 offset:49152
    s_add_u32 m0, s49, 81920
    s_add_u32 s54, s61, 0
    buffer_load_dwordx4 v1, s[4:7], s54 offen sc1 lds
    v_mul_f32_e32 v19, v27, v19
    v_mfma_f32_32x32x16_bf16 v[32:47], v[88:91], v[168:171], v[32:47]
    ds_read_b128 v[84:87], v1 offset:50176
    v_cvt_pk_bf16_f32 v16, v16, v17
    v_cvt_pk_bf16_f32 v17, v18, v19
    v_mul_f32_e32 v20, v9, v20
    v_mul_f32_e32 v21, v9, v21
    v_mul_f32_e32 v22, v9, v22
    v_mfma_f32_32x32x16_bf16 v[32:47], v[92:95], v[172:175], v[32:47]
    ds_read_b128 v[88:91], v1 offset:51200
    v_mul_f32_e32 v23, v9, v23
    v_exp_f32_e32 v20, v20
    s_waitcnt lgkmcnt(3)
    v_mfma_f32_32x32x16_bf16 v[32:47], v[96:99], v[176:179], v[32:47]
    ds_read_b128 v[92:95], v1 offset:52224
    buffer_load_dwordx4 v1, s[4:7], s54 offen offset:1024 sc1 lds
    v_exp_f32_e32 v21, v21
    v_mfma_f32_32x32x16_bf16 v[32:47], v[100:103], v[180:183], v[32:47]
    ds_read_b128 v[96:99], v1 offset:53248
    v_mov_b32_e32 v14, s36
    s_cmp_lg_u32 s43, 0
    s_mov_b64 exec, 1
    s_waitcnt vmcnt(4)
    s_cbranch_scc1 L_slow_51
    buffer_store_dword v14, off, s[4:7], s75 offset:1280
L_back_52:
    s_mov_b64 exec, -1
    v_mfma_f32_32x32x16_bf16 v[32:47], v[104:107], v[184:187], v[32:47]
    ds_read_b128 v[100:103], v1 offset:54272
    buffer_load_dwordx4 v1, s[4:7], s54 offen offset:2048 sc1 lds
    v_exp_f32_e32 v22, v22
    v_mfma_f32_32x32x16_bf16 v[32:47], v[108:111], v[188:191], v[32:47]
    ds_read_b128 v[104:107], v1 offset:55296
    v_exp_f32_e32 v23, v23
    v_fma_f32 v20, v20, v10, v10
    v_fma_f32 v21, v21, v10, v10
    s_waitcnt lgkmcnt(3)
    v_mfma_f32_32x32x16_bf16 v[32:47], v[80:83], v[192:195], v[32:47]
    ds_read_b128 v[108:111], v1 offset:56320
    buffer_load_dwordx4 v1, s[4:7], s54 offen offset:3072 sc1 lds
    v_fma_f32 v22, v22, v10, v10
    v_fma_f32 v23, v23, v10, v10
    v_mfma_f32_32x32x16_bf16 v[32:47], v[84:87], v[196:199], v[32:47]
    ds_read_b128 v[80:83], v1 offset:57344
    v_rcp_f32_e32 v20, v20
    v_rcp_f32_e32 v21, v21
    v_mfma_f32_32x32x16_bf16 v[32:47], v[88:91], v[200:203], v[32:47]
    ds_read_b128 v[84:87], v1 offset:58368
    v_rcp_f32_e32 v22, v22
    v_rcp_f32_e32 v23, v23
    v_mul_f32_e32 v20, v28, v20
    v_mfma_f32_32x32x16_bf16 v[32:47], v[92:95], v[204:207], v[32:47]
    ds_read_b128 v[88:91], v1 offset:59392
    s_add_u32 m0, s49, 114688
    s_add_u32 s54, s61, 16384
    buffer_load_dwordx4 v1, s[4:7], s54 offen sc1 lds
    s_waitcnt lgkmcnt(3)
    v_mfma_f32_32x32x16_bf16 v[32:47], v[96:99], v[208:211], v[32:47]
    ds_read_b128 v[92:95], v1 offset:60416
    v_mul_f32_e32 v21, v29, v21
    v_mul_f32_e32 v22, v30, v22
    v_mul_f32_e32 v23, v31, v23
    v_cvt_pk_bf16_f32 v18, v20, v21
    v_cvt_pk_bf16_f32 v19, v22, v23
    v_mfma_f32_32x32x16_bf16 v[32:47], v[100:103], v[212:215], v[32:47]
    ds_read_b128 v[96:99], v1 offset:61440
    ds_read_b64 v[122:123], v5 offset:1536
    s_add_u32 s50, s70, 131072
    buffer_store_dwordx4 v[16:19], v1, s[4:7], s50 offen
    v_mfma_f32_32x32x16_bf16 v[32:47], v[104:107], v[216:219], v[32:47]
    ds_read_b128 v[100:103], v1 offset:62464
    buffer_load_dwordx4 v1, s[4:7], s54 offen offset:1024 sc1 lds
    v_mfma_f32_32x32x16_bf16 v[32:47], v[108:111], v[220:223], v[32:47]
    ds_read_b128 v[104:107], v1 offset:63488
    buffer_load_dword v127, v15, s[4:7], s76 offen offset:1280 sc1
    s_waitcnt lgkmcnt(4)
    v_mfma_f32_32x32x16_bf16 v[32:47], v[80:83], v[224:227], v[32:47]
    ds_read_b128 v[108:111], v1 offset:64512
    buffer_load_dwordx4 v1, s[4:7], s54 offen offset:2048 sc1 lds
    s_waitcnt vmcnt(10)
    s_barrier
    v_mfma_f32_32x32x16_bf16 v[32:47], v[84:87], v[228:231], v[32:47]
    ds_read_b128 v[80:83], v1 offset:32768
    v_mfma_f32_32x32x16_bf16 v[32:47], v[88:91], v[232:235], v[32:47]
    ds_read_b128 v[84:87], v1 offset:33792
    buffer_load_dwordx4 v1, s[4:7], s54 offen offset:3072 sc1 lds
    v_mfma_f32_32x32x16_bf16 v[32:47], v[92:95], v[236:239], v[32:47]
    ds_read_b128 v[88:91], v1 offset:34816
    s_waitcnt lgkmcnt(3)
    v_mfma_f32_32x32x16_bf16 v[32:47], v[96:99], v[240:243], v[32:47]
    ds_read_b128 v[92:95], v1 offset:35840
    v_mfma_f32_32x32x16_bf16 v[32:47], v[100:103], v[244:247], v[32:47]
    ds_read_b128 v[96:99], v1 offset:36864
    s_add_u32 m0, s49, 131072
    s_add_u32 s54, s61, 32768
    buffer_load_dwordx4 v1, s[4:7], s54 offen sc1 lds
    v_mfma_f32_32x32x16_bf16 v[32:47], v[104:107], v[248:251], v[32:47]
    ds_read_b128 v[100:103], v1 offset:37888
    v_mfma_f32_32x32x16_bf16 v[32:47], v[108:111], v[252:255], v[32:47]
    ds_read_b128 v[104:107], v1 offset:38912
    v_mfma_f32_32x32x8_bf16 v[48:63], v[122:123], v[12:13], 0
    buffer_load_dwordx4 v1, s[4:7], s54 offen offset:1024 sc1 lds
    s_waitcnt lgkmcnt(3)
    v_mfma_f32_32x32x16_bf16 v[48:63], v[80:83], v[128:131], v[48:63]
    ds_read_b128 v[108:111], v1 offset:39936
    v_mfma_f32_32x32x16_bf16 v[48:63], v[84:87], v[132:135], v[48:63]
    ds_read_b128 v[80:83], v1 offset:40960
    buffer_load_dwordx4 v1, s[4:7], s54 offen offset:2048 sc1 lds
    v_mfma_f32_32x32x16_bf16 v[48:63], v[88:91], v[136:139], v[48:63]
    ds_read_b128 v[84:87], v1 offset:41984
    s_nop 0
    v_mul_f32_e32 v32, v9, v32
    v_mul_f32_e32 v33, v9, v33
    v_mul_f32_e32 v34, v9, v34
    v_mul_f32_e32 v35, v9, v35
    v_mfma_f32_32x32x16_bf16 v[48:63], v[92:95], v[140:143], v[48:63]
    ds_read_b128 v[88:91], v1 offset:43008
    v_exp_f32_e32 v32, v32
    buffer_load_dwordx4 v1, s[4:7], s54 offen offset:3072 sc1 lds
    s_waitcnt lgkmcnt(3)
    v_mfma_f32_32x32x16_bf16 v[48:63], v[96:99], v[144:147], v[48:63]
    ds_read_b128 v[92:95], v1 offset:44032
    v_exp_f32_e32 v33, v33
    v_exp_f32_e32 v34, v34
    v_mfma_f32_32x32x16_bf16 v[48:63], v[100:103], v[148:151], v[48:63]
    ds_read_b128 v[96:99], v1 offset:45056
    v_exp_f32_e32 v35, v35
    v_fma_f32 v32, v32, v10, v10
    v_fma_f32 v33, v33, v10, v10
    v_fma_f32 v34, v34, v10, v10
    v_mfma_f32_32x32x16_bf16 v[48:63], v[104:107], v[152:155], v[48:63]
    ds_read_b128 v[100:103], v1 offset:46080
    s_add_u32 m0, s49, 65536
    s_add_u32 s54, s61, 49152
    buffer_load_dwordx4 v1, s[4:7], s54 offen sc1 lds
    v_fma_f32 v35, v35, v10, v10
    v_mfma_f32_32x32x16_bf16 v[48:63], v[108:111], v[156:159], v[48:63]
    ds_read_b128 v[104:107], v1 offset:47104
    s_waitcnt vmcnt(7)
    v_cmp_ne_u32_e32 vcc, s36, v127
    s_cbranch_vccnz L_spin_53
L_back_54:
    v_rcp_f32_e32 v32, v32
    s_waitcnt lgkmcnt(3)
    v_mfma_f32_32x32x16_bf16 v[48:63], v[80:83], v[160:163], v[48:63]
    ds_read_b128 v[108:111], v1 offset:48128
    v_rcp_f32_e32 v33, v33
    v_rcp_f32_e32 v34, v34
    v_mfma_f32_32x32x16_bf16 v[48:63], v[84:87], v[164:167], v[48:63]
    ds_read_b128 v[80:83], v2 offset:32768
    buffer_load_dwordx4 v1, s[4:7], s54 offen offset:1024 sc1 lds
    v_rcp_f32_e32 v35, v35
    v_mul_f32_e32 v32, v40, v32
    v_mfma_f32_32x32x16_bf16 v[48:63], v[88:91], v[168:171], v[48:63]
    ds_read_b128 v[84:87], v2 offset:33792
    v_mul_f32_e32 v33, v41, v33
    v_mul_f32_e32 v34, v42, v34
    v_mul_f32_e32 v35, v43, v35
    v_cvt_pk_bf16_f32 v32, v32, v33
    v_cvt_pk_bf16_f32 v33, v34, v35
    v_mfma_f32_32x32x16_bf16 v[48:63], v[92:95], v[172:175], v[48:63]
    ds_read_b128 v[88:91], v2 offset:34816
    buffer_load_dwordx4 v1, s[4:7], s54 offen offset:2048 sc1 lds
    v_mul_f32_e32 v36, v9, v36
    v_mul_f32_e32 v37, v9, v37
    s_waitcnt lgkmcnt(3)
    v_mfma_f32_32x32x16_bf16 v[48:63], v[96:99], v[176:179], v[48:63]
    ds_read_b128 v[92:95], v2 offset:35840
    v_mul_f32_e32 v38, v9, v38
    v_mul_f32_e32 v39, v9, v39
    v_exp_f32_e32 v36, v36
    v_mfma_f32_32x32x16_bf16 v[48:63], v[100:103], v[180:183], v[48:63]
    ds_read_b128 v[96:99], v2 offset:36864
    buffer_load_dwordx4 v1, s[4:7], s54 offen offset:3072 sc1 lds
    v_exp_f32_e32 v37, v37
    v_mfma_f32_32x32x16_bf16 v[48:63], v[104:107], v[184:187], v[48:63]
    ds_read_b128 v[100:103], v2 offset:37888
    v_exp_f32_e32 v38, v38
    v_exp_f32_e32 v39, v39
    v_fma_f32 v36, v36, v10, v10
    v_mfma_f32_32x32x16_bf16 v[48:63], v[108:111], v[188:191], v[48:63]
    ds_read_b128 v[104:107], v2 offset:38912
    v_fma_f32 v37, v37, v10, v10
    v_fma_f32 v38, v38, v10, v10
    v_fma_f32 v39, v39, v10, v10
    s_waitcnt lgkmcnt(3)
    v_mfma_f32_32x32x16_bf16 v[48:63], v[80:83], v[192:195], v[48:63]
    ds_read_b128 v[108:111], v2 offset:39936
    s_add_u32 m0, s49, 16384
    s_add_u32 s54, s61, 65536
    buffer_load_dwordx4 v1, s[4:7], s54 offen sc1 lds
    v_mfma_f32_32x32x16_bf16 v[48:63], v[84:87], v[196:199], v[48:63]
    ds_read_b128 v[80:83], v2 offset:40960
    v_rcp_f32_e32 v36, v36
    v_rcp_f32_e32 v37, v37
    v_mfma_f32_32x32x16_bf16 v[48:63], v[88:91], v[200:203], v[48:63]
    ds_read_b128 v[84:87], v2 offset:41984
    v_rcp_f32_e32 v38, v38
    v_rcp_f32_e32 v39, v39
    v_mul_f32_e32 v36, v44, v36
    v_mfma_f32_32x32x16_bf16 v[48:63], v[92:95], v[204:207], v[48:63]
    ds_read_b128 v[88:91], v2 offset:43008
    buffer_load_dwordx4 v1, s[4:7], s54 offen offset:1024 sc1 lds
    v_mul_f32_e32 v37, v45, v37
    v_mul_f32_e32 v38, v46, v38
    s_waitcnt lgkmcnt(3)
    v_mfma_f32_32x32x16_bf16 v[48:63], v[96:99], v[208:211], v[48:63]
    ds_read_b128 v[92:95], v2 offset:44032
    buffer_load_dwordx4 v1, s[4:7], s54 offen offset:2048 sc1 lds
    v_mul_f32_e32 v39, v47, v39
    v_cvt_pk_bf16_f32 v34, v36, v37
    v_cvt_pk_bf16_f32 v35, v38, v39
    v_mfma_f32_32x32x16_bf16 v[48:63], v[100:103], v[212:215], v[48:63]
    ds_read_b128 v[96:99], v2 offset:45056
    s_add_u32 s50, s70, 163840
    buffer_store_dwordx4 v[32:35], v1, s[4:7], s50 offen
    v_mfma_f32_32x32x16_bf16 v[48:63], v[104:107], v[216:219], v[48:63]
    ds_read_b128 v[100:103], v2 offset:46080
    buffer_load_dwordx4 v1, s[4:7], s54 offen offset:3072 sc1 lds
    v_mfma_f32_32x32x16_bf16 v[48:63], v[108:111], v[220:223], v[48:63]
    ds_read_b128 v[104:107], v2 offset:47104
    s_waitcnt lgkmcnt(3)
    v_mfma_f32_32x32x16_bf16 v[48:63], v[80:83], v[224:227], v[48:63]
    ds_read_b128 v[108:111], v2 offset:48128
    v_mfma_f32_32x32x16_bf16 v[48:63], v[84:87], v[228:231], v[48:63]
    s_add_u32 m0, s49, 0
    s_add_u32 s54, s61, 81920
    buffer_load_dwordx4 v1, s[4:7], s54 offen sc1 lds
    v_mfma_f32_32x32x16_bf16 v[48:63], v[88:91], v[232:235], v[48:63]
    v_mfma_f32_32x32x16_bf16 v[48:63], v[92:95], v[236:239], v[48:63]
    buffer_load_dwordx4 v1, s[4:7], s54 offen offset:1024 sc1 lds
    s_waitcnt lgkmcnt(0)
    v_mfma_f32_32x32x16_bf16 v[48:63], v[96:99], v[240:243], v[48:63]
    v_mfma_f32_32x32x16_bf16 v[48:63], v[100:103], v[244:247], v[48:63]
    buffer_load_dwordx4 v1, s[4:7], s54 offen offset:2048 sc1 lds
    v_mfma_f32_32x32x16_bf16 v[48:63], v[104:107], v[248:251], v[48:63]
    v_mfma_f32_32x32x16_bf16 v[48:63], v[108:111], v[252:255], v[48:63]
    buffer_load_dwordx4 v1, s[4:7], s54 offen offset:3072 sc1 lds
    s_nop 10
    v_mul_f32_e32 v48, v9, v48
    v_mul_f32_e32 v49, v9, v49
    v_mul_f32_e32 v50, v9, v50
    v_mul_f32_e32 v51, v9, v51
    v_exp_f32_e32 v48, v48
    v_exp_f32_e32 v49, v49
    v_exp_f32_e32 v50, v50
    v_exp_f32_e32 v51, v51
    v_fma_f32 v48, v48, v10, v10
    v_fma_f32 v49, v49, v10, v10
    v_fma_f32 v50, v50, v10, v10
    v_fma_f32 v51, v51, v10, v10
    v_rcp_f32_e32 v48, v48
    v_rcp_f32_e32 v49, v49
    v_rcp_f32_e32 v50, v50
    v_rcp_f32_e32 v51, v51
    v_mul_f32_e32 v48, v56, v48
    v_mul_f32_e32 v49, v57, v49
    v_mul_f32_e32 v50, v58, v50
    v_mul_f32_e32 v51, v59, v51
    v_cvt_pk_bf16_f32 v48, v48, v49
    v_cvt_pk_bf16_f32 v49, v50, v51
    v_mul_f32_e32 v52, v9, v52
    v_mul_f32_e32 v53, v9, v53
    v_mul_f32_e32 v54, v9, v54
    v_mul_f32_e32 v55, v9, v55
    v_exp_f32_e32 v52, v52
    v_exp_f32_e32 v53, v53
    v_exp_f32_e32 v54, v54
    v_exp_f32_e32 v55, v55
    v_fma_f32 v52, v52, v10, v10
    v_fma_f32 v53, v53, v10, v10
    v_fma_f32 v54, v54, v10, v10
    v_fma_f32 v55, v55, v10, v10
    v_rcp_f32_e32 v52, v52
    v_rcp_f32_e32 v53, v53
    v_rcp_f32_e32 v54, v54
    v_rcp_f32_e32 v55, v55
    v_mul_f32_e32 v52, v60, v52
    v_mul_f32_e32 v53, v61, v53
    v_mul_f32_e32 v54, v62, v54
    v_mul_f32_e32 v55, v63, v55
    v_cvt_pk_bf16_f32 v50, v52, v53
    v_cvt_pk_bf16_f32 v51, v54, v55
    s_add_u32 s50, s70, 196608
    buffer_store_dwordx4 v[48:51], v1, s[4:7], s50 offen
    s_mul_i32 s50, s47, 3072
    s_lshl_b32 s51, s47, 10
    s_add_u32 s51, s51, 1024
    v_add_u32_e32 v192, s50, v1
    v_add_u32_e32 v195, s51, v1
    v_add_u32_e32 v193, s50, v2
    v_add_u32_e32 v196, s51, v2
    v_add_u32_e32 v194, s50, v3
    v_add_u32_e32 v197, s51, v3
    s_waitcnt vmcnt(18)
    s_barrier
    ds_read_b128 v[128:131], v196 offset:16384
    ds_read_b128 v[132:135], v193 offset:16384
    ds_read_b128 v[136:139], v196 offset:20480
    ds_read_b128 v[140:143], v193 offset:20480
    ds_read_b128 v[144:147], v196 offset:24576
    ds_read_b128 v[148:151], v193 offset:24576
    v_mov_b32_e32 v14, s36
    s_cmp_lg_u32 s43, 0
    s_mov_b64 exec, 1
    s_waitcnt vmcnt(6)
    s_cbranch_scc1 L_slow_55
    buffer_store_dword v14, off, s[4:7], s75 offset:1408
L_back_56:
    s_mov_b64 exec, -1
    s_xor_b32 s50, s49, 8192
    s_add_u32 s50, s50, 0
    v_add_u32_e32 v112, s50, v1
    s_add_u32 s50, s49, 0
    v_add_u32_e32 v113, s50, v1
    v_and_b32_e32 v114, 31, v0
    v_lshrrev_b32_e32 v115, 5, v0
    v_lshlrev_b32_e32 v114, 10, v114
    v_lshl_add_u32 v114, v115, 4, v114
    s_lshl_b32 s50, s42, 15
    s_lshl_b32 s51, s40, 7
    s_add_u32 s56, s50, s51
    s_lshl_b32 s51, s46, 6
    s_add_u32 s56, s56, s51
    v_accvgpr_read_b32 v16, a224
    v_accvgpr_read_b32 v17, a225
    v_accvgpr_read_b32 v18, a226
    v_accvgpr_read_b32 v19, a227
    v_accvgpr_read_b32 v20, a228
    v_accvgpr_read_b32 v21, a229
    v_accvgpr_read_b32 v22, a230
    v_accvgpr_read_b32 v23, a231
    v_accvgpr_read_b32 v24, a232
    v_accvgpr_read_b32 v25, a233
    v_accvgpr_read_b32 v26, a234
    v_accvgpr_read_b32 v27, a235
    v_accvgpr_read_b32 v28, a236
    v_accvgpr_read_b32 v29, a237
    v_accvgpr_read_b32 v30, a238
    v_accvgpr_read_b32 v31, a239
    s_waitcnt lgkmcnt(4)
    v_mfma_f32_32x32x16_bf16 v[32:47], a[0:3], v[128:131], 0
    ds_read_b128 v[152:155], v196 offset:28672
    v_mfma_f32_32x32x16_bf16 v[16:31], a[0:3], v[132:135], v[16:31]
    ds_read_b128 v[156:159], v193 offset:28672
    s_add_u32 m0, s49, 49152
    s_add_u32 s54, s61, 98304
    buffer_load_dwordx4 v1, s[4:7], s54 offen sc1 lds
    s_waitcnt lgkmcnt(4)
    v_mfma_f32_32x32x16_bf16 v[32:47], a[4:7], v[136:139], v[32:47]
    ds_read_b128 v[160:163], v196 offset:49152
    v_mfma_f32_32x32x16_bf16 v[16:31], a[4:7], v[140:143], v[16:31]
    ds_read_b128 v[164:167], v193 offset:49152
    s_waitcnt lgkmcnt(4)
    v_mfma_f32_32x32x16_bf16 v[32:47], a[8:11], v[144:147], v[32:47]
    ds_read_b128 v[168:171], v196 offset:53248
    buffer_load_dword v127, v15, s[4:7], s76 offen offset:1408 sc1
    buffer_load_dwordx4 v1, s[4:7], s54 offen offset:1024 sc1 lds
    v_mfma_f32_32x32x16_bf16 v[16:31], a[8:11], v[148:151], v[16:31]
    ds_read_b128 v[172:175], v193 offset:53248
    s_waitcnt lgkmcnt(4)
    v_mfma_f32_32x32x16_bf16 v[32:47], a[12:15], v[152:155], v[32:47]
    ds_read_b128 v[176:179], v196 offset:57344
    buffer_load_dwordx4 v1, s[4:7], s54 offen offset:2048 sc1 lds
    v_mfma_f32_32x32x16_bf16 v[16:31], a[12:15], v[156:159], v[16:31]
    ds_read_b128 v[180:183], v193 offset:57344
    s_waitcnt lgkmcnt(4)
    v_mfma_f32_32x32x16_bf16 v[32:47], a[16:19], v[160:163], v[32:47]
    ds_read_b128 v[184:187], v196 offset:61440
    buffer_load_dwordx4 v1, s[4:7], s54 offen offset:3072 sc1 lds
    v_mfma_f32_32x32x16_bf16 v[16:31], a[16:19], v[164:167], v[16:31]
    ds_read_b128 v[188:191], v193 offset:61440
    s_barrier
    s_waitcnt lgkmcnt(4)
    v_mfma_f32_32x32x16_bf16 v[32:47], a[20:23], v[168:171], v[32:47]
    ds_read_b128 v[128:131], v197 offset:0
    v_mov_b32_e32 v14, s36
    s_cmp_lg_u32 s43, 0
    s_mov_b64 exec, 1
    s_waitcnt vmcnt(6)
    s_cbranch_scc1 L_slow_59
    buffer_store_dword v14, off, s[4:7], s75 offset:1536
L_back_60:
    s_mov_b64 exec, -1
    v_mfma_f32_32x32x16_bf16 v[16:31], a[20:23], v[172:175], v[16:31]
    ds_read_b128 v[132:135], v194 offset:0
    s_add_u32 m0, s49, 32768
    s_add_u32 s54, s61, 114688
    buffer_load_dwordx4 v1, s[4:7], s54 offen sc1 lds
    s_waitcnt lgkmcnt(4)
    v_mfma_f32_32x32x16_bf16 v[32:47], a[24:27], v[176:179], v[32:47]
    ds_read_b128 v[136:139], v197 offset:4096
    v_mfma_f32_32x32x16_bf16 v[16:31], a[24:27], v[180:183], v[16:31]
    ds_read_b128 v[140:143], v194 offset:4096
    s_waitcnt lgkmcnt(4)
    v_mfma_f32_32x32x16_bf16 v[32:47], a[28:31], v[184:187], v[32:47]
    ds_read_b128 v[144:147], v197 offset:8192
    buffer_load_dwordx4 v1, s[4:7], s54 offen offset:1024 sc1 lds
    v_mfma_f32_32x32x16_bf16 v[16:31], a[28:31], v[188:191], v[16:31]
    ds_read_b128 v[148:151], v194 offset:8192
    s_waitcnt lgkmcnt(4)
    v_mfma_f32_32x32x16_bf16 v[32:47], a[32:35], v[128:131], v[32:47]
    ds_read_b128 v[152:155], v197 offset:12288
    buffer_load_dwordx4 v1, s[4:7], s54 offen offset:2048 sc1 lds
    v_mfma_f32_32x32x16_bf16 v[16:31], a[32:35], v[132:135], v[16:31]
    ds_read_b128 v[156:159], v194 offset:12288
    s_waitcnt lgkmcnt(4)
    v_mfma_f32_32x32x16_bf16 v[32:47], a[36:39], v[136:139], v[32:47]
    ds_read_b128 v[160:163], v196 offset:0
    buffer_load_dwordx4 v1, s[4:7], s54 offen offset:3072 sc1 lds
    v_mfma_f32_32x32x16_bf16 v[16:31], a[36:39], v[140:143], v[16:31]
    ds_read_b128 v[164:167], v193 offset:0
    s_waitcnt vmcnt(8)
    v_cmp_ne_u32_e32 vcc, s36, v127
    s_cbranch_vccnz L_spin_57
L_back_58:
    s_waitcnt lgkmcnt(4)
    v_mfma_f32_32x32x16_bf16 v[32:47], a[40:43], v[144:147], v[32:47]
    ds_read_b128 v[168:171], v196 offset:4096
    v_mfma_f32_32x32x16_bf16 v[16:31], a[40:43], v[148:151], v[16:31]
    ds_read_b128 v[172:175], v193 offset:4096
    s_add_u32 m0, s49, 98304
    s_add_u32 s54, s61, 131072
    buffer_load_dwordx4 v1, s[4:7], s54 offen sc1 lds
    s_waitcnt lgkmcnt(4)
    v_mfma_f32_32x32x16_bf16 v[32:47], a[44:47], v[152:155], v[32:47]
    ds_read_b128 v[176:179], v196 offset:8192
    v_mfma_f32_32x32x16_bf16 v[16:31], a[44:47], v[156:159], v[16:31]
    ds_read_b128 v[180:183], v193 offset:8192
    s_waitcnt lgkmcnt(4)
    v_mfma_f32_32x32x16_bf16 v[32:47], a[48:51], v[160:163], v[32:47]
    ds_read_b128 v[184:187], v196 offset:12288
    buffer_load_dwordx4 v1, s[4:7], s54 offen offset:1024 sc1 lds
    v_mfma_f32_32x32x16_bf16 v[16:31], a[48:51], v[164:167], v[16:31]
    ds_read_b128 v[188:191], v193 offset:12288
    s_barrier
    s_waitcnt lgkmcnt(4)
    v_mfma_f32_32x32x16_bf16 v[32:47], a[52:55], v[168:171], v[32:47]
    ds_read_b128 v[128:131], v195 offset:16384
    buffer_load_dwordx4 v1, s[4:7], s54 offen offset:2048 sc1 lds
    v_mfma_f32_32x32x16_bf16 v[16:31], a[52:55], v[172:175], v[16:31]
    ds_read_b128 v[132:135], v192 offset:16384
    s_waitcnt lgkmcnt(4)
    v_mfma_f32_32x32x16_bf16 v[32:47], a[56:59], v[176:179], v[32:47]
    ds_read_b128 v[136:139], v195 offset:20480
    buffer_load_dwordx4 v1, s[4:7], s54 offen offset:3072 sc1 lds
    v_mfma_f32_32x32x16_bf16 v[16:31], a[56:59], v[180:183], v[16:31]
    ds_read_b128 v[140:143], v192 offset:20480
    s_waitcnt lgkmcnt(4)
    v_mfma_f32_32x32x16_bf16 v[32:47], a[60:63], v[184:187], v[32:47]
    ds_read_b128 v[144:147], v195 offset:24576
    s_add_u32 m0, s49, 81920
    s_add_u32 s54, s61, 147456
    buffer_load_dwordx4 v1, s[4:7], s54 offen sc1 lds
    v_mfma_f32_32x32x16_bf16 v[16:31], a[60:63], v[188:191], v[16:31]
    ds_read_b128 v[148:151], v192 offset:24576
    s_waitcnt lgkmcnt(4)
    v_mfma_f32_32x32x16_bf16 v[32:47], a[64:67], v[128:131], v[32:47]
    ds_read_b128 v[152:155], v195 offset:28672
    v_mfma_f32_32x32x16_bf16 v[16:31], a[64:67], v[132:135], v[16:31]
    ds_read_b128 v[156:159], v192 offset:28672
    buffer_load_dwordx4 v1, s[4:7], s54 offen offset:1024 sc1 lds
    s_waitcnt lgkmcnt(4)
    v_mfma_f32_32x32x16_bf16 v[32:47], a[68:71], v[136:139], v[32:47]
    ds_read_b128 v[160:163], v195 offset:0
    v_mfma_f32_32x32x16_bf16 v[16:31], a[68:71], v[140:143], v[16:31]
    ds_read_b128 v[164:167], v192 offset:0
    buffer_load_dwordx4 v1, s[4:7], s54 offen offset:2048 sc1 lds
    s_waitcnt lgkmcnt(4)
    v_mfma_f32_32x32x16_bf16 v[32:47], a[72:75], v[144:147], v[32:47]
    ds_read_b128 v[168:171], v195 offset:4096
    buffer_load_dword v127, v15, s[4:7], s76 offen offset:1536 sc1
    v_mfma_f32_32x32x16_bf16 v[16:31], a[72:75], v[148:151], v[16:31]
    ds_read_b128 v[172:175], v192 offset:4096
    buffer_load_dwordx4 v1, s[4:7], s54 offen offset:3072 sc1 lds
    s_waitcnt lgkmcnt(4)
    v_mfma_f32_32x32x16_bf16 v[32:47], a[76:79], v[152:155], v[32:47]
    ds_read_b128 v[176:179], v195 offset:8192
    v_mfma_f32_32x32x16_bf16 v[16:31], a[76:79], v[156:159], v[16:31]
    ds_read_b128 v[180:183], v192 offset:8192
    s_add_u32 m0, s49, 114688
    s_add_u32 s54, s61, 163840
    buffer_load_dwordx4 v1, s[4:7], s54 offen sc1 lds
    s_waitcnt lgkmcnt(4)
    v_mfma_f32_32x32x16_bf16 v[32:47], a[80:83], v[160:163], v[32:47]
    ds_read_b128 v[184:187], v195 offset:12288
    v_mfma_f32_32x32x16_bf16 v[16:31], a[80:83], v[164:167], v[16:31]
    ds_read_b128 v[188:191], v192 offset:12288
    s_waitcnt vmcnt(10)
    s_barrier
    s_waitcnt lgkmcnt(4)
    v_mfma_f32_32x32x16_bf16 v[32:47], a[84:87], v[168:171], v[32:47]
    ds_read_b128 v[128:131], v195 offset:49152
    buffer_load_dwordx4 v1, s[4:7], s54 offen offset:1024 sc1 lds
    v_mfma_f32_32x32x16_bf16 v[16:31], a[84:87], v[172:175], v[16:31]
    ds_read_b128 v[132:135], v192 offset:49152
    s_waitcnt lgkmcnt(4)
    v_mfma_f32_32x32x16_bf16 v[32:47], a[88:91], v[176:179], v[32:47]
    ds_read_b128 v[136:139], v195 offset:53248
    buffer_load_dwordx4 v1, s[4:7], s54 offen offset:2048 sc1 lds
    v_mfma_f32_32x32x16_bf16 v[16:31], a[88:91], v[180:183], v[16:31]
    ds_read_b128 v[140:143], v192 offset:53248
    s_waitcnt lgkmcnt(4)
    v_mfma_f32_32x32x16_bf16 v[32:47], a[92:95], v[184:187], v[32:47]
    ds_read_b128 v[144:147], v195 offset:57344
    buffer_load_dwordx4 v1, s[4:7], s54 offen offset:3072 sc1 lds
    v_mfma_f32_32x32x16_bf16 v[16:31], a[92:95], v[188:191], v[16:31]
    ds_read_b128 v[148:151], v192 offset:57344
    s_waitcnt lgkmcnt(4)
    v_mfma_f32_32x32x16_bf16 v[32:47], a[96:99], v[128:131], v[32:47]
    ds_read_b128 v[152:155], v195 offset:61440
    s_add_u32 m0, s49, 131072
    s_add_u32 s54, s61, 180224
    buffer_load_dwordx4 v1, s[4:7], s54 offen sc1 lds
    v_mfma_f32_32x32x16_bf16 v[16:31], a[96:99], v[132:135], v[16:31]
    ds_read_b128 v[156:159], v192 offset:61440
    s_waitcnt lgkmcnt(4)
    v_mfma_f32_32x32x16_bf16 v[32:47], a[100:103], v[136:139], v[32:47]
    ds_read_b128 v[160:163], v195 offset:32768
    v_mfma_f32_32x32x16_bf16 v[16:31], a[100:103], v[140:143], v[16:31]
    ds_read_b128 v[164:167], v192 offset:32768
    buffer_load_dwordx4 v1, s[4:7], s54 offen offset:1024 sc1 lds
    s_waitcnt lgkmcnt(4)
    v_mfma_f32_32x32x16_bf16 v[32:47], a[104:107], v[144:147], v[32:47]
    ds_read_b128 v[168:171], v195 offset:36864
    v_mfma_f32_32x32x16_bf16 v[16:31], a[104:107], v[148:151], v[16:31]
    ds_read_b128 v[172:175], v192 offset:36864
    buffer_load_dwordx4 v1, s[4:7], s54 offen offset:2048 sc1 lds
    s_waitcnt lgkmcnt(4)
    v_mfma_f32_32x32x16_bf16 v[32:47], a[108:111], v[152:155], v[32:47]
    ds_read_b128 v[176:179], v195 offset:40960
    v_mfma_f32_32x32x16_bf16 v[16:31], a[108:111], v[156:159], v[16:31]
    ds_read_b128 v[180:183], v192 offset:40960
    s_waitcnt vmcnt(8)
    v_cmp_ne_u32_e32 vcc, s36, v127
    s_cbranch_vccnz L_spin_61
L_back_62:
    buffer_load_dwordx4 v1, s[4:7], s54 offen offset:3072 sc1 lds
    s_waitcnt lgkmcnt(4)
    v_mfma_f32_32x32x16_bf16 v[32:47], a[112:115], v[160:163], v[32:47]
    ds_read_b128 v[184:187], v195 offset:45056
    v_mfma_f32_32x32x16_bf16 v[16:31], a[112:115], v[164:167], v[16:31]
    ds_read_b128 v[188:191], v192 offset:45056
    s_waitcnt vmcnt(8)
    s_barrier
    s_waitcnt lgkmcnt(4)
    v_mfma_f32_32x32x16_bf16 v[32:47], a[116:119], v[168:171], v[32:47]
    ds_read_b128 v[128:131], v196 offset:32768
    s_add_u32 m0, s49, 65536
    s_add_u32 s54, s61, 196608
    buffer_load_dwordx4 v1, s[4:7], s54 offen sc1 lds
    v_mfma_f32_32x32x16_bf16 v[16:31], a[116:119], v[172:175], v[16:31]
    ds_read_b128 v[132:135], v193 offset:32768
    s_waitcnt lgkmcnt(4)
    v_mfma_f32_32x32x16_bf16 v[32:47], a[120:123], v[176:179], v[32:47]
    ds_read_b128 v[136:139], v196 offset:36864
    buffer_load_dwordx4 v1, s[4:7], s54 offen offset:1024 sc1 lds
    v_mfma_f32_32x32x16_bf16 v[16:31], a[120:123], v[180:183], v[16:31]
    ds_read_b128 v[140:143], v193 offset:36864
    s_waitcnt lgkmcnt(4)
    v_mfma_f32_32x32x16_bf16 v[32:47], a[124:127], v[184:187], v[32:47]
    ds_read_b128 v[144:147], v196 offset:40960
    buffer_load_dwordx4 v1, s[4:7], s54 offen offset:2048 sc1 lds
    v_mfma_f32_32x32x16_bf16 v[16:31], a[124:127], v[188:191], v[16:31]
    ds_read_b128 v[148:151], v193 offset:40960
    s_waitcnt lgkmcnt(4)
    v_mfma_f32_32x32x16_bf16 v[32:47], a[128:131], v[128:131], v[32:47]
    ds_read_b128 v[152:155], v196 offset:45056
    buffer_load_dwordx4 v1, s[4:7], s54 offen offset:3072 sc1 lds
    v_mfma_f32_32x32x16_bf16 v[16:31], a[128:131], v[132:135], v[16:31]
    ds_read_b128 v[156:159], v193 offset:45056
    s_waitcnt lgkmcnt(4)
    v_mfma_f32_32x32x16_bf16 v[32:47], a[132:135], v[136:139], v[32:47]
    ds_read_b128 v[160:163], v196 offset:16384
    s_add_u32 m0, s49, 16384
    s_add_u32 s54, s61, 212992
    buffer_load_dwordx4 v1, s[4:7], s54 offen sc1 lds
    v_mfma_f32_32x32x16_bf16 v[16:31], a[132:135], v[140:143], v[16:31]
    ds_read_b128 v[164:167], v193 offset:16384
    s_waitcnt lgkmcnt(4)
    v_mfma_f32_32x32x16_bf16 v[32:47], a[136:139], v[144:147], v[32:47]
    ds_read_b128 v[168:171], v196 offset:20480
    v_mfma_f32_32x32x16_bf16 v[16:31], a[136:139], v[148:151], v[16:31]
    ds_read_b128 v[172:175], v193 offset:20480
    buffer_load_dwordx4 v1, s[4:7], s54 offen offset:1024 sc1 lds
    s_waitcnt lgkmcnt(4)
    v_mfma_f32_32x32x16_bf16 v[32:47], a[140:143], v[152:155], v[32:47]
    ds_read_b128 v[176:179], v196 offset:24576
    v_mfma_f32_32x32x16_bf16 v[16:31], a[140:143], v[156:159], v[16:31]
    ds_read_b128 v[180:183], v193 offset:24576
    buffer_load_dwordx4 v1, s[4:7], s54 offen offset:2048 sc1 lds
    s_waitcnt lgkmcnt(4)
    v_mfma_f32_32x32x16_bf16 v[32:47], a[144:147], v[160:163], v[32:47]
    ds_read_b128 v[184:187], v196 offset:28672
    v_mfma_f32_32x32x16_bf16 v[16:31], a[144:147], v[164:167], v[16:31]
    ds_read_b128 v[188:191], v193 offset:28672
    buffer_load_dwordx4 v1, s[4:7], s54 offen offset:3072 sc1 lds
    s_waitcnt vmcnt(8)
    s_barrier
    s_waitcnt lgkmcnt(4)
    v_mfma_f32_32x32x16_bf16 v[32:47], a[148:151], v[168:171], v[32:47]
    ds_read_b128 v[128:131], v196 offset:49152
    v_mfma_f32_32x32x16_bf16 v[16:31], a[148:151], v[172:175], v[16:31]
    ds_read_b128 v[132:135], v193 offset:49152
    s_waitcnt lgkmcnt(4)
    v_mfma_f32_32x32x16_bf16 v[32:47], a[152:155], v[176:179], v[32:47]
    ds_read_b128 v[136:139], v196 offset:53248
    v_mfma_f32_32x32x16_bf16 v[16:31], a[152:155], v[180:183], v[16:31]
    ds_read_b128 v[140:143], v193 offset:53248
    s_waitcnt lgkmcnt(4)
    v_mfma_f32_32x32x16_bf16 v[32:47], a[156:159], v[184:187], v[32:47]
    ds_read_b128 v[144:147], v196 offset:57344
    v_mfma_f32_32x32x16_bf16 v[16:31], a[156:159], v[188:191], v[16:31]
    ds_read_b128 v[148:151], v193 offset:57344
    s_waitcnt lgkmcnt(4)
    v_mfma_f32_32x32x16_bf16 v[32:47], a[160:163], v[128:131], v[32:47]
    ds_read_b128 v[152:155], v196 offset:61440
    v_mfma_f32_32x32x16_bf16 v[16:31], a[160:163], v[132:135], v[16:31]
    ds_read_b128 v[156:159], v193 offset:61440
    s_waitcnt lgkmcnt(4)
    v_mfma_f32_32x32x16_bf16 v[32:47], a[164:167], v[136:139], v[32:47]
    ds_read_b128 v[160:163], v197 offset:0
    v_mfma_f32_32x32x16_bf16 v[16:31], a[164:167], v[140:143], v[16:31]
    ds_read_b128 v[164:167], v194 offset:0
    s_waitcnt lgkmcnt(4)
    v_mfma_f32_32x32x16_bf16 v[32:47], a[168:171], v[144:147], v[32:47]
    ds_read_b128 v[168:171], v197 offset:4096
    v_mfma_f32_32x32x16_bf16 v[16:31], a[168:171], v[148:151], v[16:31]
    ds_read_b128 v[172:175], v194 offset:4096
    s_waitcnt lgkmcnt(4)
    v_mfma_f32_32x32x16_bf16 v[32:47], a[172:175], v[152:155], v[32:47]
    ds_read_b128 v[176:179], v197 offset:8192
    v_mfma_f32_32x32x16_bf16 v[16:31], a[172:175], v[156:159], v[16:31]
    ds_read_b128 v[180:183], v194 offset:8192
    s_waitcnt lgkmcnt(4)
    v_mfma_f32_32x32x16_bf16 v[32:47], a[176:179], v[160:163], v[32:47]
    ds_read_b128 v[184:187], v197 offset:12288
    v_mfma_f32_32x32x16_bf16 v[16:31], a[176:179], v[164:167], v[16:31]
    ds_read_b128 v[188:191], v194 offset:12288
    s_waitcnt vmcnt(0)
    s_barrier
    s_waitcnt lgkmcnt(4)
    v_mfma_f32_32x32x16_bf16 v[32:47], a[180:183], v[168:171], v[32:47]
    ds_read_b128 v[128:131], v196 offset:0
    v_mfma_f32_32x32x16_bf16 v[16:31], a[180:183], v[172:175], v[16:31]
    ds_read_b128 v[132:135], v193 offset:0
    s_waitcnt lgkmcnt(4)
    v_mfma_f32_32x32x16_bf16 v[32:47], a[184:187], v[176:179], v[32:47]
    ds_read_b128 v[136:139], v196 offset:4096
    v_mfma_f32_32x32x16_bf16 v[16:31], a[184:187], v[180:183], v[16:31]
    ds_read_b128 v[140:143], v193 offset:4096
    s_waitcnt lgkmcnt(4)
    v_mfma_f32_32x32x16_bf16 v[32:47], a[188:191], v[184:187], v[32:47]
    ds_read_b128 v[144:147], v196 offset:8192
    v_mfma_f32_32x32x16_bf16 v[16:31], a[188:191], v[188:191], v[16:31]
    ds_read_b128 v[148:151], v193 offset:8192
    s_waitcnt lgkmcnt(4)
    v_mfma_f32_32x32x16_bf16 v[32:47], a[192:195], v[128:131], v[32:47]
    ds_read_b128 v[152:155], v196 offset:12288
    v_mfma_f32_32x32x16_bf16 v[16:31], a[192:195], v[132:135], v[16:31]
    ds_read_b128 v[156:159], v193 offset:12288
    s_waitcnt lgkmcnt(4)
    v_mfma_f32_32x32x16_bf16 v[32:47], a[196:199], v[136:139], v[32:47]
    ds_read_b128 v[160:163], v195 offset:16384
    v_mfma_f32_32x32x16_bf16 v[16:31], a[196:199], v[140:143], v[16:31]
    ds_read_b128 v[164:167], v192 offset:16384
    s_waitcnt lgkmcnt(4)
    v_mfma_f32_32x32x16_bf16 v[32:47], a[200:203], v[144:147], v[32:47]
    ds_read_b128 v[168:171], v195 offset:20480
    v_mfma_f32_32x32x16_bf16 v[16:31], a[200:203], v[148:151], v[16:31]
    ds_read_b128 v[172:175], v192 offset:20480
    s_waitcnt lgkmcnt(4)
    v_mfma_f32_32x32x16_bf16 v[32:47], a[204:207], v[152:155], v[32:47]
    ds_read_b128 v[176:179], v195 offset:24576
    v_mfma_f32_32x32x16_bf16 v[16:31], a[204:207], v[156:159], v[16:31]
    ds_read_b128 v[180:183], v192 offset:24576
    s_waitcnt lgkmcnt(4)
    v_mfma_f32_32x32x16_bf16 v[32:47], a[208:211], v[160:163], v[32:47]
    ds_read_b128 v[184:187], v195 offset:28672
    v_mfma_f32_32x32x16_bf16 v[16:31], a[208:211], v[164:167], v[16:31]
    ds_read_b128 v[188:191], v192 offset:28672
    s_waitcnt lgkmcnt(4)
    v_mfma_f32_32x32x16_bf16 v[32:47], a[212:215], v[168:171], v[32:47]
    s_waitcnt lgkmcnt(2)
    v_mfma_f32_32x32x16_bf16 v[32:47], a[216:219], v[176:179], v[32:47]
    s_waitcnt lgkmcnt(0)
    v_mfma_f32_32x32x16_bf16 v[32:47], a[220:223], v[184:187], v[32:47]
    v_mfma_f32_32x32x16_bf16 v[16:31], a[212:215], v[172:175], v[16:31]
    v_mfma_f32_32x32x16_bf16 v[16:31], a[216:219], v[180:183], v[16:31]
    v_mfma_f32_32x32x16_bf16 v[16:31], a[220:223], v[188:191], v[16:31]
    s_nop 8
    ds_write_b128 v112, v[32:35] offset:0
    ds_write_b128 v112, v[36:39] offset:1024
    ds_write_b128 v112, v[40:43] offset:2048
    ds_write_b128 v112, v[44:47] offset:3072
    s_waitcnt lgkmcnt(0)
    s_barrier
    ds_read_b128 v[48:51], v113 offset:0
    ds_read_b128 v[52:55], v113 offset:1024
    ds_read_b128 v[56:59], v113 offset:2048
    ds_read_b128 v[60:63], v113 offset:3072
    s_waitcnt lgkmcnt(3)
    v_pk_add_f32 v[16:17], v[16:17], v[48:49]
    v_pk_add_f32 v[18:19], v[18:19], v[50:51]
    s_waitcnt lgkmcnt(2)
    v_pk_add_f32 v[20:21], v[20:21], v[52:53]
    v_pk_add_f32 v[22:23], v[22:23], v[54:55]
    v_cvt_pk_bf16_f32 v32, v16, v17
    v_cvt_pk_bf16_f32 v33, v18, v19
    v_cvt_pk_bf16_f32 v34, v20, v21
    v_cvt_pk_bf16_f32 v35, v22, v23
    s_nop 0
    v_permlane32_swap_b32_e32 v32, v34
    v_permlane32_swap_b32_e32 v33, v35
    buffer_store_dwordx4 v[32:35], v114, s[28:31], s56 offen offset:0
    s_waitcnt lgkmcnt(1)
    v_pk_add_f32 v[24:25], v[24:25], v[56:57]
    v_pk_add_f32 v[26:27], v[26:27], v[58:59]
    s_waitcnt lgkmcnt(0)
    v_pk_add_f32 v[28:29], v[28:29], v[60:61]
    v_pk_add_f32 v[30:31], v[30:31], v[62:63]
    v_cvt_pk_bf16_f32 v36, v24, v25
    v_cvt_pk_bf16_f32 v37, v26, v27
    v_cvt_pk_bf16_f32 v38, v28, v29
    v_cvt_pk_bf16_f32 v39, v30, v31
    s_nop 0
    v_permlane32_swap_b32_e32 v36, v38
    v_permlane32_swap_b32_e32 v37, v39
    buffer_store_dwordx4 v[36:39], v114, s[28:31], s56 offen offset:32
    s_cmp_lg_u32 s2, 0
    s_cbranch_scc1 L_fin
    v_mov_b32_e32 v14, s36
    s_mov_b64 exec, 1
    buffer_store_dword v14, off, s[4:7], 0
    s_mov_b64 exec, -1
L_fin:
L_abort:
L_end:
    s_endpgm
L_spin_3:
    s_add_u32 s44, s44, 1
    s_cbranch_scc1 L_abort
    buffer_load_dword v76, v77, s[4:7], s88 offen offset:0 sc1
    s_waitcnt vmcnt(0)
    v_cmp_ne_u32_e32 vcc, s36, v76
    s_cbranch_vccnz L_spin_3
    s_branch L_back_4
L_retry_6:
    s_add_u32 s44, s44, 1
    s_cbranch_scc1 L_abort
    s_sleep 1
    buffer_load_dwordx4 v[16:19], v25, s[4:7], s56 offen sc1
    buffer_load_dwordx4 v[20:23], v1, s[4:7], s57 offen sc1
    buffer_load_dword v24, v15, s[4:7], s59 offen sc1
    s_waitcnt vmcnt(0)
    s_branch L_chk_5
L_retry_8:
    s_add_u32 s44, s44, 1
    s_cbranch_scc1 L_abort
    s_sleep 1
    buffer_load_dwordx4 v[32:35], v1, s[4:7], s58 offen sc1
    s_waitcnt vmcnt(0)
    s_branch L_chk_7
L_slow_9:
    buffer_wbl2 sc1
    s_waitcnt vmcnt(0)
    buffer_store_dword v14, off, s[4:7], s73 offset:384 sc1
    s_branch L_back_10
L_slow_12:
    buffer_wbl2 sc1
    s_waitcnt vmcnt(0)
    buffer_store_dword v14, off, s[4:7], s71 offset:0 sc1
    s_branch L_back_13
L_slow_15:
    buffer_wbl2 sc1
    s_waitcnt vmcnt(0)
    buffer_store_dword v14, off, s[4:7], s75 offset:640 sc1
    s_branch L_back_16
L_spin_17:
    s_add_u32 s44, s44, 1
    s_cbranch_scc1 L_abort
    buffer_load_dword v127, v15, s[4:7], s76 offen offset:640 sc1
    s_waitcnt vmcnt(0)
    v_cmp_ne_u32_e32 vcc, s36, v127
    s_cbranch_vccnz L_spin_17
    s_branch L_back_18
L_slow_19:
    buffer_wbl2 sc1
    s_waitcnt vmcnt(0)
    buffer_store_dword v14, off, s[4:7], s75 offset:768 sc1
    s_branch L_back_20
L_spin_21:
    s_add_u32 s44, s44, 1
    s_cbranch_scc1 L_abort
    buffer_load_dword v127, v15, s[4:7], s76 offen offset:768 sc1
    s_waitcnt vmcnt(0)
    v_cmp_ne_u32_e32 vcc, s36, v127
    s_cbranch_vccnz L_spin_21
    s_branch L_back_22
L_spin_24:
    s_add_u32 s44, s44, 1
    s_cbranch_scc1 L_abort
    buffer_load_dword v118, v116, s[4:7], s88 offen offset:0 sc1
    s_waitcnt vmcnt(0)
    v_cmp_ne_u32_e32 vcc, s36, v118
    s_cbranch_vccnz L_spin_24
    s_branch L_back_25
L_slow_26:
    buffer_wbl2 sc1
    s_waitcnt vmcnt(0)
    buffer_store_dword v14, off, s[4:7], s75 offset:896 sc1
    s_branch L_back_27
L_spin_28:
    s_add_u32 s44, s44, 1
    s_cbranch_scc1 L_abort
    buffer_load_dword v127, v15, s[4:7], s76 offen offset:896 sc1
    s_waitcnt vmcnt(0)
    v_cmp_ne_u32_e32 vcc, s36, v127
    s_cbranch_vccnz L_spin_28
    s_branch L_back_29
L_slow_30:
    buffer_wbl2 sc1
    s_waitcnt vmcnt(0)
    buffer_store_dword v14, off, s[4:7], s75 offset:1024 sc1
    s_branch L_back_31
L_spin_32:
    s_add_u32 s44, s44, 1
    s_cbranch_scc1 L_abort
    buffer_load_dword v127, v15, s[4:7], s76 offen offset:1024 sc1
    s_waitcnt vmcnt(0)
    v_cmp_ne_u32_e32 vcc, s36, v127
    s_cbranch_vccnz L_spin_32
    s_branch L_back_33
L_slow_34:
    buffer_wbl2 sc1
    s_waitcnt vmcnt(0)
    buffer_store_dword v14, off, s[4:7], s71 offset:128 sc1
    s_branch L_back_35
L_retry_38:
    s_add_u32 s44, s44, 1
    s_cbranch_scc1 L_abort
    s_sleep 1
    buffer_load_dwordx4 v[16:19], v25, s[4:7], s56 offen sc1
    buffer_load_dwordx4 v[20:23], v1, s[4:7], s57 offen sc1
    s_waitcnt vmcnt(0)
    s_branch L_chk_37
L_retry_40:
    s_add_u32 s44, s44, 1
    s_cbranch_scc1 L_abort
    s_sleep 1
    buffer_load_dwordx4 v[32:35], v1, s[4:7], s58 offen sc1
    s_waitcnt vmcnt(0)
    s_branch L_chk_39
L_slow_41:
    buffer_wbl2 sc1
    s_waitcnt vmcnt(0)
    buffer_store_dword v14, off, s[4:7], s73 offset:512 sc1
    s_branch L_back_42
L_slow_44:
    buffer_wbl2 sc1
    s_waitcnt vmcnt(0)
    buffer_store_dword v14, off, s[4:7], s71 offset:256 sc1
    s_branch L_back_45
L_slow_47:
    buffer_wbl2 sc1
    s_waitcnt vmcnt(0)
    buffer_store_dword v14, off, s[4:7], s75 offset:1152 sc1
    s_branch L_back_48
L_spin_49:
    s_add_u32 s44, s44, 1
    s_cbranch_scc1 L_abort
    buffer_load_dword v127, v15, s[4:7], s76 offen offset:1152 sc1
    s_waitcnt vmcnt(0)
    v_cmp_ne_u32_e32 vcc, s36, v127
    s_cbranch_vccnz L_spin_49
    s_branch L_back_50
L_slow_51:
    buffer_wbl2 sc1
    s_waitcnt vmcnt(0)
    buffer_store_dword v14, off, s[4:7], s75 offset:1280 sc1
    s_branch L_back_52
L_spin_53:
    s_add_u32 s44, s44, 1
    s_cbranch_scc1 L_abort
    buffer_load_dword v127, v15, s[4:7], s76 offen offset:1280 sc1
    s_waitcnt vmcnt(0)
    v_cmp_ne_u32_e32 vcc, s36, v127
    s_cbranch_vccnz L_spin_53
    s_branch L_back_54
L_slow_55:
    buffer_wbl2 sc1
    s_waitcnt vmcnt(0)
    buffer_store_dword v14, off, s[4:7], s75 offset:1408 sc1
    s_branch L_back_56
L_spin_57:
    s_add_u32 s44, s44, 1
    s_cbranch_scc1 L_abort
    buffer_load_dword v127, v15, s[4:7], s76 offen offset:1408 sc1
    s_waitcnt vmcnt(0)
    v_cmp_ne_u32_e32 vcc, s36, v127
    s_cbranch_vccnz L_spin_57
    s_branch L_back_58
L_slow_59:
    buffer_wbl2 sc1
    s_waitcnt vmcnt(0)
    buffer_store_dword v14, off, s[4:7], s75 offset:1536 sc1
    s_branch L_back_60
L_spin_61:
    s_add_u32 s44, s44, 1
    s_cbranch_scc1 L_abort
    buffer_load_dword v127, v15, s[4:7], s76 offen offset:1536 sc1
    s_waitcnt vmcnt(0)
    v_cmp_ne_u32_e32 vcc, s36, v127
    s_cbranch_vccnz L_spin_61
    s_branch L_back_62
L_codeend:

.section .rodata,"a"
.p2align 6
.amdhsa_kernel interleave_layers__linear_kernel_hedgehog__glu_gated_glu__prompt_kernel
  .amdhsa_next_free_vgpr 512
  .amdhsa_next_free_sgpr 102
  .amdhsa_accum_offset 256
  .amdhsa_group_segment_fixed_size 0
  .amdhsa_kernarg_size 88
  .amdhsa_user_sgpr_count 2
  .amdhsa_user_sgpr_kernarg_segment_ptr 1
  .amdhsa_system_sgpr_workgroup_id_x 1
  .amdhsa_float_denorm_mode_32 3
.end_amdhsa_kernel
```
